```python
import torch

def _softmax(x, axis=-1):
    return torch.softmax(x, dim=axis)
def _gelu(x):
    return torch.nn.functional.gelu(x, approximate="tanh")
def _silu(x):
    return torch.nn.functional.silu(x)
def _sigmoid(x):
    return torch.sigmoid(x)
def _layernorm(x, axis=-1, eps=1e-5):
    m = x.mean(dim=axis, keepdim=True)
    v = x.var(dim=axis, keepdim=True, unbiased=False)
    return (x - m) / torch.sqrt(v + eps)
def _scatter_add(tgt, idx, src, axis=0):
    return tgt.clone().index_add_(axis, idx, src)
def _segment_sum(src, seg, n):
    out = torch.zeros((n,) + src.shape[1:], dtype=src.dtype)
    return out.index_add_(0, seg, src)
def _pad(x, pw):
    flat = tuple(v for pair in reversed(pw) for v in pair)
    return torch.nn.functional.pad(x, flat)

kernel_name = 'parallel_sum__mha_block__dense_activation_gelu__prompt'

def setup_inputs():

    _w = (lambda a: (lambda t: t.to(torch.bfloat16) if t.is_floating_point() else t)(torch.as_tensor(a)))
    def _A_setup():
        B, S, D, H = 1, 2048, 640, 32
        return {
            "x": _w((lambda *s: torch.randn(*s, dtype=torch.bfloat16) * 0.05)(B, S, D)),
            "wqkv": _w((lambda *s: torch.randn(*s, dtype=torch.bfloat16) * 0.05)(D, 3 * D)),
            "wo": _w((lambda *s: torch.randn(*s, dtype=torch.bfloat16) * 0.05)(D, D)),
        }
    _A_in = _A_setup()

    def _B_setup():
        B, S, D, F = 1, 2048, 640, 1728
        return {
            "x": _w((lambda *s: torch.randn(*s, dtype=torch.bfloat16) * 0.05)(B, S, D)),
            "w1": _w((lambda *s: torch.randn(*s, dtype=torch.bfloat16) * 1.6)(D, F) * (D ** -0.5)),
            "b1": _w((lambda *s: torch.randn(*s, dtype=torch.bfloat16) * 1.6)(F) * 0.01),
            "w2": _w((lambda *s: torch.randn(*s, dtype=torch.bfloat16) * 0.2)(F, D) * (F ** -0.5)),
            "b2": _w((lambda *s: torch.randn(*s, dtype=torch.bfloat16) * 0.2)(D) * 0.01),
        }
    _B_in = _B_setup()

    return {
        "A_x": _A_in["x"],
        "A_wqkv": _A_in["wqkv"],
        "A_wo": _A_in["wo"],
        "B_x": _B_in["x"],
        "B_w1": _B_in["w1"],
        "B_b1": _B_in["b1"],
        "B_w2": _B_in["w2"],
        "B_b2": _B_in["b2"],
    }

def reference(A_x, A_wqkv, A_wo, B_x, B_w1, B_b1, B_w2, B_b2):
    def _A_ref(x, wqkv, wo):
        B, S, D = x.shape
        H = 32
        Dh = D // H
        qkv = (lambda x, *d: x.permute(*d))((x @ wqkv).reshape(B, S, 3, H, Dh), 2, 0, 3, 1, 4)
        q, k, v = qkv[0], qkv[1], qkv[2]
        scores = torch.einsum("bhqd,bhkd->bhqk", q, k) * (Dh ** -0.5)
        p = _softmax(scores, axis=-1)
        o = torch.einsum("bhqk,bhkd->bhqd", p, v)
        return (lambda x, *d: x.permute(*d))(o, 0, 2, 1, 3).reshape(B, S, D) @ wo

    def _B_ref(x, w1, b1, w2, b2):
        h = torch.einsum("bsd,df->bsf", x, w1) + b1
        h = _gelu(h)
        return torch.einsum("bsf,fd->bsd", h, w2) + b2

    x = A_x
    xn = _layernorm(x, axis=-1)
    return x + _A_ref(xn, A_wqkv, A_wo) + _B_ref(xn, B_w1, B_b1, B_w2, B_b2)
```

```asm
; @launch grid=(256,1,1) block=(768,1,1) lds=159488
.amdgcn_target "amdgcn-amd-amdhsa--gfx950"
.text
.globl parallel_sum__mha_block__dense_activation_gelu__prompt_kernel
.p2align 8
.type parallel_sum__mha_block__dense_activation_gelu__prompt_kernel,@function
parallel_sum__mha_block__dense_activation_gelu__prompt_kernel:
    s_cmp_ge_u32 s2, 256
    s_cbranch_scc1 K_END
    s_load_dwordx4 s[4:7], s[0:1], 0
    s_load_dwordx4 s[68:71], s[0:1], 72
    s_load_dwordx2 s[24:25], s[0:1], 16
    s_load_dwordx4 s[52:55], s[0:1], 32
    s_load_dwordx4 s[28:31], s[0:1], 48
    s_load_dwordx2 s[72:73], s[0:1], 64
    s_mov_b32 s101, 0
    v_lshrrev_b32 v1, 6, v0
    s_and_b32 s34, s2, 7
    v_readfirstlane_b32 s3, v1
    v_and_b32 v1, 63, v0
    s_lshr_b32 s35, s2, 3
    s_and_b32 s32, s34, 3
    s_lshl_b32 s32, s32, 2
    s_and_b32 s36, s35, 3
    s_add_u32 s32, s32, s36
    s_lshr_b32 s33, s35, 2
    s_lshr_b32 s36, s34, 2
    s_sub_u32 s33, s33, s36
    s_and_b32 s33, s33, 7
    s_lshl_b32 s36, s36, 3
    s_add_u32 s33, s33, s36
    s_lshl_b32 s80, s34, 2
    s_lshr_b32 s36, s35, 3
    s_add_u32 s80, s80, s36
    s_and_b32 s81, s35, 7
    s_lshl_b32 s82, s32, 8
    s_add_u32 s82, s82, 20893696
    v_lshlrev_b32 v2, 2, v1
    v_add_u32 v2, 159232, v2
    v_mov_b32 v3, 0
    s_cmp_lg_u32 s3, 0
    s_cbranch_scc1 K_NOZ
    ds_write_b32 v2, v3
K_NOZ:
    s_waitcnt lgkmcnt(0)
    s_mov_b32 s8, s4
    s_mov_b32 s9, s5
    s_mov_b32 s10, 2621440
    s_mov_b32 s11, 0x00020000
    s_mov_b32 s12, s6
    s_mov_b32 s13, s7
    s_mov_b32 s14, 2457600
    s_mov_b32 s15, 0x00020000
    s_mov_b32 s16, s70
    s_mov_b32 s17, s71
    s_mov_b32 s18, 21975040
    s_mov_b32 s19, 0x00020000
    s_mov_b32 s76, s68
    s_mov_b32 s77, s69
    s_mov_b32 s78, 256
    s_mov_b32 s79, 0x00020000
    s_cmp_eq_u32 s33, 15
    s_cbranch_scc1 K_STATS
    s_cmp_lt_u32 s3, 4
    s_cbranch_scc1 K_MFMA
    s_sub_u32 s34, s3, 4
    s_cmp_ge_u32 s34, 4
    s_cbranch_scc1 H_WARM
    v_lshrrev_b32 v143, 3, v1
    v_and_b32 v144, 7, v1
    v_lshrrev_b32 v145, 4, v1
    v_xor_b32 v144, v144, v145
    v_mul_u32_u24 v140, 1280, v143
    s_lshl_b32 s36, s32, 2
    s_add_u32 s36, s36, s34
    s_mul_i32 s36, s36, 40960
    v_add_u32 v140, s36, v140
    v_add_u32 v141, 10240, v140
    v_lshl_add_u32 v140, v144, 4, v140
    v_xor_b32 v144, 4, v144
    v_lshl_add_u32 v141, v144, 4, v141
    v_add_u32 v152, 20480, v140
    v_add_u32 v153, 20480, v141
    s_lshl_b32 s44, s34, 12
    v_bfe_u32 v143, v1, 2, 2
    v_mul_u32_u24 v142, 3840, v143
    v_and_b32 v143, 3, v1
    v_lshl_add_u32 v142, v143, 4, v142
    v_lshrrev_b32 v143, 4, v1
    v_lshl_add_u32 v142, v143, 6, v142
    s_mul_i32 s46, s34, 61440
    s_lshl_b32 s36, s33, 8
    s_add_u32 s46, s46, s36
    s_mov_b32 s45, 0
    s_add_u32 m0, s44, 0
    s_nop 0
    buffer_load_dwordx4 v140, s[8:11], s45 offen lds
    s_add_u32 m0, s44, 16384
    s_nop 0
    buffer_load_dwordx4 v142, s[12:15], s46 offen lds
    s_add_u32 s46, s46, 15360
    s_add_u32 m0, s44, 1024
    s_nop 0
    buffer_load_dwordx4 v141, s[8:11], s45 offen lds
    s_add_u32 m0, s44, 17408
    s_nop 0
    buffer_load_dwordx4 v142, s[12:15], s46 offen lds
    s_add_u32 s46, s46, 15360
    s_add_u32 m0, s44, 2048
    s_nop 0
    buffer_load_dwordx4 v152, s[8:11], s45 offen lds
    s_add_u32 m0, s44, 18432
    s_nop 0
    buffer_load_dwordx4 v142, s[12:15], s46 offen lds
    s_add_u32 s46, s46, 15360
    s_add_u32 m0, s44, 3072
    s_nop 0
    buffer_load_dwordx4 v153, s[8:11], s45 offen lds
    s_add_u32 m0, s44, 19456
    s_nop 0
    buffer_load_dwordx4 v142, s[12:15], s46 offen lds
    s_add_u32 s46, s46, 199680
    s_add_u32 s45, s45, 128
    s_add_u32 m0, s44, 32768
    s_nop 0
    buffer_load_dwordx4 v140, s[8:11], s45 offen lds
    s_add_u32 m0, s44, 49152
    s_nop 0
    buffer_load_dwordx4 v142, s[12:15], s46 offen lds
    s_add_u32 s46, s46, 15360
    s_add_u32 m0, s44, 33792
    s_nop 0
    buffer_load_dwordx4 v141, s[8:11], s45 offen lds
    s_add_u32 m0, s44, 50176
    s_nop 0
    buffer_load_dwordx4 v142, s[12:15], s46 offen lds
    s_add_u32 s46, s46, 15360
    s_add_u32 m0, s44, 34816
    s_nop 0
    buffer_load_dwordx4 v152, s[8:11], s45 offen lds
    s_add_u32 m0, s44, 51200
    s_nop 0
    buffer_load_dwordx4 v142, s[12:15], s46 offen lds
    s_add_u32 s46, s46, 15360
    s_add_u32 m0, s44, 35840
    s_nop 0
    buffer_load_dwordx4 v153, s[8:11], s45 offen lds
    s_add_u32 m0, s44, 52224
    s_nop 0
    buffer_load_dwordx4 v142, s[12:15], s46 offen lds
    s_add_u32 s46, s46, 199680
    s_add_u32 s45, s45, 128
    s_add_u32 m0, s44, 65536
    s_nop 0
    buffer_load_dwordx4 v140, s[8:11], s45 offen lds
    s_add_u32 m0, s44, 81920
    s_nop 0
    buffer_load_dwordx4 v142, s[12:15], s46 offen lds
    s_add_u32 s46, s46, 15360
    s_add_u32 m0, s44, 66560
    s_nop 0
    buffer_load_dwordx4 v141, s[8:11], s45 offen lds
    s_add_u32 m0, s44, 82944
    s_nop 0
    buffer_load_dwordx4 v142, s[12:15], s46 offen lds
    s_add_u32 s46, s46, 15360
    s_add_u32 m0, s44, 67584
    s_nop 0
    buffer_load_dwordx4 v152, s[8:11], s45 offen lds
    s_add_u32 m0, s44, 83968
    s_nop 0
    buffer_load_dwordx4 v142, s[12:15], s46 offen lds
    s_add_u32 s46, s46, 15360
    s_add_u32 m0, s44, 68608
    s_nop 0
    buffer_load_dwordx4 v153, s[8:11], s45 offen lds
    s_add_u32 m0, s44, 84992
    s_nop 0
    buffer_load_dwordx4 v142, s[12:15], s46 offen lds
    s_add_u32 s46, s46, 199680
    s_add_u32 s45, s45, 128
    s_waitcnt vmcnt(16)
    s_barrier
    s_add_u32 m0, s44, 98304
    s_nop 0
    buffer_load_dwordx4 v140, s[8:11], s45 offen lds
    s_add_u32 m0, s44, 114688
    s_nop 0
    buffer_load_dwordx4 v142, s[12:15], s46 offen lds
    s_add_u32 s46, s46, 15360
    s_add_u32 m0, s44, 99328
    s_nop 0
    buffer_load_dwordx4 v141, s[8:11], s45 offen lds
    s_add_u32 m0, s44, 115712
    s_nop 0
    buffer_load_dwordx4 v142, s[12:15], s46 offen lds
    s_add_u32 s46, s46, 15360
    s_add_u32 m0, s44, 100352
    s_nop 0
    buffer_load_dwordx4 v152, s[8:11], s45 offen lds
    s_add_u32 m0, s44, 116736
    s_nop 0
    buffer_load_dwordx4 v142, s[12:15], s46 offen lds
    s_add_u32 s46, s46, 15360
    s_add_u32 m0, s44, 101376
    s_nop 0
    buffer_load_dwordx4 v153, s[8:11], s45 offen lds
    s_add_u32 m0, s44, 117760
    s_nop 0
    buffer_load_dwordx4 v142, s[12:15], s46 offen lds
    s_add_u32 s46, s46, 199680
    s_add_u32 s45, s45, 128
    s_waitcnt vmcnt(16)
    s_barrier
    s_add_u32 m0, s44, 0
    s_nop 0
    buffer_load_dwordx4 v140, s[8:11], s45 offen lds
    s_add_u32 m0, s44, 16384
    s_nop 0
    buffer_load_dwordx4 v142, s[12:15], s46 offen lds
    s_add_u32 s46, s46, 15360
    s_add_u32 m0, s44, 1024
    s_nop 0
    buffer_load_dwordx4 v141, s[8:11], s45 offen lds
    s_add_u32 m0, s44, 17408
    s_nop 0
    buffer_load_dwordx4 v142, s[12:15], s46 offen lds
    s_add_u32 s46, s46, 15360
    s_add_u32 m0, s44, 2048
    s_nop 0
    buffer_load_dwordx4 v152, s[8:11], s45 offen lds
    s_add_u32 m0, s44, 18432
    s_nop 0
    buffer_load_dwordx4 v142, s[12:15], s46 offen lds
    s_add_u32 s46, s46, 15360
    s_add_u32 m0, s44, 3072
    s_nop 0
    buffer_load_dwordx4 v153, s[8:11], s45 offen lds
    s_add_u32 m0, s44, 19456
    s_nop 0
    buffer_load_dwordx4 v142, s[12:15], s46 offen lds
    s_add_u32 s46, s46, 199680
    s_add_u32 s45, s45, 128
    s_waitcnt vmcnt(16)
    s_barrier
    s_add_u32 m0, s44, 32768
    s_nop 0
    buffer_load_dwordx4 v140, s[8:11], s45 offen lds
    s_add_u32 m0, s44, 49152
    s_nop 0
    buffer_load_dwordx4 v142, s[12:15], s46 offen lds
    s_add_u32 s46, s46, 15360
    s_add_u32 m0, s44, 33792
    s_nop 0
    buffer_load_dwordx4 v141, s[8:11], s45 offen lds
    s_add_u32 m0, s44, 50176
    s_nop 0
    buffer_load_dwordx4 v142, s[12:15], s46 offen lds
    s_add_u32 s46, s46, 15360
    s_add_u32 m0, s44, 34816
    s_nop 0
    buffer_load_dwordx4 v152, s[8:11], s45 offen lds
    s_add_u32 m0, s44, 51200
    s_nop 0
    buffer_load_dwordx4 v142, s[12:15], s46 offen lds
    s_add_u32 s46, s46, 15360
    s_add_u32 m0, s44, 35840
    s_nop 0
    buffer_load_dwordx4 v153, s[8:11], s45 offen lds
    s_add_u32 m0, s44, 52224
    s_nop 0
    buffer_load_dwordx4 v142, s[12:15], s46 offen lds
    s_add_u32 s46, s46, 199680
    s_add_u32 s45, s45, 128
    s_waitcnt vmcnt(16)
    s_barrier
    s_add_u32 m0, s44, 65536
    s_nop 0
    buffer_load_dwordx4 v140, s[8:11], s45 offen lds
    s_add_u32 m0, s44, 81920
    s_nop 0
    buffer_load_dwordx4 v142, s[12:15], s46 offen lds
    s_add_u32 s46, s46, 15360
    s_add_u32 m0, s44, 66560
    s_nop 0
    buffer_load_dwordx4 v141, s[8:11], s45 offen lds
    s_add_u32 m0, s44, 82944
    s_nop 0
    buffer_load_dwordx4 v142, s[12:15], s46 offen lds
    s_add_u32 s46, s46, 15360
    s_add_u32 m0, s44, 67584
    s_nop 0
    buffer_load_dwordx4 v152, s[8:11], s45 offen lds
    s_add_u32 m0, s44, 83968
    s_nop 0
    buffer_load_dwordx4 v142, s[12:15], s46 offen lds
    s_add_u32 s46, s46, 15360
    s_add_u32 m0, s44, 68608
    s_nop 0
    buffer_load_dwordx4 v153, s[8:11], s45 offen lds
    s_add_u32 m0, s44, 84992
    s_nop 0
    buffer_load_dwordx4 v142, s[12:15], s46 offen lds
    s_add_u32 s46, s46, 199680
    s_add_u32 s45, s45, 128
    s_waitcnt vmcnt(16)
    s_barrier
    s_add_u32 m0, s44, 98304
    s_nop 0
    buffer_load_dwordx4 v140, s[8:11], s45 offen lds
    s_add_u32 m0, s44, 114688
    s_nop 0
    buffer_load_dwordx4 v142, s[12:15], s46 offen lds
    s_add_u32 s46, s46, 15360
    s_add_u32 m0, s44, 99328
    s_nop 0
    buffer_load_dwordx4 v141, s[8:11], s45 offen lds
    s_add_u32 m0, s44, 115712
    s_nop 0
    buffer_load_dwordx4 v142, s[12:15], s46 offen lds
    s_add_u32 s46, s46, 15360
    s_add_u32 m0, s44, 100352
    s_nop 0
    buffer_load_dwordx4 v152, s[8:11], s45 offen lds
    s_add_u32 m0, s44, 116736
    s_nop 0
    buffer_load_dwordx4 v142, s[12:15], s46 offen lds
    s_add_u32 s46, s46, 15360
    s_add_u32 m0, s44, 101376
    s_nop 0
    buffer_load_dwordx4 v153, s[8:11], s45 offen lds
    s_add_u32 m0, s44, 117760
    s_nop 0
    buffer_load_dwordx4 v142, s[12:15], s46 offen lds
    s_add_u32 s46, s46, 199680
    s_add_u32 s45, s45, 128
    s_waitcnt vmcnt(16)
    s_barrier
    s_add_u32 m0, s44, 0
    s_nop 0
    buffer_load_dwordx4 v140, s[8:11], s45 offen lds
    s_add_u32 m0, s44, 16384
    s_nop 0
    buffer_load_dwordx4 v142, s[12:15], s46 offen lds
    s_add_u32 s46, s46, 15360
    s_add_u32 m0, s44, 1024
    s_nop 0
    buffer_load_dwordx4 v141, s[8:11], s45 offen lds
    s_add_u32 m0, s44, 17408
    s_nop 0
    buffer_load_dwordx4 v142, s[12:15], s46 offen lds
    s_add_u32 s46, s46, 15360
    s_add_u32 m0, s44, 2048
    s_nop 0
    buffer_load_dwordx4 v152, s[8:11], s45 offen lds
    s_add_u32 m0, s44, 18432
    s_nop 0
    buffer_load_dwordx4 v142, s[12:15], s46 offen lds
    s_add_u32 s46, s46, 15360
    s_add_u32 m0, s44, 3072
    s_nop 0
    buffer_load_dwordx4 v153, s[8:11], s45 offen lds
    s_add_u32 m0, s44, 19456
    s_nop 0
    buffer_load_dwordx4 v142, s[12:15], s46 offen lds
    s_add_u32 s46, s46, 199680
    s_add_u32 s45, s45, 128
    s_waitcnt vmcnt(16)
    s_barrier
    s_add_u32 m0, s44, 32768
    s_nop 0
    buffer_load_dwordx4 v140, s[8:11], s45 offen lds
    s_add_u32 m0, s44, 49152
    s_nop 0
    buffer_load_dwordx4 v142, s[12:15], s46 offen lds
    s_add_u32 s46, s46, 15360
    s_add_u32 m0, s44, 33792
    s_nop 0
    buffer_load_dwordx4 v141, s[8:11], s45 offen lds
    s_add_u32 m0, s44, 50176
    s_nop 0
    buffer_load_dwordx4 v142, s[12:15], s46 offen lds
    s_add_u32 s46, s46, 15360
    s_add_u32 m0, s44, 34816
    s_nop 0
    buffer_load_dwordx4 v152, s[8:11], s45 offen lds
    s_add_u32 m0, s44, 51200
    s_nop 0
    buffer_load_dwordx4 v142, s[12:15], s46 offen lds
    s_add_u32 s46, s46, 15360
    s_add_u32 m0, s44, 35840
    s_nop 0
    buffer_load_dwordx4 v153, s[8:11], s45 offen lds
    s_add_u32 m0, s44, 52224
    s_nop 0
    buffer_load_dwordx4 v142, s[12:15], s46 offen lds
    s_add_u32 s46, s46, 199680
    s_add_u32 s45, s45, 128
    s_cmp_eq_u32 s33, 14
    s_cbranch_scc1 H_TYPEB
    s_waitcnt vmcnt(16)
    s_barrier
    s_mov_b32 s12, s52
    s_mov_b32 s13, s53
    s_mov_b32 s14, 2211840
    s_mov_b32 s15, 0x00020000
    v_bfe_u32 v143, v1, 2, 2
    v_mul_u32_u24 v142, 3456, v143
    v_and_b32 v143, 3, v1
    v_lshl_add_u32 v142, v143, 4, v142
    v_lshrrev_b32 v143, 4, v1
    v_lshl_add_u32 v142, v143, 6, v142
    s_mul_i32 s46, s34, 55296
    s_lshl_b32 s36, s33, 8
    s_add_u32 s46, s46, s36
    s_mov_b32 s45, 0
    s_add_u32 m0, s44, 65536
    s_nop 0
    buffer_load_dwordx4 v140, s[8:11], s45 offen lds
    s_add_u32 m0, s44, 81920
    s_nop 0
    buffer_load_dwordx4 v142, s[12:15], s46 offen lds
    s_add_u32 s46, s46, 13824
    s_add_u32 m0, s44, 66560
    s_nop 0
    buffer_load_dwordx4 v141, s[8:11], s45 offen lds
    s_add_u32 m0, s44, 82944
    s_nop 0
    buffer_load_dwordx4 v142, s[12:15], s46 offen lds
    s_add_u32 s46, s46, 13824
    s_add_u32 m0, s44, 67584
    s_nop 0
    buffer_load_dwordx4 v152, s[8:11], s45 offen lds
    s_add_u32 m0, s44, 83968
    s_nop 0
    buffer_load_dwordx4 v142, s[12:15], s46 offen lds
    s_add_u32 s46, s46, 13824
    s_add_u32 m0, s44, 68608
    s_nop 0
    buffer_load_dwordx4 v153, s[8:11], s45 offen lds
    s_add_u32 m0, s44, 84992
    s_nop 0
    buffer_load_dwordx4 v142, s[12:15], s46 offen lds
    s_add_u32 s46, s46, 179712
    s_add_u32 s45, s45, 128
    s_waitcnt vmcnt(16)
    s_barrier
    s_add_u32 m0, s44, 98304
    s_nop 0
    buffer_load_dwordx4 v140, s[8:11], s45 offen lds
    s_add_u32 m0, s44, 114688
    s_nop 0
    buffer_load_dwordx4 v142, s[12:15], s46 offen lds
    s_add_u32 s46, s46, 13824
    s_add_u32 m0, s44, 99328
    s_nop 0
    buffer_load_dwordx4 v141, s[8:11], s45 offen lds
    s_add_u32 m0, s44, 115712
    s_nop 0
    buffer_load_dwordx4 v142, s[12:15], s46 offen lds
    s_add_u32 s46, s46, 13824
    s_add_u32 m0, s44, 100352
    s_nop 0
    buffer_load_dwordx4 v152, s[8:11], s45 offen lds
    s_add_u32 m0, s44, 116736
    s_nop 0
    buffer_load_dwordx4 v142, s[12:15], s46 offen lds
    s_add_u32 s46, s46, 13824
    s_add_u32 m0, s44, 101376
    s_nop 0
    buffer_load_dwordx4 v153, s[8:11], s45 offen lds
    s_add_u32 m0, s44, 117760
    s_nop 0
    buffer_load_dwordx4 v142, s[12:15], s46 offen lds
    s_add_u32 s46, s46, 179712
    s_add_u32 s45, s45, 128
    s_waitcnt vmcnt(16)
    s_barrier
    s_add_u32 m0, s44, 0
    s_nop 0
    buffer_load_dwordx4 v140, s[8:11], s45 offen lds
    s_add_u32 m0, s44, 16384
    s_nop 0
    buffer_load_dwordx4 v142, s[12:15], s46 offen lds
    s_add_u32 s46, s46, 13824
    s_add_u32 m0, s44, 1024
    s_nop 0
    buffer_load_dwordx4 v141, s[8:11], s45 offen lds
    s_add_u32 m0, s44, 17408
    s_nop 0
    buffer_load_dwordx4 v142, s[12:15], s46 offen lds
    s_add_u32 s46, s46, 13824
    s_add_u32 m0, s44, 2048
    s_nop 0
    buffer_load_dwordx4 v152, s[8:11], s45 offen lds
    s_add_u32 m0, s44, 18432
    s_nop 0
    buffer_load_dwordx4 v142, s[12:15], s46 offen lds
    s_add_u32 s46, s46, 13824
    s_add_u32 m0, s44, 3072
    s_nop 0
    buffer_load_dwordx4 v153, s[8:11], s45 offen lds
    s_add_u32 m0, s44, 19456
    s_nop 0
    buffer_load_dwordx4 v142, s[12:15], s46 offen lds
    s_add_u32 s46, s46, 179712
    s_add_u32 s45, s45, 128
    s_barrier
    s_waitcnt vmcnt(16)
    s_barrier
    s_add_u32 m0, s44, 32768
    s_nop 0
    buffer_load_dwordx4 v140, s[8:11], s45 offen lds
    s_add_u32 m0, s44, 49152
    s_nop 0
    buffer_load_dwordx4 v142, s[12:15], s46 offen lds
    s_add_u32 s46, s46, 13824
    s_add_u32 m0, s44, 33792
    s_nop 0
    buffer_load_dwordx4 v141, s[8:11], s45 offen lds
    s_add_u32 m0, s44, 50176
    s_nop 0
    buffer_load_dwordx4 v142, s[12:15], s46 offen lds
    s_add_u32 s46, s46, 13824
    s_add_u32 m0, s44, 34816
    s_nop 0
    buffer_load_dwordx4 v152, s[8:11], s45 offen lds
    s_add_u32 m0, s44, 51200
    s_nop 0
    buffer_load_dwordx4 v142, s[12:15], s46 offen lds
    s_add_u32 s46, s46, 13824
    s_add_u32 m0, s44, 35840
    s_nop 0
    buffer_load_dwordx4 v153, s[8:11], s45 offen lds
    s_add_u32 m0, s44, 52224
    s_nop 0
    buffer_load_dwordx4 v142, s[12:15], s46 offen lds
    s_add_u32 s46, s46, 179712
    s_add_u32 s45, s45, 128
    s_waitcnt vmcnt(16)
    s_barrier
    s_add_u32 m0, s44, 65536
    s_nop 0
    buffer_load_dwordx4 v140, s[8:11], s45 offen lds
    s_add_u32 m0, s44, 81920
    s_nop 0
    buffer_load_dwordx4 v142, s[12:15], s46 offen lds
    s_add_u32 s46, s46, 13824
    s_add_u32 m0, s44, 66560
    s_nop 0
    buffer_load_dwordx4 v141, s[8:11], s45 offen lds
    s_add_u32 m0, s44, 82944
    s_nop 0
    buffer_load_dwordx4 v142, s[12:15], s46 offen lds
    s_add_u32 s46, s46, 13824
    s_add_u32 m0, s44, 67584
    s_nop 0
    buffer_load_dwordx4 v152, s[8:11], s45 offen lds
    s_add_u32 m0, s44, 83968
    s_nop 0
    buffer_load_dwordx4 v142, s[12:15], s46 offen lds
    s_add_u32 s46, s46, 13824
    s_add_u32 m0, s44, 68608
    s_nop 0
    buffer_load_dwordx4 v153, s[8:11], s45 offen lds
    s_add_u32 m0, s44, 84992
    s_nop 0
    buffer_load_dwordx4 v142, s[12:15], s46 offen lds
    s_add_u32 s46, s46, 179712
    s_add_u32 s45, s45, 128
    s_waitcnt vmcnt(16)
    s_barrier
    s_add_u32 m0, s44, 98304
    s_nop 0
    buffer_load_dwordx4 v140, s[8:11], s45 offen lds
    s_add_u32 m0, s44, 114688
    s_nop 0
    buffer_load_dwordx4 v142, s[12:15], s46 offen lds
    s_add_u32 s46, s46, 13824
    s_add_u32 m0, s44, 99328
    s_nop 0
    buffer_load_dwordx4 v141, s[8:11], s45 offen lds
    s_add_u32 m0, s44, 115712
    s_nop 0
    buffer_load_dwordx4 v142, s[12:15], s46 offen lds
    s_add_u32 s46, s46, 13824
    s_add_u32 m0, s44, 100352
    s_nop 0
    buffer_load_dwordx4 v152, s[8:11], s45 offen lds
    s_add_u32 m0, s44, 116736
    s_nop 0
    buffer_load_dwordx4 v142, s[12:15], s46 offen lds
    s_add_u32 s46, s46, 13824
    s_add_u32 m0, s44, 101376
    s_nop 0
    buffer_load_dwordx4 v153, s[8:11], s45 offen lds
    s_add_u32 m0, s44, 117760
    s_nop 0
    buffer_load_dwordx4 v142, s[12:15], s46 offen lds
    s_add_u32 s46, s46, 179712
    s_add_u32 s45, s45, 128
    s_waitcnt vmcnt(16)
    s_barrier
    s_add_u32 m0, s44, 0
    s_nop 0
    buffer_load_dwordx4 v140, s[8:11], s45 offen lds
    s_add_u32 m0, s44, 16384
    s_nop 0
    buffer_load_dwordx4 v142, s[12:15], s46 offen lds
    s_add_u32 s46, s46, 13824
    s_add_u32 m0, s44, 1024
    s_nop 0
    buffer_load_dwordx4 v141, s[8:11], s45 offen lds
    s_add_u32 m0, s44, 17408
    s_nop 0
    buffer_load_dwordx4 v142, s[12:15], s46 offen lds
    s_add_u32 s46, s46, 13824
    s_add_u32 m0, s44, 2048
    s_nop 0
    buffer_load_dwordx4 v152, s[8:11], s45 offen lds
    s_add_u32 m0, s44, 18432
    s_nop 0
    buffer_load_dwordx4 v142, s[12:15], s46 offen lds
    s_add_u32 s46, s46, 13824
    s_add_u32 m0, s44, 3072
    s_nop 0
    buffer_load_dwordx4 v153, s[8:11], s45 offen lds
    s_add_u32 m0, s44, 19456
    s_nop 0
    buffer_load_dwordx4 v142, s[12:15], s46 offen lds
    s_add_u32 s46, s46, 179712
    s_add_u32 s45, s45, 128
    s_waitcnt vmcnt(16)
    s_barrier
    s_add_u32 m0, s44, 32768
    s_nop 0
    buffer_load_dwordx4 v140, s[8:11], s45 offen lds
    s_add_u32 m0, s44, 49152
    s_nop 0
    buffer_load_dwordx4 v142, s[12:15], s46 offen lds
    s_add_u32 s46, s46, 13824
    s_add_u32 m0, s44, 33792
    s_nop 0
    buffer_load_dwordx4 v141, s[8:11], s45 offen lds
    s_add_u32 m0, s44, 50176
    s_nop 0
    buffer_load_dwordx4 v142, s[12:15], s46 offen lds
    s_add_u32 s46, s46, 13824
    s_add_u32 m0, s44, 34816
    s_nop 0
    buffer_load_dwordx4 v152, s[8:11], s45 offen lds
    s_add_u32 m0, s44, 51200
    s_nop 0
    buffer_load_dwordx4 v142, s[12:15], s46 offen lds
    s_add_u32 s46, s46, 13824
    s_add_u32 m0, s44, 35840
    s_nop 0
    buffer_load_dwordx4 v153, s[8:11], s45 offen lds
    s_add_u32 m0, s44, 52224
    s_nop 0
    buffer_load_dwordx4 v142, s[12:15], s46 offen lds
    s_add_u32 s46, s46, 179712
    s_add_u32 s45, s45, 128
    s_waitcnt vmcnt(16)
    s_barrier
    s_add_u32 m0, s44, 65536
    s_nop 0
    buffer_load_dwordx4 v140, s[8:11], s45 offen lds
    s_add_u32 m0, s44, 81920
    s_nop 0
    buffer_load_dwordx4 v142, s[12:15], s46 offen lds
    s_add_u32 s46, s46, 13824
    s_add_u32 m0, s44, 66560
    s_nop 0
    buffer_load_dwordx4 v141, s[8:11], s45 offen lds
    s_add_u32 m0, s44, 82944
    s_nop 0
    buffer_load_dwordx4 v142, s[12:15], s46 offen lds
    s_add_u32 s46, s46, 13824
    s_add_u32 m0, s44, 67584
    s_nop 0
    buffer_load_dwordx4 v152, s[8:11], s45 offen lds
    s_add_u32 m0, s44, 83968
    s_nop 0
    buffer_load_dwordx4 v142, s[12:15], s46 offen lds
    s_add_u32 s46, s46, 13824
    s_add_u32 m0, s44, 68608
    s_nop 0
    buffer_load_dwordx4 v153, s[8:11], s45 offen lds
    s_add_u32 m0, s44, 84992
    s_nop 0
    buffer_load_dwordx4 v142, s[12:15], s46 offen lds
    s_add_u32 s46, s46, 179712
    s_add_u32 s45, s45, 128
    s_waitcnt vmcnt(16)
    s_barrier
    s_add_u32 m0, s44, 98304
    s_nop 0
    buffer_load_dwordx4 v140, s[8:11], s45 offen lds
    s_add_u32 m0, s44, 114688
    s_nop 0
    buffer_load_dwordx4 v142, s[12:15], s46 offen lds
    s_add_u32 s46, s46, 13824
    s_add_u32 m0, s44, 99328
    s_nop 0
    buffer_load_dwordx4 v141, s[8:11], s45 offen lds
    s_add_u32 m0, s44, 115712
    s_nop 0
    buffer_load_dwordx4 v142, s[12:15], s46 offen lds
    s_add_u32 s46, s46, 13824
    s_add_u32 m0, s44, 100352
    s_nop 0
    buffer_load_dwordx4 v152, s[8:11], s45 offen lds
    s_add_u32 m0, s44, 116736
    s_nop 0
    buffer_load_dwordx4 v142, s[12:15], s46 offen lds
    s_add_u32 s46, s46, 13824
    s_add_u32 m0, s44, 101376
    s_nop 0
    buffer_load_dwordx4 v153, s[8:11], s45 offen lds
    s_add_u32 m0, s44, 117760
    s_nop 0
    buffer_load_dwordx4 v142, s[12:15], s46 offen lds
    s_add_u32 s46, s46, 179712
    s_add_u32 s45, s45, 128
    s_waitcnt vmcnt(16)
    s_barrier
    s_waitcnt vmcnt(8)
    s_barrier
    s_waitcnt vmcnt(0)
    s_barrier
H_TAIL:
    s_setprio 1
    s_sub_u32 s39, s3, 4
    v_and_b32 v30, 31, v1
    v_lshrrev_b32 v29, 5, v1
    v_lshlrev_b32 v2, 4, v1
    s_lshr_b32 s34, s39, 2
    s_and_b32 s35, s39, 3
    s_lshl_b32 s40, s34, 5
    s_add_u32 s40, s40, s35
    s_mul_i32 s40, s40, 2560
    s_mul_i32 s41, s80, 163840
    s_add_u32 s40, s40, s41
    s_add_u32 s40, s40, 2621440
    s_mul_i32 s41, s39, 2592
    s_mov_b32 s46, 0x000fffff
    s_mov_b32 s47, 0x000fffff
    v_lshlrev_b32 v3, 3, v30
    v_lshl_add_u32 v3, v29, 8, v3
    s_lshl_b32 s36, s81, 3
    s_lshl_b32 s37, s35, 1
    s_add_u32 s36, s36, s37
    s_add_u32 s48, s36, s34
    s_xor_b32 s49, s48, 1
    s_mul_i32 s38, s80, 1280
    s_cmp_lg_u32 s39, 0
    s_cbranch_scc1 AT_WAITQ
    v_mov_b32 v24, 159336
    ds_read_b32 v25, v24
    s_waitcnt lgkmcnt(0)
    v_cmp_ne_u32 vcc, 0, v25
    s_nop 1
    s_cbranch_vccnz AT_GO
    v_and_b32 v24, 15, v1
    v_lshlrev_b32 v24, 8, v24
    v_add_u32 v24, 20893696, v24
    v_mov_b32 v25, 15
POLL1:
    buffer_load_dword v26, v24, s[16:19], 0 offen sc1
    s_waitcnt vmcnt(0)
    v_cmp_gt_u32 vcc, v25, v26
    s_nop 1
    s_cbranch_vccz POLL1_OK
    s_add_u32 s101, s101, 1
    s_cmp_gt_u32 s101, 0x40000
    s_cbranch_scc1 K_END
    s_sleep 4
    s_branch POLL1
POLL1_OK:
    v_mov_b32 v24, 159336
    v_mov_b32 v25, 1
    s_mov_b64 exec, 1
    ds_add_u32 v24, v25
    s_mov_b64 exec, -1
    s_branch AT_GO
AT_WAITQ:
    v_mov_b32 v24, 159336
LW2:
    ds_read_b32 v25, v24
    s_waitcnt lgkmcnt(0)
    v_cmp_gt_u32 vcc, 1, v25
    s_nop 1
    s_cbranch_vccz LW2_OK
    s_add_u32 s101, s101, 1
    s_cmp_gt_u32 s101, 0x40000
    s_cbranch_scc1 K_END
    s_sleep 2
    s_branch LW2
LW2_OK:
AT_GO:
    s_add_u32 m0, s41, 0
    s_mov_b64 exec, 0xffffffff
    buffer_load_dwordx4 v2, s[16:19], s40 offen offset:2048 sc1 lds
    s_mov_b64 exec, -1
    buffer_load_dwordx4 v2, s[16:19], s40 offen sc1 lds
    buffer_load_dwordx4 v2, s[16:19], s40 offen offset:1024 sc1 lds
    s_add_u32 s40, s40, 10240
    s_mul_i32 s37, s48, 40960
    s_add_u32 s37, s37, s38
    buffer_load_dwordx2 v[4:5], v3, s[16:19], s37 offen offset:0 sc1
    buffer_load_dwordx2 v[6:7], v3, s[16:19], s37 offen offset:512 sc1
    buffer_load_dwordx2 v[8:9], v3, s[16:19], s37 offen offset:1024 sc1
    s_mul_i32 s37, s49, 40960
    s_add_u32 s37, s37, s38
    buffer_load_dwordx2 v[10:11], v3, s[16:19], s37 offen offset:0 sc1
    buffer_load_dwordx2 v[12:13], v3, s[16:19], s37 offen offset:512 sc1
    buffer_load_dwordx2 v[14:15], v3, s[16:19], s37 offen offset:1024 sc1
    s_add_u32 m0, s41, 20736
    s_mov_b64 exec, 0xffffffff
    buffer_load_dwordx4 v2, s[16:19], s40 offen offset:2048 sc1 lds
    s_mov_b64 exec, -1
    buffer_load_dwordx4 v2, s[16:19], s40 offen sc1 lds
    buffer_load_dwordx4 v2, s[16:19], s40 offen offset:1024 sc1 lds
    s_add_u32 s40, s40, 10240
    s_add_u32 m0, s41, 41472
    s_mov_b64 exec, 0xffffffff
    buffer_load_dwordx4 v2, s[16:19], s40 offen offset:2048 sc1 lds
    s_mov_b64 exec, -1
    buffer_load_dwordx4 v2, s[16:19], s40 offen sc1 lds
    buffer_load_dwordx4 v2, s[16:19], s40 offen offset:1024 sc1 lds
    s_add_u32 s40, s40, 10240
    v_mul_u32_u24 v31, 320, v29
    v_lshl_add_u32 v31, v30, 4, v31
    v_add_u32 v31, 1280, v31
    v_mov_b32 v16, v3
    v_mov_b32 v17, 2560
    v_mov_b32 v18, 2576
    v_mov_b32 v19, 2576
    s_mov_b32 exec_lo, 0x11000000
    s_mov_b32 exec_hi, 0x11000000
    v_mov_b32 v18, 2560
    v_mov_b32 v19, 2560
    s_mov_b64 exec, s[46:47]
    v_mov_b32 v18, v31
    v_add_u32 v19, 640, v31
    s_mov_b64 exec, 0xffffffff
    v_add_u32 v17, 1024, v3
    s_mov_b64 exec, -1
    s_lshl_b32 s36, s39, 2
    s_add_u32 s36, s36, 159232
    v_mov_b32 v26, s36
    v_and_b32 v27, 7, v1
    v_lshlrev_b32 v27, 2, v27
    v_add_u32 v27, 159232, v27
    v_mov_b32 v28, 1
    s_lshl_b32 s36, s35, 2
    s_add_u32 s36, s36, 159280
    v_mov_b32 v132, s36
    s_lshl_b32 s45, s34, 1
    s_sub_u32 s45, 1, s45
    v_mov_b32 v133, s45
    v_mov_b32 v52, 0x3f803f80
    v_mov_b32 v53, 0x3f803f80
    v_mov_b32 v54, 0x3f803f80
    v_mov_b32 v55, 0x3f803f80
    v_mov_b32 v56, 0x3f803f80
    v_mov_b32 v57, 0x3f803f80
    v_mov_b32 v58, 0x3f803f80
    v_mov_b32 v59, 0x3f803f80
    v_mov_b32 v60, 0x3f803f80
    v_mov_b32 v61, 0x3f803f80
    v_mov_b32 v62, 0x3f803f80
    v_mov_b32 v63, 0x3f803f80
    v_mov_b32 v64, 0x3f803f80
    v_mov_b32 v65, 0x3f803f80
    v_mov_b32 v66, 0x3f803f80
    v_mov_b32 v67, 0x3f803f80
    v_and_b32 v24, 3, v1
    v_mul_u32_u24 v24, 20736, v24
    v_add_u32 v24, s41, v24
    ds_write_b128 v24, v[52:55] offset:2560
    v_mov_b32 v100, 0
    v_mov_b32 v101, 0
    v_mov_b32 v102, 0
    v_mov_b32 v103, 0
    v_mov_b32 v104, 0
    v_mov_b32 v105, 0
    v_mov_b32 v106, 0
    v_mov_b32 v107, 0
    v_mov_b32 v108, 0
    v_mov_b32 v109, 0
    v_mov_b32 v110, 0
    v_mov_b32 v111, 0
    v_mov_b32 v112, 0
    v_mov_b32 v113, 0
    v_mov_b32 v114, 0
    v_mov_b32 v115, 0
    v_mov_b32 v116, 0
    v_mov_b32 v117, 0
    v_mov_b32 v118, 0
    v_mov_b32 v119, 0
    v_mov_b32 v120, 0
    v_mov_b32 v121, 0
    v_mov_b32 v122, 0
    v_mov_b32 v123, 0
    v_mov_b32 v124, 0
    v_mov_b32 v125, 0
    v_mov_b32 v126, 0
    v_mov_b32 v127, 0
    v_mov_b32 v128, 0
    v_mov_b32 v129, 0
    v_mov_b32 v130, 0
    v_mov_b32 v131, 0
    ds_write_b128 v24, v[100:103] offset:2576
    v_mov_b32 v32, 0
    v_mov_b32 v33, 0
    v_mov_b32 v34, 0
    v_mov_b32 v35, 0
    v_mov_b32 v36, 0
    v_mov_b32 v37, 0
    v_mov_b32 v38, 0
    v_mov_b32 v39, 0
    s_waitcnt vmcnt(6) lgkmcnt(0)
    ds_write_b32 v26, v28
    s_mov_b32 s43, 1
AT_W0:
    s_add_u32 s101, s101, 1
    s_cmp_gt_u32 s101, 0x40000
    s_cbranch_scc1 K_END
    ds_read_b32 v24, v27
    s_waitcnt lgkmcnt(0)
    v_cmp_gt_u32 vcc, s43, v24
    s_nop 1
    s_cbranch_vccnz AT_W0
    ds_read_b64 v[46:47], v16
    ds_read_b64 v[48:49], v16 offset:512
    ds_read_b64 v[50:51], v17
    s_mul_i32 s36, s34, 10368
    v_add_u32 v16, s36, v16
    v_add_u32 v17, s36, v17
    v_add_u32 v18, s36, v18
    v_add_u32 v19, s36, v19
    v_mov_b32 v136, v16
    v_mov_b32 v137, v17
    v_mov_b32 v138, v18
    v_mov_b32 v139, v19
    v_add_u32 v20, 20736, v16
    v_add_u32 v21, 20736, v17
    ds_read_b64 v[40:41], v16 offset:0
    ds_read_b64 v[42:43], v16 offset:512
    ds_read_b64 v[44:45], v17 offset:0
    s_mov_b32 exec_lo, 0
    v_mov_b32 v8, 0
    v_mov_b32 v9, 0
    v_mov_b32 v14, 0
    v_mov_b32 v15, 0
    s_mov_b64 exec, -1
    s_waitcnt lgkmcnt(3)
    v_mfma_f32_32x32x16_bf16 v[68:83], v[46:49], v[4:7], 0
    v_mfma_f32_32x32x8_bf16 v[68:83], v[50:51], v[8:9], v[68:83]
    v_mfma_f32_32x32x16_bf16 v[84:99], v[46:49], v[10:13], 0
    v_mfma_f32_32x32x8_bf16 v[84:99], v[50:51], v[14:15], v[84:99]
    ds_read_b64 v[46:47], v16 offset:2592
    ds_read_b64 v[48:49], v16 offset:3104
    ds_read_b64 v[50:51], v17 offset:2592
    s_nop 10
    v_max3_f32 v24, v68, v69, v70
    v_max3_f32 v24, v24, v71, v72
    v_max3_f32 v24, v24, v73, v74
    v_max3_f32 v24, v24, v75, v76
    v_max3_f32 v24, v24, v77, v78
    v_max3_f32 v24, v24, v79, v80
    v_max3_f32 v24, v24, v81, v82
    v_max_f32 v24, v24, v83
    v_mov_b32 v25, v24
    s_nop 1
    v_permlane32_swap_b32 v24, v25
    v_max_f32 v24, v24, v25
    v_max3_f32 v32, v84, v85, v86
    v_max3_f32 v32, v32, v87, v88
    v_max3_f32 v32, v32, v89, v90
    v_max3_f32 v32, v32, v91, v92
    v_max3_f32 v32, v32, v93, v94
    v_max3_f32 v32, v32, v95, v96
    v_max3_f32 v32, v32, v97, v98
    v_max_f32 v32, v32, v99
    v_mov_b32 v33, v32
    s_nop 1
    v_permlane32_swap_b32 v32, v33
    v_max_f32 v32, v32, v33
    s_mov_b32 exec_lo, 0
    v_cvt_pk_bf16_f32 v8, -v24, 0
    v_cvt_pk_bf16_f32 v14, -v32, 0
    s_mov_b64 exec, -1
    v_mov_b32 v32, 0
    v_mov_b32 v33, 0
    v_mov_b32 v96, 0
    v_mov_b32 v97, 0
    v_mov_b32 v98, 0
    v_mov_b32 v99, 0
    s_waitcnt lgkmcnt(0)
    v_mfma_f32_32x32x16_bf16 v[68:83], v[40:43], v[4:7], 0
    v_mfma_f32_32x32x8_bf16 v[68:83], v[44:45], v[8:9], v[68:83]
    s_mov_b32 s43, 2
    s_mov_b32 s44, 20736
    s_mov_b32 s42, 62208
    v_mov_b32 v28, 2
    s_waitcnt vmcnt(3)
    ds_write_b32 v26, v28
    s_nop 4
.p2align 6
AT_LOOP:
    v_mfma_f32_32x32x16_bf16 v[116:131], v[60:63], v[32:35], v[116:131]
    ds_read_b128 v[52:55], v18 offset:0
    ds_read_b128 v[56:59], v19 offset:0
    v_exp_f32 v68, v68
    v_exp_f32 v69, v69
    v_cvt_pk_bf16_f32 v38, v96, v97
    v_exp_f32 v70, v70
    v_cvt_pk_bf16_f32 v39, v98, v99
    v_exp_f32 v71, v71
    v_mfma_f32_32x32x16_bf16 v[84:99], v[40:43], v[10:13], 0
    v_exp_f32 v72, v72
    v_exp_f32 v73, v73
    v_cvt_pk_bf16_f32 v32, v68, v69
    v_exp_f32 v74, v74
    v_cvt_pk_bf16_f32 v33, v70, v71
    v_exp_f32 v75, v75
    v_mfma_f32_32x32x8_bf16 v[84:99], v[44:45], v[14:15], v[84:99]
    v_exp_f32 v76, v76
    v_exp_f32 v77, v77
    v_cvt_pk_bf16_f32 v34, v72, v73
    v_exp_f32 v78, v78
    v_cvt_pk_bf16_f32 v35, v74, v75
    v_exp_f32 v79, v79
    v_mfma_f32_32x32x16_bf16 v[116:131], v[64:67], v[36:39], v[116:131]
    s_waitcnt lgkmcnt(0)
    v_exp_f32 v80, v80
    v_exp_f32 v81, v81
    v_cvt_pk_bf16_f32 v36, v76, v77
    v_exp_f32 v82, v82
    v_cvt_pk_bf16_f32 v37, v78, v79
    v_exp_f32 v83, v83
    v_mfma_f32_32x32x16_bf16 v[100:115], v[52:55], v[32:35], v[100:115]
    ds_read_b64 v[40:41], v16 offset:5184
    ds_read_b64 v[42:43], v16 offset:5696
    ds_read_b64 v[44:45], v17 offset:5184
    v_exp_f32 v84, v84
    v_exp_f32 v85, v85
    v_cvt_pk_bf16_f32 v38, v80, v81
    v_exp_f32 v86, v86
    v_cvt_pk_bf16_f32 v39, v82, v83
    v_exp_f32 v87, v87
    v_mfma_f32_32x32x16_bf16 v[68:83], v[46:49], v[4:7], 0
    v_exp_f32 v88, v88
    v_exp_f32 v89, v89
    v_cvt_pk_bf16_f32 v32, v84, v85
    v_exp_f32 v90, v90
    v_cvt_pk_bf16_f32 v33, v86, v87
    v_exp_f32 v91, v91
    v_mfma_f32_32x32x8_bf16 v[68:83], v[50:51], v[8:9], v[68:83]
    v_exp_f32 v92, v92
    v_exp_f32 v93, v93
    v_cvt_pk_bf16_f32 v34, v88, v89
    v_exp_f32 v94, v94
    v_cvt_pk_bf16_f32 v35, v90, v91
    v_exp_f32 v95, v95
    v_mfma_f32_32x32x16_bf16 v[100:115], v[56:59], v[36:39], v[100:115]
    s_waitcnt lgkmcnt(0)
    v_exp_f32 v96, v96
    v_exp_f32 v97, v97
    v_cvt_pk_bf16_f32 v36, v92, v93
    v_exp_f32 v98, v98
    v_cvt_pk_bf16_f32 v37, v94, v95
    v_exp_f32 v99, v99
    v_mfma_f32_32x32x16_bf16 v[116:131], v[52:55], v[32:35], v[116:131]
    ds_read_b128 v[60:63], v18 offset:2592
    ds_read_b128 v[64:67], v19 offset:2592
    v_exp_f32 v68, v68
    v_exp_f32 v69, v69
    v_cvt_pk_bf16_f32 v38, v96, v97
    v_exp_f32 v70, v70
    v_cvt_pk_bf16_f32 v39, v98, v99
    v_exp_f32 v71, v71
    v_mfma_f32_32x32x16_bf16 v[84:99], v[46:49], v[10:13], 0
    v_exp_f32 v72, v72
    v_exp_f32 v73, v73
    v_cvt_pk_bf16_f32 v32, v68, v69
    v_exp_f32 v74, v74
    v_cvt_pk_bf16_f32 v33, v70, v71
    v_exp_f32 v75, v75
    v_mfma_f32_32x32x8_bf16 v[84:99], v[50:51], v[14:15], v[84:99]
    v_exp_f32 v76, v76
    v_exp_f32 v77, v77
    v_cvt_pk_bf16_f32 v34, v72, v73
    v_exp_f32 v78, v78
    v_cvt_pk_bf16_f32 v35, v74, v75
    v_exp_f32 v79, v79
    v_mfma_f32_32x32x16_bf16 v[116:131], v[56:59], v[36:39], v[116:131]
    s_waitcnt lgkmcnt(0)
    v_exp_f32 v80, v80
    v_exp_f32 v81, v81
    v_cvt_pk_bf16_f32 v36, v76, v77
    v_exp_f32 v82, v82
    v_cvt_pk_bf16_f32 v37, v78, v79
    v_exp_f32 v83, v83
    v_mfma_f32_32x32x16_bf16 v[100:115], v[60:63], v[32:35], v[100:115]
    ds_read_b64 v[46:47], v16 offset:7776
    ds_read_b64 v[48:49], v16 offset:8288
    ds_read_b64 v[50:51], v17 offset:7776
    v_exp_f32 v84, v84
    v_exp_f32 v85, v85
    v_cvt_pk_bf16_f32 v38, v80, v81
    v_exp_f32 v86, v86
    v_cvt_pk_bf16_f32 v39, v82, v83
    v_exp_f32 v87, v87
    v_mfma_f32_32x32x16_bf16 v[68:83], v[40:43], v[4:7], 0
    v_exp_f32 v88, v88
    v_exp_f32 v89, v89
    v_cvt_pk_bf16_f32 v32, v84, v85
    v_exp_f32 v90, v90
    v_cvt_pk_bf16_f32 v33, v86, v87
    v_exp_f32 v91, v91
    v_mfma_f32_32x32x8_bf16 v[68:83], v[44:45], v[8:9], v[68:83]
    v_exp_f32 v92, v92
    v_exp_f32 v93, v93
    v_cvt_pk_bf16_f32 v34, v88, v89
    v_exp_f32 v94, v94
    v_cvt_pk_bf16_f32 v35, v90, v91
    v_exp_f32 v95, v95
    v_mfma_f32_32x32x16_bf16 v[100:115], v[64:67], v[36:39], v[100:115]
    s_waitcnt lgkmcnt(0)
    v_exp_f32 v96, v96
    v_exp_f32 v97, v97
    v_cvt_pk_bf16_f32 v36, v92, v93
    v_exp_f32 v98, v98
    v_cvt_pk_bf16_f32 v37, v94, v95
    v_exp_f32 v99, v99
    v_mfma_f32_32x32x16_bf16 v[116:131], v[60:63], v[32:35], v[116:131]
    ds_read_b128 v[52:55], v18 offset:5184
    ds_read_b128 v[56:59], v19 offset:5184
    ds_read_b32 v24, v27
    v_exp_f32 v68, v68
    v_exp_f32 v69, v69
    v_cvt_pk_bf16_f32 v38, v96, v97
    v_exp_f32 v70, v70
    v_cvt_pk_bf16_f32 v39, v98, v99
    v_exp_f32 v71, v71
    v_mfma_f32_32x32x16_bf16 v[84:99], v[40:43], v[10:13], 0
    v_exp_f32 v72, v72
    v_exp_f32 v73, v73
    v_cvt_pk_bf16_f32 v32, v68, v69
    v_exp_f32 v74, v74
    v_cvt_pk_bf16_f32 v33, v70, v71
    v_exp_f32 v75, v75
    v_mfma_f32_32x32x8_bf16 v[84:99], v[44:45], v[14:15], v[84:99]
    v_exp_f32 v76, v76
    v_exp_f32 v77, v77
    v_cvt_pk_bf16_f32 v34, v72, v73
    v_exp_f32 v78, v78
    v_cvt_pk_bf16_f32 v35, v74, v75
    v_exp_f32 v79, v79
    v_mfma_f32_32x32x16_bf16 v[116:131], v[64:67], v[36:39], v[116:131]
    s_waitcnt lgkmcnt(0)
    v_cmp_gt_u32 vcc, s43, v24
    v_exp_f32 v80, v80
    s_cbranch_vccnz AT_SPIN
AT_SPUN:
    s_add_u32 s36, s41, s42
    s_cmp_le_u32 s43, 6
    s_cselect_b32 m0, s36, 82944
    s_cselect_b32 s37, s40, 21975040
    s_mov_b64 exec, 0xffffffff
    buffer_load_dwordx4 v2, s[16:19], s37 offen offset:2048 sc1 lds
    s_mov_b64 exec, -1
    buffer_load_dwordx4 v2, s[16:19], s37 offen sc1 lds
    buffer_load_dwordx4 v2, s[16:19], s37 offen offset:1024 sc1 lds
    s_add_u32 s40, s40, 10240
    s_add_u32 s42, s42, 20736
    s_cmp_eq_u32 s42, 82944
    s_cselect_b32 s42, 0, s42
    v_exp_f32 v81, v81
    v_cvt_pk_bf16_f32 v36, v76, v77
    v_exp_f32 v82, v82
    v_cvt_pk_bf16_f32 v37, v78, v79
    v_exp_f32 v83, v83
    v_mfma_f32_32x32x16_bf16 v[100:115], v[52:55], v[32:35], v[100:115]
    ds_read_b64 v[40:41], v20 offset:0
    ds_read_b64 v[42:43], v20 offset:512
    ds_read_b64 v[44:45], v21 offset:0
    v_exp_f32 v84, v84
    v_exp_f32 v85, v85
    v_cvt_pk_bf16_f32 v38, v80, v81
    v_exp_f32 v86, v86
    v_cvt_pk_bf16_f32 v39, v82, v83
    v_exp_f32 v87, v87
    v_mfma_f32_32x32x16_bf16 v[68:83], v[46:49], v[4:7], 0
    v_exp_f32 v88, v88
    v_exp_f32 v89, v89
    v_cvt_pk_bf16_f32 v32, v84, v85
    v_exp_f32 v90, v90
    v_cvt_pk_bf16_f32 v33, v86, v87
    v_exp_f32 v91, v91
    v_mfma_f32_32x32x8_bf16 v[68:83], v[50:51], v[8:9], v[68:83]
    v_exp_f32 v92, v92
    v_exp_f32 v93, v93
    v_cvt_pk_bf16_f32 v34, v88, v89
    v_exp_f32 v94, v94
    v_cvt_pk_bf16_f32 v35, v90, v91
    v_exp_f32 v95, v95
    v_mfma_f32_32x32x16_bf16 v[100:115], v[56:59], v[36:39], v[100:115]
    s_waitcnt lgkmcnt(0)
    v_exp_f32 v96, v96
    v_exp_f32 v97, v97
    v_cvt_pk_bf16_f32 v36, v92, v93
    v_exp_f32 v98, v98
    v_cvt_pk_bf16_f32 v37, v94, v95
    v_exp_f32 v99, v99
    v_mfma_f32_32x32x16_bf16 v[116:131], v[52:55], v[32:35], v[116:131]
    ds_read_b128 v[60:63], v18 offset:7776
    ds_read_b128 v[64:67], v19 offset:7776
    v_exp_f32 v68, v68
    v_exp_f32 v69, v69
    v_cvt_pk_bf16_f32 v38, v96, v97
    v_exp_f32 v70, v70
    v_cvt_pk_bf16_f32 v39, v98, v99
    v_exp_f32 v71, v71
    v_mfma_f32_32x32x16_bf16 v[84:99], v[46:49], v[10:13], 0
    v_exp_f32 v72, v72
    v_exp_f32 v73, v73
    v_cvt_pk_bf16_f32 v32, v68, v69
    v_exp_f32 v74, v74
    v_cvt_pk_bf16_f32 v33, v70, v71
    v_exp_f32 v75, v75
    v_mfma_f32_32x32x8_bf16 v[84:99], v[50:51], v[14:15], v[84:99]
    v_exp_f32 v76, v76
    v_exp_f32 v77, v77
    v_cvt_pk_bf16_f32 v34, v72, v73
    v_exp_f32 v78, v78
    v_cvt_pk_bf16_f32 v35, v74, v75
    v_exp_f32 v79, v79
    v_mfma_f32_32x32x16_bf16 v[116:131], v[56:59], v[36:39], v[116:131]
    s_waitcnt lgkmcnt(0)
    s_add_u32 s43, s43, 1
    v_add_u32 v28, 1, v28
    v_exp_f32 v80, v80
    v_exp_f32 v81, v81
    v_cvt_pk_bf16_f32 v36, v76, v77
    v_exp_f32 v82, v82
    v_cvt_pk_bf16_f32 v37, v78, v79
    v_exp_f32 v83, v83
    v_mfma_f32_32x32x16_bf16 v[100:115], v[60:63], v[32:35], v[100:115]
    ds_read_b64 v[46:47], v20 offset:2592
    ds_read_b64 v[48:49], v20 offset:3104
    ds_read_b64 v[50:51], v21 offset:2592
    s_mov_b64 exec, 1
    ds_add_rtn_u32 v134, v132, v133
    s_mov_b64 exec, -1
    v_exp_f32 v84, v84
    v_exp_f32 v85, v85
    v_cvt_pk_bf16_f32 v38, v80, v81
    v_exp_f32 v86, v86
    v_cvt_pk_bf16_f32 v39, v82, v83
    v_exp_f32 v87, v87
    v_mfma_f32_32x32x16_bf16 v[68:83], v[40:43], v[4:7], 0
    s_waitcnt vmcnt(3)
    ds_write_b32 v26, v28
    s_add_u32 s36, s44, 20736
    s_cmp_eq_u32 s36, 82944
    s_cselect_b32 s36, 0, s36
    v_exp_f32 v88, v88
    v_exp_f32 v89, v89
    v_cvt_pk_bf16_f32 v32, v84, v85
    v_exp_f32 v90, v90
    v_cvt_pk_bf16_f32 v33, v86, v87
    v_exp_f32 v91, v91
    v_mfma_f32_32x32x8_bf16 v[68:83], v[44:45], v[8:9], v[68:83]
    v_add_u32 v16, s44, v136
    v_add_u32 v17, s44, v137
    v_add_u32 v18, s44, v138
    v_add_u32 v19, s44, v139
    v_add_u32 v20, s36, v136
    v_add_u32 v21, s36, v137
    s_mov_b32 s44, s36
    v_exp_f32 v92, v92
    v_exp_f32 v93, v93
    v_cvt_pk_bf16_f32 v34, v88, v89
    v_exp_f32 v94, v94
    v_cvt_pk_bf16_f32 v35, v90, v91
    v_exp_f32 v95, v95
    v_mfma_f32_32x32x16_bf16 v[100:115], v[64:67], v[36:39], v[100:115]
    s_waitcnt lgkmcnt(0)
    v_readfirstlane_b32 s36, v134
    s_setprio 1
    s_mul_i32 s36, s36, s45
    s_cmp_ge_i32 s36, 0
    s_cbranch_scc1 AT_BAL7
    s_setprio 2
AT_BAL7:
    s_cmp_le_u32 s43, 9
    v_exp_f32 v96, v96
    v_exp_f32 v97, v97
    v_cvt_pk_bf16_f32 v36, v92, v93
    v_exp_f32 v98, v98
    v_cvt_pk_bf16_f32 v37, v94, v95
    v_exp_f32 v99, v99
    s_cbranch_scc1 AT_LOOP
    v_mfma_f32_32x32x16_bf16 v[116:131], v[60:63], v[32:35], v[116:131]
    v_cvt_pk_bf16_f32 v38, v96, v97
    v_cvt_pk_bf16_f32 v39, v98, v99
    v_mov_b32 v28, 100
    s_lshl_b32 s36, s39, 12
    v_mfma_f32_32x32x16_bf16 v[116:131], v[64:67], v[36:39], v[116:131]
    v_add_u32 v25, s36, v2
    s_xor_b32 s37, s39, 4
    s_lshl_b32 s37, s37, 2
    s_add_u32 s37, s37, 159232
    v_mov_b32 v27, s37
    s_nop 7
    ds_write_b128 v25, v[116:119] offset:0
    ds_write_b128 v25, v[120:123] offset:1024
    ds_write_b128 v25, v[124:127] offset:2048
    ds_write_b128 v25, v[128:131] offset:3072
    s_waitcnt lgkmcnt(0)
    ds_write_b32 v26, v28
    v_xor_b32 v25, 0x4000, v25
AT_XW:
    ds_read_b32 v24, v27
    s_waitcnt lgkmcnt(0)
    v_cmp_gt_u32 vcc, 100, v24
    s_nop 1
    s_cbranch_vccz AT_XOK
    s_add_u32 s101, s101, 1
    s_cmp_gt_u32 s101, 0x40000
    s_cbranch_scc1 K_END
    s_sleep 1
    s_branch AT_XW
AT_XOK:
    ds_read_b128 v[116:119], v25 offset:0
    ds_read_b128 v[120:123], v25 offset:1024
    ds_read_b128 v[124:127], v25 offset:2048
    ds_read_b128 v[128:131], v25 offset:3072
    s_waitcnt lgkmcnt(3)
    v_add_f32 v100, v100, v116
    v_add_f32 v101, v101, v117
    v_add_f32 v102, v102, v118
    v_add_f32 v103, v103, v119
    s_waitcnt lgkmcnt(2)
    v_add_f32 v104, v104, v120
    v_add_f32 v105, v105, v121
    v_add_f32 v106, v106, v122
    v_add_f32 v107, v107, v123
    s_waitcnt lgkmcnt(1)
    v_add_f32 v108, v108, v124
    v_add_f32 v109, v109, v125
    v_add_f32 v110, v110, v126
    v_add_f32 v111, v111, v127
    s_waitcnt lgkmcnt(0)
    v_add_f32 v112, v112, v128
    v_add_f32 v113, v113, v129
    v_add_f32 v114, v114, v130
    v_add_f32 v115, v115, v131
    v_mul_f32 v24, 0, v100
    v_fmac_f32 v24, 0, v101
    v_fmac_f32 v24, 0, v102
    v_fmac_f32 v24, 0, v103
    v_fmac_f32 v24, 0, v104
    v_fmac_f32 v24, 0, v105
    v_fmac_f32 v24, 0, v106
    v_fmac_f32 v24, 0, v107
    v_fmac_f32 v24, 0, v108
    v_fmac_f32 v24, 0, v109
    v_fmac_f32 v24, 0, v110
    v_fmac_f32 v24, 0, v111
    v_add_f32 v24, v24, v112
    v_cmp_gt_f32 vcc, 0x71800000, v24
    s_nop 1
    s_cmp_eq_u64 vcc, exec
    s_cbranch_scc0 AT_SLOW
AT_FIN:
    v_rcp_f32 v24, v112
    s_mul_i32 s36, s48, 40960
    s_add_u32 s36, s36, s38
    s_add_u32 s36, s36, 18239488
    v_mul_f32 v100, v24, v100
    v_mul_f32 v101, v24, v101
    v_mul_f32 v102, v24, v102
    v_mul_f32 v103, v24, v103
    v_cvt_pk_bf16_f32 v32, v100, v101
    v_cvt_pk_bf16_f32 v33, v102, v103
    buffer_store_dwordx2 v[32:33], v3, s[16:19], s36 offen offset:0 sc1
    v_mul_f32 v104, v24, v104
    v_mul_f32 v105, v24, v105
    v_mul_f32 v106, v24, v106
    v_mul_f32 v107, v24, v107
    v_cvt_pk_bf16_f32 v34, v104, v105
    v_cvt_pk_bf16_f32 v35, v106, v107
    buffer_store_dwordx2 v[34:35], v3, s[16:19], s36 offen offset:512 sc1
    v_mul_f32 v108, v24, v108
    v_mul_f32 v109, v24, v109
    v_mul_f32 v110, v24, v110
    v_mul_f32 v111, v24, v111
    v_cvt_pk_bf16_f32 v36, v108, v109
    v_cvt_pk_bf16_f32 v37, v110, v111
    s_mov_b64 exec, 0xffffffff
    buffer_store_dwordx2 v[36:37], v3, s[16:19], s36 offen offset:1024 sc1
    s_mov_b64 exec, -1
    s_lshl_b32 s37, s81, 8
    s_add_u32 s37, s37, 20905984
    v_mov_b32 v68, 159320
    v_mov_b32 v69, 1
    v_mov_b32 v71, s37
    s_waitcnt vmcnt(0)
    s_mov_b64 exec, 1
    ds_add_rtn_u32 v70, v68, v69
    s_waitcnt lgkmcnt(0)
    v_readfirstlane_b32 s36, v70
    s_cmp_lg_u32 s36, 7
    s_cbranch_scc1 PUB3
    buffer_atomic_add v69, v71, s[16:19], 0 offen sc1
PUB3:
    s_mov_b64 exec, -1
    s_endpgm
AT_SPIN:
    s_add_u32 s101, s101, 1
    s_cmp_gt_u32 s101, 0x40000
    s_cbranch_scc1 K_END
    s_sleep 1
    ds_read_b32 v24, v27
    s_waitcnt lgkmcnt(0)
    v_cmp_gt_u32 vcc, s43, v24
    s_nop 1
    s_cbranch_vccnz AT_SPIN
    s_branch AT_SPUN
AT_SLOW:
    s_mul_i32 s40, s80, 163840
    s_add_u32 s40, s40, 2621440
    s_mov_b32 s43, 0
    v_mov_b32 v84, 0xff800000
    s_mov_b32 exec_lo, 0
    v_mov_b32 v8, 0
    s_mov_b64 exec, -1
    v_mov_b32 v100, 0
    v_mov_b32 v101, 0
    v_mov_b32 v102, 0
    v_mov_b32 v103, 0
    v_mov_b32 v104, 0
    v_mov_b32 v105, 0
    v_mov_b32 v106, 0
    v_mov_b32 v107, 0
    v_mov_b32 v108, 0
    v_mov_b32 v109, 0
    v_mov_b32 v110, 0
    v_mov_b32 v111, 0
    v_mov_b32 v112, 0
    v_mov_b32 v113, 0
    v_mov_b32 v114, 0
    v_mov_b32 v115, 0
AT_SLOOP:
    buffer_load_dwordx2 v[40:41], v3, s[16:19], s40 offen sc1
    buffer_load_dwordx2 v[42:43], v3, s[16:19], s40 offen offset:512 sc1
    buffer_load_dwordx2 v[44:45], v3, s[16:19], s40 offen offset:1024 sc1
    s_mov_b64 exec, s[46:47]
    buffer_load_dwordx4 v[52:55], v31, s[16:19], s40 offen sc1
    buffer_load_dwordx4 v[56:59], v31, s[16:19], s40 offen offset:640 sc1
    s_mov_b64 exec, -1
    s_waitcnt vmcnt(0)
    v_mfma_f32_32x32x16_bf16 v[68:83], v[40:43], v[4:7], 0
    v_mfma_f32_32x32x8_bf16 v[68:83], v[44:45], v[8:9], v[68:83]
    s_nop 15
    v_max3_f32 v24, v68, v69, v84
    v_max3_f32 v24, v24, v70, v71
    v_max3_f32 v24, v24, v72, v73
    v_max3_f32 v24, v24, v74, v75
    v_max3_f32 v24, v24, v76, v77
    v_max3_f32 v24, v24, v78, v79
    v_max3_f32 v24, v24, v80, v81
    v_max3_f32 v24, v24, v82, v83
    v_mov_b32 v25, v24
    s_nop 1
    v_permlane32_swap_b32 v24, v25
    v_max_f32 v24, v24, v25
    v_sub_f32 v25, v84, v24
    v_exp_f32 v25, v25
    v_mov_b32 v84, v24
    v_sub_f32 v68, v68, v24
    v_sub_f32 v69, v69, v24
    v_sub_f32 v70, v70, v24
    v_sub_f32 v71, v71, v24
    v_sub_f32 v72, v72, v24
    v_sub_f32 v73, v73, v24
    v_sub_f32 v74, v74, v24
    v_sub_f32 v75, v75, v24
    v_sub_f32 v76, v76, v24
    v_sub_f32 v77, v77, v24
    v_sub_f32 v78, v78, v24
    v_sub_f32 v79, v79, v24
    v_sub_f32 v80, v80, v24
    v_sub_f32 v81, v81, v24
    v_sub_f32 v82, v82, v24
    v_sub_f32 v83, v83, v24
    v_exp_f32 v68, v68
    v_exp_f32 v69, v69
    v_exp_f32 v70, v70
    v_exp_f32 v71, v71
    v_exp_f32 v72, v72
    v_exp_f32 v73, v73
    v_exp_f32 v74, v74
    v_exp_f32 v75, v75
    v_exp_f32 v76, v76
    v_exp_f32 v77, v77
    v_exp_f32 v78, v78
    v_exp_f32 v79, v79
    v_exp_f32 v80, v80
    v_exp_f32 v81, v81
    v_exp_f32 v82, v82
    v_exp_f32 v83, v83
    v_mul_f32 v100, v25, v100
    v_mul_f32 v101, v25, v101
    v_mul_f32 v102, v25, v102
    v_mul_f32 v103, v25, v103
    v_mul_f32 v104, v25, v104
    v_mul_f32 v105, v25, v105
    v_mul_f32 v106, v25, v106
    v_mul_f32 v107, v25, v107
    v_mul_f32 v108, v25, v108
    v_mul_f32 v109, v25, v109
    v_mul_f32 v110, v25, v110
    v_mul_f32 v111, v25, v111
    v_mul_f32 v112, v25, v112
    v_mul_f32 v113, v25, v113
    v_mul_f32 v114, v25, v114
    v_mul_f32 v115, v25, v115
    v_cvt_pk_bf16_f32 v32, v68, v69
    v_cvt_pk_bf16_f32 v33, v70, v71
    v_cvt_pk_bf16_f32 v34, v72, v73
    v_cvt_pk_bf16_f32 v35, v74, v75
    v_cvt_pk_bf16_f32 v36, v76, v77
    v_cvt_pk_bf16_f32 v37, v78, v79
    v_cvt_pk_bf16_f32 v38, v80, v81
    v_cvt_pk_bf16_f32 v39, v82, v83
    s_nop 1
    v_mfma_f32_32x32x16_bf16 v[100:115], v[52:55], v[32:35], v[100:115]
    v_mfma_f32_32x32x16_bf16 v[100:115], v[56:59], v[36:39], v[100:115]
    s_add_u32 s40, s40, 2560
    s_add_u32 s43, s43, 1
    s_nop 15
    s_cmp_lt_u32 s43, 64
    s_cbranch_scc1 AT_SLOOP
    s_branch AT_FIN
H_WARM:
    s_sub_u32 s35, s34, 4
    s_and_b32 s36, s32, 3
    s_lshl_b32 s36, s36, 2
    s_lshl_b32 s37, s35, 4
    s_add_u32 s36, s36, s37
    s_mul_i32 s83, s36, 3840
    s_lshl_b32 s37, s33, 8
    s_add_u32 s83, s83, s37
    v_lshrrev_b32 v143, 4, v1
    v_mul_u32_u24 v143, 3840, v143
    v_and_b32 v144, 15, v1
    v_lshl_add_u32 v146, v144, 4, v143
    s_add_u32 s83, s83, 737280
    s_and_b32 s37, s33, 7
    s_lshl_b32 s37, s37, 1
    s_add_u32 s37, s37, s35
    s_lshl_b32 s37, s37, 3
    s_lshl_b32 s38, s32, 7
    s_add_u32 s37, s37, s38
    s_mul_i32 s84, s37, 1280
    s_cmp_lt_u32 s35, 2
    s_cselect_b32 s84, s84, 0x40000000
    v_lshrrev_b32 v144, 3, v1
    v_mul_u32_u24 v144, 1280, v144
    v_and_b32 v145, 7, v1
    v_lshl_add_u32 v147, v145, 4, v144
    buffer_load_dwordx4 v[148:151], v146, s[12:15], s83 offen
    s_add_u32 s83, s83, 245760
    buffer_load_dwordx4 v[148:151], v147, s[8:11], s84 offen offset:384
    buffer_load_dwordx4 v[148:151], v146, s[12:15], s83 offen
    s_add_u32 s83, s83, 245760
    buffer_load_dwordx4 v[148:151], v147, s[8:11], s84 offen offset:512
    buffer_load_dwordx4 v[148:151], v146, s[12:15], s83 offen
    s_add_u32 s83, s83, 245760
    buffer_load_dwordx4 v[148:151], v147, s[8:11], s84 offen offset:640
    s_barrier
    buffer_load_dwordx4 v[148:151], v146, s[12:15], s83 offen
    s_add_u32 s83, s83, 245760
    buffer_load_dwordx4 v[148:151], v147, s[8:11], s84 offen offset:768
    buffer_load_dwordx4 v[148:151], v146, s[12:15], s83 offen
    s_add_u32 s83, s83, 245760
    buffer_load_dwordx4 v[148:151], v147, s[8:11], s84 offen offset:896
    buffer_load_dwordx4 v[148:151], v146, s[12:15], s83 offen
    s_add_u32 s83, s83, 245760
    buffer_load_dwordx4 v[148:151], v147, s[8:11], s84 offen offset:1024
    s_barrier
    buffer_load_dwordx4 v[148:151], v146, s[12:15], s83 offen
    s_add_u32 s83, s83, 245760
    buffer_load_dwordx4 v[148:151], v147, s[8:11], s84 offen offset:1152
    s_mov_b32 s12, s52
    s_mov_b32 s13, s53
    s_mov_b32 s14, 2211840
    s_mov_b32 s15, 0x00020000
    s_sub_u32 s35, s34, 4
    s_and_b32 s36, s32, 3
    s_lshl_b32 s36, s36, 2
    s_lshl_b32 s37, s35, 4
    s_add_u32 s36, s36, s37
    s_mul_i32 s83, s36, 3456
    s_lshl_b32 s37, s33, 8
    s_add_u32 s83, s83, s37
    v_lshrrev_b32 v143, 4, v1
    v_mul_u32_u24 v143, 3456, v143
    v_and_b32 v144, 15, v1
    v_lshl_add_u32 v146, v144, 4, v143
    buffer_load_dwordx4 v[148:151], v146, s[12:15], s83 offen
    s_add_u32 s83, s83, 221184
    buffer_load_dwordx4 v[148:151], v146, s[12:15], s83 offen
    s_add_u32 s83, s83, 221184
    s_barrier
    buffer_load_dwordx4 v[148:151], v146, s[12:15], s83 offen
    s_add_u32 s83, s83, 221184
    buffer_load_dwordx4 v[148:151], v146, s[12:15], s83 offen
    s_add_u32 s83, s83, 221184
    buffer_load_dwordx4 v[148:151], v146, s[12:15], s83 offen
    s_add_u32 s83, s83, 221184
    s_barrier
    buffer_load_dwordx4 v[148:151], v146, s[12:15], s83 offen
    s_add_u32 s83, s83, 221184
    buffer_load_dwordx4 v[148:151], v146, s[12:15], s83 offen
    s_add_u32 s83, s83, 221184
    buffer_load_dwordx4 v[148:151], v146, s[12:15], s83 offen
    s_add_u32 s83, s83, 221184
    s_barrier
    buffer_load_dwordx4 v[148:151], v146, s[12:15], s83 offen
    s_add_u32 s83, s83, 221184
    buffer_load_dwordx4 v[148:151], v146, s[12:15], s83 offen
    s_add_u32 s83, s83, 221184
    s_barrier
    s_barrier
    s_barrier
    s_barrier
    s_barrier
    s_barrier
    s_cmp_eq_u32 s33, 14
    s_cbranch_scc1 K_PREP
    s_barrier
    s_barrier
    s_barrier
    s_barrier
    s_barrier
    s_barrier
    s_barrier
    s_barrier
    s_barrier
    s_barrier
    s_branch H_TAIL
H_TYPEB:
    s_waitcnt vmcnt(16)
    s_barrier
    s_waitcnt vmcnt(8)
    s_barrier
    s_waitcnt vmcnt(0)
    s_barrier
    s_barrier
K_PREP:
    s_mul_i32 s47, s32, 12
    s_add_u32 s47, s47, s3
    v_lshlrev_b32 v4, 4, v1
    v_bfe_u32 v3, v1, 2, 2
    v_mul_u32_u24 v2, 1280, v3
    v_and_b32 v3, 3, v1
    v_lshl_add_u32 v2, v3, 4, v2
    v_lshrrev_b32 v3, 4, v1
    v_lshl_add_u32 v2, v3, 6, v2
    v_lshrrev_b32 v3, 5, v1
    v_mul_u32_u24 v6, 1024, v3
    v_bfe_u32 v3, v1, 2, 2
    v_lshl_add_u32 v6, v3, 6, v6
    v_bfe_u32 v3, v1, 4, 1
    v_lshl_add_u32 v6, v3, 5, v6
    v_and_b32 v3, 3, v1
    v_lshl_add_u32 v6, v3, 3, v6
    s_lshl_b32 s36, s3, 12
    v_add_u32 v6, s36, v6
    v_add_u32 v5, s36, v4
    s_cmp_eq_u32 s33, 15
    s_cbranch_scc1 PREP3
    s_add_u32 s40, s47, 576
    s_min_u32 s40, s40, 739
    s_cmp_lt_u32 s40, 540
    s_cselect_b32 s36, 0, 540
    s_cselect_b32 s20, s28, s24
    s_cselect_b32 s21, s29, s25
    s_mov_b32 s22, 819200
    s_cselect_b32 s22, 2211840, s22
    s_mov_b32 s23, 0x00020000
    s_sub_u32 s36, s40, s36
    s_mul_i32 s37, s36, 209716
    s_lshr_b32 s37, s37, 20
    s_mul_i32 s38, s37, 5
    s_sub_u32 s36, s36, s38
    s_mul_i32 s37, s37, 20480
    s_lshl_b32 s36, s36, 8
    s_add_u32 s37, s37, s36
    s_lshl_b32 s42, s40, 12
    s_add_u32 s42, s42, 7864320
    buffer_load_dwordx4 v[8:11], v2, s[20:23], s37 offen
    s_add_u32 s37, s37, 5120
    buffer_load_dwordx4 v[12:15], v2, s[20:23], s37 offen
    s_add_u32 s37, s37, 5120
    buffer_load_dwordx4 v[16:19], v2, s[20:23], s37 offen
    s_add_u32 s37, s37, 5120
    buffer_load_dwordx4 v[20:23], v2, s[20:23], s37 offen
    s_add_u32 s37, s37, 5120
    s_waitcnt vmcnt(0)
    ds_write_b128 v5, v[8:11] offset:0
    ds_write_b128 v5, v[12:15] offset:1024
    ds_write_b128 v5, v[16:19] offset:2048
    ds_write_b128 v5, v[20:23] offset:3072
    s_waitcnt lgkmcnt(0)
    ds_read_b64_tr_b16 v[56:57], v6 offset:0
    ds_read_b64_tr_b16 v[58:59], v6 offset:2048
    ds_read_b64_tr_b16 v[60:61], v6 offset:256
    ds_read_b64_tr_b16 v[62:63], v6 offset:2304
    ds_read_b64_tr_b16 v[64:65], v6 offset:512
    ds_read_b64_tr_b16 v[66:67], v6 offset:2560
    ds_read_b64_tr_b16 v[68:69], v6 offset:768
    ds_read_b64_tr_b16 v[70:71], v6 offset:2816
    s_waitcnt lgkmcnt(6)
    buffer_store_dwordx4 v[56:59], v4, s[16:19], s42 offen offset:0 sc1
    s_waitcnt lgkmcnt(4)
    buffer_store_dwordx4 v[60:63], v4, s[16:19], s42 offen offset:1024 sc1
    s_waitcnt lgkmcnt(2)
    buffer_store_dwordx4 v[64:67], v4, s[16:19], s42 offen offset:2048 sc1
    s_waitcnt lgkmcnt(0)
    buffer_store_dwordx4 v[68:71], v4, s[16:19], s42 offen offset:3072 sc1
    s_branch PREP_DONE
PREP3:
    s_add_u32 s40, s47, 0
    s_min_u32 s40, s40, 739
    s_cmp_lt_u32 s40, 540
    s_cselect_b32 s36, 0, 540
    s_cselect_b32 s20, s28, s24
    s_cselect_b32 s21, s29, s25
    s_mov_b32 s22, 819200
    s_cselect_b32 s22, 2211840, s22
    s_mov_b32 s23, 0x00020000
    s_sub_u32 s36, s40, s36
    s_mul_i32 s37, s36, 209716
    s_lshr_b32 s37, s37, 20
    s_mul_i32 s38, s37, 5
    s_sub_u32 s36, s36, s38
    s_mul_i32 s37, s37, 20480
    s_lshl_b32 s36, s36, 8
    s_add_u32 s37, s37, s36
    s_lshl_b32 s42, s40, 12
    s_add_u32 s42, s42, 7864320
    buffer_load_dwordx4 v[8:11], v2, s[20:23], s37 offen
    s_add_u32 s37, s37, 5120
    buffer_load_dwordx4 v[12:15], v2, s[20:23], s37 offen
    s_add_u32 s37, s37, 5120
    buffer_load_dwordx4 v[16:19], v2, s[20:23], s37 offen
    s_add_u32 s37, s37, 5120
    buffer_load_dwordx4 v[20:23], v2, s[20:23], s37 offen
    s_add_u32 s37, s37, 5120
    s_add_u32 s40, s47, 192
    s_min_u32 s40, s40, 739
    s_cmp_lt_u32 s40, 540
    s_cselect_b32 s36, 0, 540
    s_cselect_b32 s20, s28, s24
    s_cselect_b32 s21, s29, s25
    s_mov_b32 s22, 819200
    s_cselect_b32 s22, 2211840, s22
    s_mov_b32 s23, 0x00020000
    s_sub_u32 s36, s40, s36
    s_mul_i32 s37, s36, 209716
    s_lshr_b32 s37, s37, 20
    s_mul_i32 s38, s37, 5
    s_sub_u32 s36, s36, s38
    s_mul_i32 s37, s37, 20480
    s_lshl_b32 s36, s36, 8
    s_add_u32 s37, s37, s36
    s_lshl_b32 s43, s40, 12
    s_add_u32 s43, s43, 7864320
    buffer_load_dwordx4 v[24:27], v2, s[20:23], s37 offen
    s_add_u32 s37, s37, 5120
    buffer_load_dwordx4 v[28:31], v2, s[20:23], s37 offen
    s_add_u32 s37, s37, 5120
    buffer_load_dwordx4 v[32:35], v2, s[20:23], s37 offen
    s_add_u32 s37, s37, 5120
    buffer_load_dwordx4 v[36:39], v2, s[20:23], s37 offen
    s_add_u32 s37, s37, 5120
    s_add_u32 s40, s47, 384
    s_min_u32 s40, s40, 739
    s_cmp_lt_u32 s40, 540
    s_cselect_b32 s36, 0, 540
    s_cselect_b32 s20, s28, s24
    s_cselect_b32 s21, s29, s25
    s_mov_b32 s22, 819200
    s_cselect_b32 s22, 2211840, s22
    s_mov_b32 s23, 0x00020000
    s_sub_u32 s36, s40, s36
    s_mul_i32 s37, s36, 209716
    s_lshr_b32 s37, s37, 20
    s_mul_i32 s38, s37, 5
    s_sub_u32 s36, s36, s38
    s_mul_i32 s37, s37, 20480
    s_lshl_b32 s36, s36, 8
    s_add_u32 s37, s37, s36
    s_lshl_b32 s44, s40, 12
    s_add_u32 s44, s44, 7864320
    buffer_load_dwordx4 v[40:43], v2, s[20:23], s37 offen
    s_add_u32 s37, s37, 5120
    buffer_load_dwordx4 v[44:47], v2, s[20:23], s37 offen
    s_add_u32 s37, s37, 5120
    buffer_load_dwordx4 v[48:51], v2, s[20:23], s37 offen
    s_add_u32 s37, s37, 5120
    buffer_load_dwordx4 v[52:55], v2, s[20:23], s37 offen
    s_add_u32 s37, s37, 5120
    s_waitcnt vmcnt(8)
    ds_write_b128 v5, v[8:11] offset:0
    ds_write_b128 v5, v[12:15] offset:1024
    ds_write_b128 v5, v[16:19] offset:2048
    ds_write_b128 v5, v[20:23] offset:3072
    s_waitcnt lgkmcnt(0)
    ds_read_b64_tr_b16 v[56:57], v6 offset:0
    ds_read_b64_tr_b16 v[58:59], v6 offset:2048
    ds_read_b64_tr_b16 v[60:61], v6 offset:256
    ds_read_b64_tr_b16 v[62:63], v6 offset:2304
    ds_read_b64_tr_b16 v[64:65], v6 offset:512
    ds_read_b64_tr_b16 v[66:67], v6 offset:2560
    ds_read_b64_tr_b16 v[68:69], v6 offset:768
    ds_read_b64_tr_b16 v[70:71], v6 offset:2816
    s_waitcnt lgkmcnt(6)
    buffer_store_dwordx4 v[56:59], v4, s[16:19], s42 offen offset:0 sc1
    s_waitcnt lgkmcnt(4)
    buffer_store_dwordx4 v[60:63], v4, s[16:19], s42 offen offset:1024 sc1
    s_waitcnt lgkmcnt(2)
    buffer_store_dwordx4 v[64:67], v4, s[16:19], s42 offen offset:2048 sc1
    s_waitcnt lgkmcnt(0)
    buffer_store_dwordx4 v[68:71], v4, s[16:19], s42 offen offset:3072 sc1
    s_waitcnt vmcnt(8)
    ds_write_b128 v5, v[24:27] offset:0
    ds_write_b128 v5, v[28:31] offset:1024
    ds_write_b128 v5, v[32:35] offset:2048
    ds_write_b128 v5, v[36:39] offset:3072
    s_waitcnt lgkmcnt(0)
    ds_read_b64_tr_b16 v[72:73], v6 offset:0
    ds_read_b64_tr_b16 v[74:75], v6 offset:2048
    ds_read_b64_tr_b16 v[76:77], v6 offset:256
    ds_read_b64_tr_b16 v[78:79], v6 offset:2304
    ds_read_b64_tr_b16 v[80:81], v6 offset:512
    ds_read_b64_tr_b16 v[82:83], v6 offset:2560
    ds_read_b64_tr_b16 v[84:85], v6 offset:768
    ds_read_b64_tr_b16 v[86:87], v6 offset:2816
    s_waitcnt lgkmcnt(6)
    buffer_store_dwordx4 v[72:75], v4, s[16:19], s43 offen offset:0 sc1
    s_waitcnt lgkmcnt(4)
    buffer_store_dwordx4 v[76:79], v4, s[16:19], s43 offen offset:1024 sc1
    s_waitcnt lgkmcnt(2)
    buffer_store_dwordx4 v[80:83], v4, s[16:19], s43 offen offset:2048 sc1
    s_waitcnt lgkmcnt(0)
    buffer_store_dwordx4 v[84:87], v4, s[16:19], s43 offen offset:3072 sc1
    s_waitcnt vmcnt(8)
    ds_write_b128 v5, v[40:43] offset:0
    ds_write_b128 v5, v[44:47] offset:1024
    ds_write_b128 v5, v[48:51] offset:2048
    ds_write_b128 v5, v[52:55] offset:3072
    s_waitcnt lgkmcnt(0)
    ds_read_b64_tr_b16 v[88:89], v6 offset:0
    ds_read_b64_tr_b16 v[90:91], v6 offset:2048
    ds_read_b64_tr_b16 v[92:93], v6 offset:256
    ds_read_b64_tr_b16 v[94:95], v6 offset:2304
    ds_read_b64_tr_b16 v[96:97], v6 offset:512
    ds_read_b64_tr_b16 v[98:99], v6 offset:2560
    ds_read_b64_tr_b16 v[100:101], v6 offset:768
    ds_read_b64_tr_b16 v[102:103], v6 offset:2816
    s_waitcnt lgkmcnt(6)
    buffer_store_dwordx4 v[88:91], v4, s[16:19], s44 offen offset:0 sc1
    s_waitcnt lgkmcnt(4)
    buffer_store_dwordx4 v[92:95], v4, s[16:19], s44 offen offset:1024 sc1
    s_waitcnt lgkmcnt(2)
    buffer_store_dwordx4 v[96:99], v4, s[16:19], s44 offen offset:2048 sc1
    s_waitcnt lgkmcnt(0)
    buffer_store_dwordx4 v[100:103], v4, s[16:19], s44 offen offset:3072 sc1
PREP_DONE:
    s_barrier
    s_lshl_b32 s37, s32, 8
    s_add_u32 s37, s37, 20901888
    v_mov_b32 v104, 159324
    v_mov_b32 v105, 1
    v_mov_b32 v107, s37
    s_waitcnt vmcnt(0)
    s_mov_b64 exec, 1
    ds_add_rtn_u32 v106, v104, v105
    s_waitcnt lgkmcnt(0)
    v_readfirstlane_b32 s36, v106
    s_cmp_lg_u32 s36, 11
    s_cbranch_scc1 PUB4
    buffer_atomic_add v105, v107, s[16:19], 0 offen sc1
PUB4:
    s_mov_b64 exec, -1
    s_cmp_ge_u32 s3, 4
    s_cbranch_scc1 H_TAIL
    s_branch M_FFN2
K_STATS:
    s_cmp_ge_u32 s3, 8
    s_cbranch_scc1 ST_ZERO
    v_lshrrev_b32 v2, 3, v1
    v_and_b32 v3, 7, v1
    v_mul_u32_u24 v4, 1280, v2
    v_lshl_add_u32 v4, v3, 4, v4
    s_lshl_b32 s36, s32, 3
    s_add_u32 s36, s36, s3
    s_mul_i32 s36, s36, 20480
    s_add_u32 s37, s36, 10240
    buffer_load_dwordx4 v[16:19], v4, s[8:11], s36 offen offset:0
    buffer_load_dwordx4 v[20:23], v4, s[8:11], s36 offen offset:128
    buffer_load_dwordx4 v[24:27], v4, s[8:11], s36 offen offset:256
    buffer_load_dwordx4 v[28:31], v4, s[8:11], s36 offen offset:384
    buffer_load_dwordx4 v[32:35], v4, s[8:11], s36 offen offset:512
    buffer_load_dwordx4 v[36:39], v4, s[8:11], s36 offen offset:640
    buffer_load_dwordx4 v[40:43], v4, s[8:11], s36 offen offset:768
    buffer_load_dwordx4 v[44:47], v4, s[8:11], s36 offen offset:896
    buffer_load_dwordx4 v[48:51], v4, s[8:11], s36 offen offset:1024
    buffer_load_dwordx4 v[52:55], v4, s[8:11], s36 offen offset:1152
    buffer_load_dwordx4 v[56:59], v4, s[8:11], s37 offen offset:0
    buffer_load_dwordx4 v[60:63], v4, s[8:11], s37 offen offset:128
    buffer_load_dwordx4 v[64:67], v4, s[8:11], s37 offen offset:256
    buffer_load_dwordx4 v[68:71], v4, s[8:11], s37 offen offset:384
    buffer_load_dwordx4 v[72:75], v4, s[8:11], s37 offen offset:512
    buffer_load_dwordx4 v[76:79], v4, s[8:11], s37 offen offset:640
    buffer_load_dwordx4 v[80:83], v4, s[8:11], s37 offen offset:768
    buffer_load_dwordx4 v[84:87], v4, s[8:11], s37 offen offset:896
    buffer_load_dwordx4 v[88:91], v4, s[8:11], s37 offen offset:1024
    buffer_load_dwordx4 v[92:95], v4, s[8:11], s37 offen offset:1152
    v_mov_b32 v8, 0
    v_mov_b32 v9, 0
    v_mov_b32 v10, 0
    v_mov_b32 v11, 0
    s_mov_b32 s38, 0x3f803f80
    s_waitcnt vmcnt(19)
    v_dot2c_f32_bf16 v8, s38, v16
    v_dot2c_f32_bf16 v10, v16, v16
    v_dot2c_f32_bf16 v8, s38, v17
    v_dot2c_f32_bf16 v10, v17, v17
    v_dot2c_f32_bf16 v8, s38, v18
    v_dot2c_f32_bf16 v10, v18, v18
    v_dot2c_f32_bf16 v8, s38, v19
    v_dot2c_f32_bf16 v10, v19, v19
    s_waitcnt vmcnt(18)
    v_dot2c_f32_bf16 v8, s38, v20
    v_dot2c_f32_bf16 v10, v20, v20
    v_dot2c_f32_bf16 v8, s38, v21
    v_dot2c_f32_bf16 v10, v21, v21
    v_dot2c_f32_bf16 v8, s38, v22
    v_dot2c_f32_bf16 v10, v22, v22
    v_dot2c_f32_bf16 v8, s38, v23
    v_dot2c_f32_bf16 v10, v23, v23
    s_waitcnt vmcnt(17)
    v_dot2c_f32_bf16 v8, s38, v24
    v_dot2c_f32_bf16 v10, v24, v24
    v_dot2c_f32_bf16 v8, s38, v25
    v_dot2c_f32_bf16 v10, v25, v25
    v_dot2c_f32_bf16 v8, s38, v26
    v_dot2c_f32_bf16 v10, v26, v26
    v_dot2c_f32_bf16 v8, s38, v27
    v_dot2c_f32_bf16 v10, v27, v27
    s_waitcnt vmcnt(16)
    v_dot2c_f32_bf16 v8, s38, v28
    v_dot2c_f32_bf16 v10, v28, v28
    v_dot2c_f32_bf16 v8, s38, v29
    v_dot2c_f32_bf16 v10, v29, v29
    v_dot2c_f32_bf16 v8, s38, v30
    v_dot2c_f32_bf16 v10, v30, v30
    v_dot2c_f32_bf16 v8, s38, v31
    v_dot2c_f32_bf16 v10, v31, v31
    s_waitcnt vmcnt(15)
    v_dot2c_f32_bf16 v8, s38, v32
    v_dot2c_f32_bf16 v10, v32, v32
    v_dot2c_f32_bf16 v8, s38, v33
    v_dot2c_f32_bf16 v10, v33, v33
    v_dot2c_f32_bf16 v8, s38, v34
    v_dot2c_f32_bf16 v10, v34, v34
    v_dot2c_f32_bf16 v8, s38, v35
    v_dot2c_f32_bf16 v10, v35, v35
    s_waitcnt vmcnt(14)
    v_dot2c_f32_bf16 v8, s38, v36
    v_dot2c_f32_bf16 v10, v36, v36
    v_dot2c_f32_bf16 v8, s38, v37
    v_dot2c_f32_bf16 v10, v37, v37
    v_dot2c_f32_bf16 v8, s38, v38
    v_dot2c_f32_bf16 v10, v38, v38
    v_dot2c_f32_bf16 v8, s38, v39
    v_dot2c_f32_bf16 v10, v39, v39
    s_waitcnt vmcnt(13)
    v_dot2c_f32_bf16 v8, s38, v40
    v_dot2c_f32_bf16 v10, v40, v40
    v_dot2c_f32_bf16 v8, s38, v41
    v_dot2c_f32_bf16 v10, v41, v41
    v_dot2c_f32_bf16 v8, s38, v42
    v_dot2c_f32_bf16 v10, v42, v42
    v_dot2c_f32_bf16 v8, s38, v43
    v_dot2c_f32_bf16 v10, v43, v43
    s_waitcnt vmcnt(12)
    v_dot2c_f32_bf16 v8, s38, v44
    v_dot2c_f32_bf16 v10, v44, v44
    v_dot2c_f32_bf16 v8, s38, v45
    v_dot2c_f32_bf16 v10, v45, v45
    v_dot2c_f32_bf16 v8, s38, v46
    v_dot2c_f32_bf16 v10, v46, v46
    v_dot2c_f32_bf16 v8, s38, v47
    v_dot2c_f32_bf16 v10, v47, v47
    s_waitcnt vmcnt(11)
    v_dot2c_f32_bf16 v8, s38, v48
    v_dot2c_f32_bf16 v10, v48, v48
    v_dot2c_f32_bf16 v8, s38, v49
    v_dot2c_f32_bf16 v10, v49, v49
    v_dot2c_f32_bf16 v8, s38, v50
    v_dot2c_f32_bf16 v10, v50, v50
    v_dot2c_f32_bf16 v8, s38, v51
    v_dot2c_f32_bf16 v10, v51, v51
    s_waitcnt vmcnt(10)
    v_dot2c_f32_bf16 v8, s38, v52
    v_dot2c_f32_bf16 v10, v52, v52
    v_dot2c_f32_bf16 v8, s38, v53
    v_dot2c_f32_bf16 v10, v53, v53
    v_dot2c_f32_bf16 v8, s38, v54
    v_dot2c_f32_bf16 v10, v54, v54
    v_dot2c_f32_bf16 v8, s38, v55
    v_dot2c_f32_bf16 v10, v55, v55
    s_waitcnt vmcnt(9)
    v_dot2c_f32_bf16 v9, s38, v56
    v_dot2c_f32_bf16 v11, v56, v56
    v_dot2c_f32_bf16 v9, s38, v57
    v_dot2c_f32_bf16 v11, v57, v57
    v_dot2c_f32_bf16 v9, s38, v58
    v_dot2c_f32_bf16 v11, v58, v58
    v_dot2c_f32_bf16 v9, s38, v59
    v_dot2c_f32_bf16 v11, v59, v59
    s_waitcnt vmcnt(8)
    v_dot2c_f32_bf16 v9, s38, v60
    v_dot2c_f32_bf16 v11, v60, v60
    v_dot2c_f32_bf16 v9, s38, v61
    v_dot2c_f32_bf16 v11, v61, v61
    v_dot2c_f32_bf16 v9, s38, v62
    v_dot2c_f32_bf16 v11, v62, v62
    v_dot2c_f32_bf16 v9, s38, v63
    v_dot2c_f32_bf16 v11, v63, v63
    s_waitcnt vmcnt(7)
    v_dot2c_f32_bf16 v9, s38, v64
    v_dot2c_f32_bf16 v11, v64, v64
    v_dot2c_f32_bf16 v9, s38, v65
    v_dot2c_f32_bf16 v11, v65, v65
    v_dot2c_f32_bf16 v9, s38, v66
    v_dot2c_f32_bf16 v11, v66, v66
    v_dot2c_f32_bf16 v9, s38, v67
    v_dot2c_f32_bf16 v11, v67, v67
    s_waitcnt vmcnt(6)
    v_dot2c_f32_bf16 v9, s38, v68
    v_dot2c_f32_bf16 v11, v68, v68
    v_dot2c_f32_bf16 v9, s38, v69
    v_dot2c_f32_bf16 v11, v69, v69
    v_dot2c_f32_bf16 v9, s38, v70
    v_dot2c_f32_bf16 v11, v70, v70
    v_dot2c_f32_bf16 v9, s38, v71
    v_dot2c_f32_bf16 v11, v71, v71
    s_waitcnt vmcnt(5)
    v_dot2c_f32_bf16 v9, s38, v72
    v_dot2c_f32_bf16 v11, v72, v72
    v_dot2c_f32_bf16 v9, s38, v73
    v_dot2c_f32_bf16 v11, v73, v73
    v_dot2c_f32_bf16 v9, s38, v74
    v_dot2c_f32_bf16 v11, v74, v74
    v_dot2c_f32_bf16 v9, s38, v75
    v_dot2c_f32_bf16 v11, v75, v75
    s_waitcnt vmcnt(4)
    v_dot2c_f32_bf16 v9, s38, v76
    v_dot2c_f32_bf16 v11, v76, v76
    v_dot2c_f32_bf16 v9, s38, v77
    v_dot2c_f32_bf16 v11, v77, v77
    v_dot2c_f32_bf16 v9, s38, v78
    v_dot2c_f32_bf16 v11, v78, v78
    v_dot2c_f32_bf16 v9, s38, v79
    v_dot2c_f32_bf16 v11, v79, v79
    s_waitcnt vmcnt(3)
    v_dot2c_f32_bf16 v9, s38, v80
    v_dot2c_f32_bf16 v11, v80, v80
    v_dot2c_f32_bf16 v9, s38, v81
    v_dot2c_f32_bf16 v11, v81, v81
    v_dot2c_f32_bf16 v9, s38, v82
    v_dot2c_f32_bf16 v11, v82, v82
    v_dot2c_f32_bf16 v9, s38, v83
    v_dot2c_f32_bf16 v11, v83, v83
    s_waitcnt vmcnt(2)
    v_dot2c_f32_bf16 v9, s38, v84
    v_dot2c_f32_bf16 v11, v84, v84
    v_dot2c_f32_bf16 v9, s38, v85
    v_dot2c_f32_bf16 v11, v85, v85
    v_dot2c_f32_bf16 v9, s38, v86
    v_dot2c_f32_bf16 v11, v86, v86
    v_dot2c_f32_bf16 v9, s38, v87
    v_dot2c_f32_bf16 v11, v87, v87
    s_waitcnt vmcnt(1)
    v_dot2c_f32_bf16 v9, s38, v88
    v_dot2c_f32_bf16 v11, v88, v88
    v_dot2c_f32_bf16 v9, s38, v89
    v_dot2c_f32_bf16 v11, v89, v89
    v_dot2c_f32_bf16 v9, s38, v90
    v_dot2c_f32_bf16 v11, v90, v90
    v_dot2c_f32_bf16 v9, s38, v91
    v_dot2c_f32_bf16 v11, v91, v91
    s_waitcnt vmcnt(0)
    v_dot2c_f32_bf16 v9, s38, v92
    v_dot2c_f32_bf16 v11, v92, v92
    v_dot2c_f32_bf16 v9, s38, v93
    v_dot2c_f32_bf16 v11, v93, v93
    v_dot2c_f32_bf16 v9, s38, v94
    v_dot2c_f32_bf16 v11, v94, v94
    v_dot2c_f32_bf16 v9, s38, v95
    v_dot2c_f32_bf16 v11, v95, v95
    s_nop 3
    v_add_f32_dpp v8, v8, v8 quad_perm:[1,0,3,2] row_mask:0xf bank_mask:0xf
    v_add_f32_dpp v9, v9, v9 quad_perm:[1,0,3,2] row_mask:0xf bank_mask:0xf
    v_add_f32_dpp v10, v10, v10 quad_perm:[1,0,3,2] row_mask:0xf bank_mask:0xf
    v_add_f32_dpp v11, v11, v11 quad_perm:[1,0,3,2] row_mask:0xf bank_mask:0xf
    v_add_f32_dpp v8, v8, v8 quad_perm:[2,3,0,1] row_mask:0xf bank_mask:0xf
    v_add_f32_dpp v9, v9, v9 quad_perm:[2,3,0,1] row_mask:0xf bank_mask:0xf
    v_add_f32_dpp v10, v10, v10 quad_perm:[2,3,0,1] row_mask:0xf bank_mask:0xf
    v_add_f32_dpp v11, v11, v11 quad_perm:[2,3,0,1] row_mask:0xf bank_mask:0xf
    v_add_f32_dpp v8, v8, v8 row_half_mirror row_mask:0xf bank_mask:0xf
    v_add_f32_dpp v9, v9, v9 row_half_mirror row_mask:0xf bank_mask:0xf
    v_add_f32_dpp v10, v10, v10 row_half_mirror row_mask:0xf bank_mask:0xf
    v_add_f32_dpp v11, v11, v11 row_half_mirror row_mask:0xf bank_mask:0xf
    s_mov_b32 s36, 0x3acccccd
    v_mul_f32 v8, s36, v8
    v_mul_f32 v10, s36, v10
    v_mul_f32 v9, s36, v9
    v_mul_f32 v11, s36, v11
    v_fma_f32 v10, -v8, v8, v10
    v_fma_f32 v11, -v9, v9, v11
    v_max_f32 v10, 0, v10
    v_max_f32 v11, 0, v11
    v_cvt_pk_bf16_f32 v8, v8, v8
    v_and_b32 v8, 0xffff0000, v8
    v_cvt_pk_bf16_f32 v10, v10, v10
    v_and_b32 v10, 0xffff0000, v10
    v_cvt_pk_bf16_f32 v9, v9, v9
    v_and_b32 v9, 0xffff0000, v9
    v_cvt_pk_bf16_f32 v11, v11, v11
    v_and_b32 v11, 0xffff0000, v11
    v_add_f32 v10, 0x3727c5ac, v10
    v_add_f32 v11, 0x3727c5ac, v11
    v_cvt_pk_bf16_f32 v10, v10, v10
    v_and_b32 v10, 0xffff0000, v10
    v_cvt_pk_bf16_f32 v11, v11, v11
    v_and_b32 v11, 0xffff0000, v11
    v_sqrt_f32 v10, v10
    v_sqrt_f32 v11, v11
    s_nop 0
    v_cvt_pk_bf16_f32 v10, v10, v10
    v_and_b32 v10, 0xffff0000, v10
    v_cvt_pk_bf16_f32 v11, v11, v11
    v_and_b32 v11, 0xffff0000, v11
    v_rcp_f32 v10, v10
    v_rcp_f32 v11, v11
    s_mul_i32 s36, s32, 1536
    s_lshl_b32 s37, s3, 6
    s_add_u32 s36, s36, s37
    s_add_u32 s36, s36, 20860928
    v_lshlrev_b32 v2, 2, v2
    v_cmp_eq_u32 vcc, 0, v3
    v_mul_f32 v12, v8, v10
    v_mul_f32 v13, v9, v11
    s_and_saveexec_b64 s[40:41], vcc
    buffer_store_dword v8, v2, s[16:19], s36 offen offset:0 sc1
    buffer_store_dword v10, v2, s[16:19], s36 offen offset:512 sc1
    buffer_store_dword v12, v2, s[16:19], s36 offen offset:1024 sc1
    buffer_store_dword v9, v2, s[16:19], s36 offen offset:32 sc1
    buffer_store_dword v11, v2, s[16:19], s36 offen offset:544 sc1
    buffer_store_dword v13, v2, s[16:19], s36 offen offset:1056 sc1
    s_mov_b64 exec, s[40:41]
    s_branch ST_BAR
ST_ZERO:
    s_sub_u32 s36, s3, 8
    s_lshl_b32 s36, s36, 12
    s_lshl_b32 s37, s32, 8
    s_add_u32 s36, s36, s37
    s_add_u32 s36, s36, 20893696
    v_mov_b32 v2, 0
    s_mov_b64 exec, 1
    buffer_store_dword v2, v2, s[16:19], s36 offen sc1
    s_mov_b64 exec, -1
ST_BAR:
    s_waitcnt vmcnt(0)
    s_waitcnt lgkmcnt(0)
    s_barrier
    s_cmp_lg_u32 s3, 0
    s_cbranch_scc1 ST_DONE
    s_lshl_b32 s36, s32, 2
    v_mov_b32 v2, s36
    v_mov_b32 v3, 1
    s_mov_b64 exec, 1
    buffer_store_dword v3, v2, s[76:79], 0 offen offset:128 sc1
    s_mov_b64 exec, -1
    v_and_b32 v2, 15, v1
    v_lshlrev_b32 v2, 2, v2
    v_add_u32 v2, 128, v2
    v_mov_b32 v3, 1
POLL5:
    buffer_load_dword v4, v2, s[76:79], 0 offen sc1
    s_waitcnt vmcnt(0)
    v_cmp_gt_u32 vcc, v3, v4
    s_nop 1
    s_cbranch_vccz POLL5_OK
    s_add_u32 s101, s101, 1
    s_cmp_gt_u32 s101, 0x40000
    s_cbranch_scc1 K_END
    s_sleep 16
    s_branch POLL5
POLL5_OK:
ST_DONE:
    s_branch K_PREP
K_MFMA:
    s_lshr_b32 s34, s3, 1
    s_and_b32 s35, s3, 1
    s_xor_b32 s43, s34, 1
    v_and_b32 v7, 31, v1
    v_lshrrev_b32 v8, 5, v1
    v_bfe_u32 v9, v7, 1, 3
    v_xor_b32 v9, v9, v8
    v_lshlrev_b32 v9, 4, v9
    v_lshl_add_u32 v9, v7, 7, v9
    s_lshl_b32 s36, s34, 13
    v_add_u32 v2, s36, v9
    v_xor_b32 v3, 32, v2
    v_xor_b32 v4, 64, v2
    v_xor_b32 v5, 0x60, v2
    v_and_b32 v9, 15, v1
    v_bfe_u32 v10, v1, 4, 1
    v_cmp_eq_u32 vcc, v9, v10
    v_mov_b32 v9, 0x3f803f80
    s_nop 1
    v_cndmask_b32 v24, 0, v9, vcc
    v_cndmask_b32 v25, 0, v9, vcc
    v_cndmask_b32 v26, 0, v9, vcc
    v_cndmask_b32 v27, 0, v9, vcc
    v_lshrrev_b32 v9, 5, v1
    v_mul_u32_u24 v6, 2048, v9
    v_bfe_u32 v9, v1, 2, 2
    v_lshl_add_u32 v6, v9, 6, v6
    v_bfe_u32 v9, v1, 4, 1
    v_lshl_add_u32 v6, v9, 5, v6
    v_and_b32 v9, 3, v1
    v_lshl_add_u32 v6, v9, 3, v6
    s_lshl_b32 s36, s35, 9
    s_add_u32 s36, s36, 16384
    s_lshl_b32 s37, s34, 8
    s_add_u32 s36, s36, s37
    v_add_u32 v6, s36, v6
    v_xor_b32 v11, 0x100, v6
    v_add_u32 v160, 65536, v2
    v_add_u32 v161, 65536, v3
    v_add_u32 v162, 65536, v4
    v_add_u32 v163, 65536, v5
    v_add_u32 v164, 65536, v6
    v_add_u32 v165, 65536, v11
    s_cmp_ge_u32 s33, 10
    s_cbranch_scc1 M_V
    s_cmp_ge_u32 s33, 5
    s_cselect_b32 s38, 5, 0
    s_sub_u32 s36, s33, s38
    s_lshl_b32 s36, s36, 5
    s_lshl_b32 s37, s35, 4
    s_add_u32 s36, s36, s37
    s_lshl_b32 s37, s32, 2
    s_lshl_b32 s38, s34, 1
    s_add_u32 s37, s37, s38
    s_mov_b32 s39, 40960
    s_mov_b32 s40, 0
    s_movk_i32 s41, 1280
    s_cmp_ge_u32 s33, 5
    s_cselect_b32 s39, 2560, s39
    s_cselect_b32 s40, 2621440, s40
    s_cselect_b32 s41, 163840, s41
    s_mul_i32 s44, s37, s39
    s_add_u32 s44, s44, s40
    s_add_u32 s45, s44, s39
    s_lshl_b32 s38, s34, 3
    s_add_u32 s38, s38, s36
    v_add_u32 v10, s38, v8
    v_add_u32 v20, 0, v10
    v_mul_u32_u24 v21, 205, v20
    v_lshrrev_b32 v21, 10, v21
    v_mul_u32_u24 v22, 5, v21
    v_sub_u32 v20, v20, v22
    v_mul_lo_u32 v12, v21, s41
    v_lshl_add_u32 v12, v20, 8, v12
    v_lshl_add_u32 v12, v7, 3, v12
    v_add_u32 v20, 2, v10
    v_mul_u32_u24 v21, 205, v20
    v_lshrrev_b32 v21, 10, v21
    v_mul_u32_u24 v22, 5, v21
    v_sub_u32 v20, v20, v22
    v_mul_lo_u32 v13, v21, s41
    v_lshl_add_u32 v13, v20, 8, v13
    v_lshl_add_u32 v13, v7, 3, v13
    v_add_u32 v20, 4, v10
    v_mul_u32_u24 v21, 205, v20
    v_lshrrev_b32 v21, 10, v21
    v_mul_u32_u24 v22, 5, v21
    v_sub_u32 v20, v20, v22
    v_mul_lo_u32 v14, v21, s41
    v_lshl_add_u32 v14, v20, 8, v14
    v_lshl_add_u32 v14, v7, 3, v14
    v_add_u32 v20, 6, v10
    v_mul_u32_u24 v21, 205, v20
    v_lshrrev_b32 v21, 10, v21
    v_mul_u32_u24 v22, 5, v21
    v_sub_u32 v20, v20, v22
    v_mul_lo_u32 v15, v21, s41
    v_lshl_add_u32 v15, v20, 8, v15
    v_lshl_add_u32 v15, v7, 3, v15
    s_lshl_b32 s38, s43, 3
    s_add_u32 s38, s38, s36
    v_add_u32 v10, s38, v8
    v_add_u32 v20, 0, v10
    v_mul_u32_u24 v21, 205, v20
    v_lshrrev_b32 v21, 10, v21
    v_mul_u32_u24 v22, 5, v21
    v_sub_u32 v20, v20, v22
    v_mul_lo_u32 v16, v21, s41
    v_lshl_add_u32 v16, v20, 8, v16
    v_lshl_add_u32 v16, v7, 3, v16
    v_add_u32 v20, 2, v10
    v_mul_u32_u24 v21, 205, v20
    v_lshrrev_b32 v21, 10, v21
    v_mul_u32_u24 v22, 5, v21
    v_sub_u32 v20, v20, v22
    v_mul_lo_u32 v17, v21, s41
    v_lshl_add_u32 v17, v20, 8, v17
    v_lshl_add_u32 v17, v7, 3, v17
    v_add_u32 v20, 4, v10
    v_mul_u32_u24 v21, 205, v20
    v_lshrrev_b32 v21, 10, v21
    v_mul_u32_u24 v22, 5, v21
    v_sub_u32 v20, v20, v22
    v_mul_lo_u32 v18, v21, s41
    v_lshl_add_u32 v18, v20, 8, v18
    v_lshl_add_u32 v18, v7, 3, v18
    v_add_u32 v20, 6, v10
    v_mul_u32_u24 v21, 205, v20
    v_lshrrev_b32 v21, 10, v21
    v_mul_u32_u24 v22, 5, v21
    v_sub_u32 v20, v20, v22
    v_mul_lo_u32 v19, v21, s41
    v_lshl_add_u32 v19, v20, 8, v19
    v_lshl_add_u32 v19, v7, 3, v19
    s_barrier
    ds_read_b64_tr_b16 v[40:41], v6 offset:0
    ds_read_b64_tr_b16 v[42:43], v6 offset:1024
    ds_read_b128 v[32:35], v2 offset:0
    ds_read_b128 v[36:39], v2 offset:4096
    ds_read_b64_tr_b16 v[44:45], v11 offset:0
    ds_read_b64_tr_b16 v[46:47], v11 offset:1024
    s_waitcnt lgkmcnt(0)
    v_mfma_f32_32x32x16_bf16 v[64:79], v[40:43], v[32:35], 0
    ds_read_b64_tr_b16 v[56:57], v6 offset:4096
    ds_read_b64_tr_b16 v[58:59], v6 offset:5120
    v_mfma_f32_32x32x16_bf16 v[80:95], v[40:43], v[36:39], 0
    ds_read_b128 v[48:51], v3 offset:0
    ds_read_b128 v[52:55], v3 offset:4096
    v_mfma_f32_32x32x16_bf16 v[96:111], v[44:47], v[32:35], 0
    ds_read_b64_tr_b16 v[60:61], v11 offset:4096
    ds_read_b64_tr_b16 v[62:63], v11 offset:5120
    v_mfma_f32_16x16x32_bf16 v[28:31], v[24:27], v[40:43], 0
    v_mfma_f32_32x32x16_bf16 v[112:127], v[44:47], v[36:39], 0
    s_waitcnt lgkmcnt(0)
    v_mfma_f32_32x32x16_bf16 v[64:79], v[56:59], v[48:51], v[64:79]
    ds_read_b64_tr_b16 v[40:41], v6 offset:8192
    ds_read_b64_tr_b16 v[42:43], v6 offset:9216
    v_mfma_f32_32x32x16_bf16 v[80:95], v[56:59], v[52:55], v[80:95]
    ds_read_b128 v[32:35], v4 offset:0
    ds_read_b128 v[36:39], v4 offset:4096
    v_mfma_f32_32x32x16_bf16 v[96:111], v[60:63], v[48:51], v[96:111]
    ds_read_b64_tr_b16 v[44:45], v11 offset:8192
    ds_read_b64_tr_b16 v[46:47], v11 offset:9216
    v_mfma_f32_16x16x32_bf16 v[28:31], v[24:27], v[56:59], v[28:31]
    v_mfma_f32_32x32x16_bf16 v[112:127], v[60:63], v[52:55], v[112:127]
    s_waitcnt lgkmcnt(0)
    v_mfma_f32_32x32x16_bf16 v[64:79], v[40:43], v[32:35], v[64:79]
    ds_read_b64_tr_b16 v[56:57], v6 offset:12288
    ds_read_b64_tr_b16 v[58:59], v6 offset:13312
    v_mfma_f32_32x32x16_bf16 v[80:95], v[40:43], v[36:39], v[80:95]
    ds_read_b128 v[48:51], v5 offset:0
    ds_read_b128 v[52:55], v5 offset:4096
    v_mfma_f32_32x32x16_bf16 v[96:111], v[44:47], v[32:35], v[96:111]
    ds_read_b64_tr_b16 v[60:61], v11 offset:12288
    ds_read_b64_tr_b16 v[62:63], v11 offset:13312
    v_mfma_f32_16x16x32_bf16 v[28:31], v[24:27], v[40:43], v[28:31]
    v_mfma_f32_32x32x16_bf16 v[112:127], v[44:47], v[36:39], v[112:127]
    s_waitcnt lgkmcnt(0)
    s_barrier
    v_mfma_f32_32x32x16_bf16 v[64:79], v[56:59], v[48:51], v[64:79]
    ds_read_b64_tr_b16 v[40:41], v6 offset:32768
    ds_read_b64_tr_b16 v[42:43], v6 offset:33792
    v_mfma_f32_32x32x16_bf16 v[80:95], v[56:59], v[52:55], v[80:95]
    ds_read_b128 v[32:35], v2 offset:32768
    ds_read_b128 v[36:39], v2 offset:36864
    v_mfma_f32_32x32x16_bf16 v[96:111], v[60:63], v[48:51], v[96:111]
    ds_read_b64_tr_b16 v[44:45], v11 offset:32768
    ds_read_b64_tr_b16 v[46:47], v11 offset:33792
    v_mfma_f32_16x16x32_bf16 v[28:31], v[24:27], v[56:59], v[28:31]
    v_mfma_f32_32x32x16_bf16 v[112:127], v[60:63], v[52:55], v[112:127]
    s_waitcnt lgkmcnt(0)
    v_mfma_f32_32x32x16_bf16 v[64:79], v[40:43], v[32:35], v[64:79]
    ds_read_b64_tr_b16 v[56:57], v6 offset:36864
    ds_read_b64_tr_b16 v[58:59], v6 offset:37888
    v_mfma_f32_32x32x16_bf16 v[80:95], v[40:43], v[36:39], v[80:95]
    ds_read_b128 v[48:51], v3 offset:32768
    ds_read_b128 v[52:55], v3 offset:36864
    v_mfma_f32_32x32x16_bf16 v[96:111], v[44:47], v[32:35], v[96:111]
    ds_read_b64_tr_b16 v[60:61], v11 offset:36864
    ds_read_b64_tr_b16 v[62:63], v11 offset:37888
    v_mfma_f32_16x16x32_bf16 v[28:31], v[24:27], v[40:43], v[28:31]
    v_mfma_f32_32x32x16_bf16 v[112:127], v[44:47], v[36:39], v[112:127]
    s_waitcnt lgkmcnt(0)
    v_mfma_f32_32x32x16_bf16 v[64:79], v[56:59], v[48:51], v[64:79]
    ds_read_b64_tr_b16 v[40:41], v6 offset:40960
    ds_read_b64_tr_b16 v[42:43], v6 offset:41984
    v_mfma_f32_32x32x16_bf16 v[80:95], v[56:59], v[52:55], v[80:95]
    ds_read_b128 v[32:35], v4 offset:32768
    ds_read_b128 v[36:39], v4 offset:36864
    v_mfma_f32_32x32x16_bf16 v[96:111], v[60:63], v[48:51], v[96:111]
    ds_read_b64_tr_b16 v[44:45], v11 offset:40960
    ds_read_b64_tr_b16 v[46:47], v11 offset:41984
    v_mfma_f32_16x16x32_bf16 v[28:31], v[24:27], v[56:59], v[28:31]
    v_mfma_f32_32x32x16_bf16 v[112:127], v[60:63], v[52:55], v[112:127]
    s_waitcnt lgkmcnt(0)
    v_mfma_f32_32x32x16_bf16 v[64:79], v[40:43], v[32:35], v[64:79]
    ds_read_b64_tr_b16 v[56:57], v6 offset:45056
    ds_read_b64_tr_b16 v[58:59], v6 offset:46080
    v_mfma_f32_32x32x16_bf16 v[80:95], v[40:43], v[36:39], v[80:95]
    ds_read_b128 v[48:51], v5 offset:32768
    ds_read_b128 v[52:55], v5 offset:36864
    v_mfma_f32_32x32x16_bf16 v[96:111], v[44:47], v[32:35], v[96:111]
    ds_read_b64_tr_b16 v[60:61], v11 offset:45056
    ds_read_b64_tr_b16 v[62:63], v11 offset:46080
    v_mfma_f32_16x16x32_bf16 v[28:31], v[24:27], v[40:43], v[28:31]
    v_mfma_f32_32x32x16_bf16 v[112:127], v[44:47], v[36:39], v[112:127]
    s_waitcnt lgkmcnt(0)
    s_barrier
    v_mfma_f32_32x32x16_bf16 v[64:79], v[56:59], v[48:51], v[64:79]
    ds_read_b64_tr_b16 v[40:41], v164 offset:0
    ds_read_b64_tr_b16 v[42:43], v164 offset:1024
    v_mfma_f32_32x32x16_bf16 v[80:95], v[56:59], v[52:55], v[80:95]
    ds_read_b128 v[32:35], v160 offset:0
    ds_read_b128 v[36:39], v160 offset:4096
    v_mfma_f32_32x32x16_bf16 v[96:111], v[60:63], v[48:51], v[96:111]
    ds_read_b64_tr_b16 v[44:45], v165 offset:0
    ds_read_b64_tr_b16 v[46:47], v165 offset:1024
    v_mfma_f32_16x16x32_bf16 v[28:31], v[24:27], v[56:59], v[28:31]
    v_mfma_f32_32x32x16_bf16 v[112:127], v[60:63], v[52:55], v[112:127]
    s_waitcnt lgkmcnt(0)
    v_mfma_f32_32x32x16_bf16 v[64:79], v[40:43], v[32:35], v[64:79]
    ds_read_b64_tr_b16 v[56:57], v164 offset:4096
    ds_read_b64_tr_b16 v[58:59], v164 offset:5120
    v_mfma_f32_32x32x16_bf16 v[80:95], v[40:43], v[36:39], v[80:95]
    ds_read_b128 v[48:51], v161 offset:0
    ds_read_b128 v[52:55], v161 offset:4096
    v_mfma_f32_32x32x16_bf16 v[96:111], v[44:47], v[32:35], v[96:111]
    ds_read_b64_tr_b16 v[60:61], v165 offset:4096
    ds_read_b64_tr_b16 v[62:63], v165 offset:5120
    v_mfma_f32_16x16x32_bf16 v[28:31], v[24:27], v[40:43], v[28:31]
    v_mfma_f32_32x32x16_bf16 v[112:127], v[44:47], v[36:39], v[112:127]
    s_waitcnt lgkmcnt(0)
    v_mfma_f32_32x32x16_bf16 v[64:79], v[56:59], v[48:51], v[64:79]
    ds_read_b64_tr_b16 v[40:41], v164 offset:8192
    ds_read_b64_tr_b16 v[42:43], v164 offset:9216
    v_mfma_f32_32x32x16_bf16 v[80:95], v[56:59], v[52:55], v[80:95]
    ds_read_b128 v[32:35], v162 offset:0
    ds_read_b128 v[36:39], v162 offset:4096
    v_mfma_f32_32x32x16_bf16 v[96:111], v[60:63], v[48:51], v[96:111]
    ds_read_b64_tr_b16 v[44:45], v165 offset:8192
    ds_read_b64_tr_b16 v[46:47], v165 offset:9216
    v_mfma_f32_16x16x32_bf16 v[28:31], v[24:27], v[56:59], v[28:31]
    v_mfma_f32_32x32x16_bf16 v[112:127], v[60:63], v[52:55], v[112:127]
    s_waitcnt lgkmcnt(0)
    v_mfma_f32_32x32x16_bf16 v[64:79], v[40:43], v[32:35], v[64:79]
    ds_read_b64_tr_b16 v[56:57], v164 offset:12288
    ds_read_b64_tr_b16 v[58:59], v164 offset:13312
    v_mfma_f32_32x32x16_bf16 v[80:95], v[40:43], v[36:39], v[80:95]
    ds_read_b128 v[48:51], v163 offset:0
    ds_read_b128 v[52:55], v163 offset:4096
    v_mfma_f32_32x32x16_bf16 v[96:111], v[44:47], v[32:35], v[96:111]
    ds_read_b64_tr_b16 v[60:61], v165 offset:12288
    ds_read_b64_tr_b16 v[62:63], v165 offset:13312
    v_mfma_f32_16x16x32_bf16 v[28:31], v[24:27], v[40:43], v[28:31]
    v_mfma_f32_32x32x16_bf16 v[112:127], v[44:47], v[36:39], v[112:127]
    s_waitcnt lgkmcnt(0)
    s_barrier
    v_mfma_f32_32x32x16_bf16 v[64:79], v[56:59], v[48:51], v[64:79]
    ds_read_b64_tr_b16 v[40:41], v164 offset:32768
    ds_read_b64_tr_b16 v[42:43], v164 offset:33792
    v_mfma_f32_32x32x16_bf16 v[80:95], v[56:59], v[52:55], v[80:95]
    ds_read_b128 v[32:35], v160 offset:32768
    ds_read_b128 v[36:39], v160 offset:36864
    v_mfma_f32_32x32x16_bf16 v[96:111], v[60:63], v[48:51], v[96:111]
    ds_read_b64_tr_b16 v[44:45], v165 offset:32768
    ds_read_b64_tr_b16 v[46:47], v165 offset:33792
    v_mfma_f32_16x16x32_bf16 v[28:31], v[24:27], v[56:59], v[28:31]
    v_mfma_f32_32x32x16_bf16 v[112:127], v[60:63], v[52:55], v[112:127]
    s_waitcnt lgkmcnt(0)
    v_mfma_f32_32x32x16_bf16 v[64:79], v[40:43], v[32:35], v[64:79]
    ds_read_b64_tr_b16 v[56:57], v164 offset:36864
    ds_read_b64_tr_b16 v[58:59], v164 offset:37888
    v_mfma_f32_32x32x16_bf16 v[80:95], v[40:43], v[36:39], v[80:95]
    ds_read_b128 v[48:51], v161 offset:32768
    ds_read_b128 v[52:55], v161 offset:36864
    v_mfma_f32_32x32x16_bf16 v[96:111], v[44:47], v[32:35], v[96:111]
    ds_read_b64_tr_b16 v[60:61], v165 offset:36864
    ds_read_b64_tr_b16 v[62:63], v165 offset:37888
    v_mfma_f32_16x16x32_bf16 v[28:31], v[24:27], v[40:43], v[28:31]
    v_mfma_f32_32x32x16_bf16 v[112:127], v[44:47], v[36:39], v[112:127]
    s_waitcnt lgkmcnt(0)
    v_mfma_f32_32x32x16_bf16 v[64:79], v[56:59], v[48:51], v[64:79]
    ds_read_b64_tr_b16 v[40:41], v164 offset:40960
    ds_read_b64_tr_b16 v[42:43], v164 offset:41984
    v_mfma_f32_32x32x16_bf16 v[80:95], v[56:59], v[52:55], v[80:95]
    ds_read_b128 v[32:35], v162 offset:32768
    ds_read_b128 v[36:39], v162 offset:36864
    v_mfma_f32_32x32x16_bf16 v[96:111], v[60:63], v[48:51], v[96:111]
    ds_read_b64_tr_b16 v[44:45], v165 offset:40960
    ds_read_b64_tr_b16 v[46:47], v165 offset:41984
    v_mfma_f32_16x16x32_bf16 v[28:31], v[24:27], v[56:59], v[28:31]
    v_mfma_f32_32x32x16_bf16 v[112:127], v[60:63], v[52:55], v[112:127]
    s_waitcnt lgkmcnt(0)
    v_mfma_f32_32x32x16_bf16 v[64:79], v[40:43], v[32:35], v[64:79]
    ds_read_b64_tr_b16 v[56:57], v164 offset:45056
    ds_read_b64_tr_b16 v[58:59], v164 offset:46080
    v_mfma_f32_32x32x16_bf16 v[80:95], v[40:43], v[36:39], v[80:95]
    ds_read_b128 v[48:51], v163 offset:32768
    ds_read_b128 v[52:55], v163 offset:36864
    v_mfma_f32_32x32x16_bf16 v[96:111], v[44:47], v[32:35], v[96:111]
    ds_read_b64_tr_b16 v[60:61], v165 offset:45056
    ds_read_b64_tr_b16 v[62:63], v165 offset:46080
    v_mfma_f32_16x16x32_bf16 v[28:31], v[24:27], v[40:43], v[28:31]
    v_mfma_f32_32x32x16_bf16 v[112:127], v[44:47], v[36:39], v[112:127]
    s_waitcnt lgkmcnt(0)
    s_barrier
    v_mfma_f32_32x32x16_bf16 v[64:79], v[56:59], v[48:51], v[64:79]
    ds_read_b64_tr_b16 v[40:41], v6 offset:0
    ds_read_b64_tr_b16 v[42:43], v6 offset:1024
    v_mfma_f32_32x32x16_bf16 v[80:95], v[56:59], v[52:55], v[80:95]
    ds_read_b128 v[32:35], v2 offset:0
    ds_read_b128 v[36:39], v2 offset:4096
    v_mfma_f32_32x32x16_bf16 v[96:111], v[60:63], v[48:51], v[96:111]
    ds_read_b64_tr_b16 v[44:45], v11 offset:0
    ds_read_b64_tr_b16 v[46:47], v11 offset:1024
    v_mfma_f32_16x16x32_bf16 v[28:31], v[24:27], v[56:59], v[28:31]
    v_mfma_f32_32x32x16_bf16 v[112:127], v[60:63], v[52:55], v[112:127]
    s_waitcnt lgkmcnt(0)
    v_mfma_f32_32x32x16_bf16 v[64:79], v[40:43], v[32:35], v[64:79]
    ds_read_b64_tr_b16 v[56:57], v6 offset:4096
    ds_read_b64_tr_b16 v[58:59], v6 offset:5120
    v_mfma_f32_32x32x16_bf16 v[80:95], v[40:43], v[36:39], v[80:95]
    ds_read_b128 v[48:51], v3 offset:0
    ds_read_b128 v[52:55], v3 offset:4096
    v_mfma_f32_32x32x16_bf16 v[96:111], v[44:47], v[32:35], v[96:111]
    ds_read_b64_tr_b16 v[60:61], v11 offset:4096
    ds_read_b64_tr_b16 v[62:63], v11 offset:5120
    v_mfma_f32_16x16x32_bf16 v[28:31], v[24:27], v[40:43], v[28:31]
    v_mfma_f32_32x32x16_bf16 v[112:127], v[44:47], v[36:39], v[112:127]
    s_waitcnt lgkmcnt(0)
    v_mfma_f32_32x32x16_bf16 v[64:79], v[56:59], v[48:51], v[64:79]
    ds_read_b64_tr_b16 v[40:41], v6 offset:8192
    ds_read_b64_tr_b16 v[42:43], v6 offset:9216
    v_mfma_f32_32x32x16_bf16 v[80:95], v[56:59], v[52:55], v[80:95]
    ds_read_b128 v[32:35], v4 offset:0
    ds_read_b128 v[36:39], v4 offset:4096
    v_mfma_f32_32x32x16_bf16 v[96:111], v[60:63], v[48:51], v[96:111]
    ds_read_b64_tr_b16 v[44:45], v11 offset:8192
    ds_read_b64_tr_b16 v[46:47], v11 offset:9216
    v_mfma_f32_16x16x32_bf16 v[28:31], v[24:27], v[56:59], v[28:31]
    v_mfma_f32_32x32x16_bf16 v[112:127], v[60:63], v[52:55], v[112:127]
    s_waitcnt lgkmcnt(0)
    v_mfma_f32_32x32x16_bf16 v[64:79], v[40:43], v[32:35], v[64:79]
    ds_read_b64_tr_b16 v[56:57], v6 offset:12288
    ds_read_b64_tr_b16 v[58:59], v6 offset:13312
    v_mfma_f32_32x32x16_bf16 v[80:95], v[40:43], v[36:39], v[80:95]
    ds_read_b128 v[48:51], v5 offset:0
    ds_read_b128 v[52:55], v5 offset:4096
    v_mfma_f32_32x32x16_bf16 v[96:111], v[44:47], v[32:35], v[96:111]
    ds_read_b64_tr_b16 v[60:61], v11 offset:12288
    ds_read_b64_tr_b16 v[62:63], v11 offset:13312
    v_mfma_f32_16x16x32_bf16 v[28:31], v[24:27], v[40:43], v[28:31]
    v_mfma_f32_32x32x16_bf16 v[112:127], v[44:47], v[36:39], v[112:127]
    s_waitcnt lgkmcnt(0)
    s_barrier
    v_mfma_f32_32x32x16_bf16 v[64:79], v[56:59], v[48:51], v[64:79]
    ds_read_b64_tr_b16 v[40:41], v6 offset:32768
    ds_read_b64_tr_b16 v[42:43], v6 offset:33792
    v_mfma_f32_32x32x16_bf16 v[80:95], v[56:59], v[52:55], v[80:95]
    ds_read_b128 v[32:35], v2 offset:32768
    ds_read_b128 v[36:39], v2 offset:36864
    v_mfma_f32_32x32x16_bf16 v[96:111], v[60:63], v[48:51], v[96:111]
    ds_read_b64_tr_b16 v[44:45], v11 offset:32768
    ds_read_b64_tr_b16 v[46:47], v11 offset:33792
    v_mfma_f32_16x16x32_bf16 v[28:31], v[24:27], v[56:59], v[28:31]
    v_mfma_f32_32x32x16_bf16 v[112:127], v[60:63], v[52:55], v[112:127]
    s_waitcnt lgkmcnt(0)
    v_mfma_f32_32x32x16_bf16 v[64:79], v[40:43], v[32:35], v[64:79]
    ds_read_b64_tr_b16 v[56:57], v6 offset:36864
    ds_read_b64_tr_b16 v[58:59], v6 offset:37888
    v_mfma_f32_32x32x16_bf16 v[80:95], v[40:43], v[36:39], v[80:95]
    ds_read_b128 v[48:51], v3 offset:32768
    ds_read_b128 v[52:55], v3 offset:36864
    v_mfma_f32_32x32x16_bf16 v[96:111], v[44:47], v[32:35], v[96:111]
    ds_read_b64_tr_b16 v[60:61], v11 offset:36864
    ds_read_b64_tr_b16 v[62:63], v11 offset:37888
    v_mfma_f32_16x16x32_bf16 v[28:31], v[24:27], v[40:43], v[28:31]
    v_mfma_f32_32x32x16_bf16 v[112:127], v[44:47], v[36:39], v[112:127]
    s_waitcnt lgkmcnt(0)
    v_mfma_f32_32x32x16_bf16 v[64:79], v[56:59], v[48:51], v[64:79]
    ds_read_b64_tr_b16 v[40:41], v6 offset:40960
    ds_read_b64_tr_b16 v[42:43], v6 offset:41984
    v_mfma_f32_32x32x16_bf16 v[80:95], v[56:59], v[52:55], v[80:95]
    ds_read_b128 v[32:35], v4 offset:32768
    ds_read_b128 v[36:39], v4 offset:36864
    v_mfma_f32_32x32x16_bf16 v[96:111], v[60:63], v[48:51], v[96:111]
    ds_read_b64_tr_b16 v[44:45], v11 offset:40960
    ds_read_b64_tr_b16 v[46:47], v11 offset:41984
    v_mfma_f32_16x16x32_bf16 v[28:31], v[24:27], v[56:59], v[28:31]
    v_mfma_f32_32x32x16_bf16 v[112:127], v[60:63], v[52:55], v[112:127]
    s_waitcnt lgkmcnt(0)
    v_mfma_f32_32x32x16_bf16 v[64:79], v[40:43], v[32:35], v[64:79]
    ds_read_b64_tr_b16 v[56:57], v6 offset:45056
    ds_read_b64_tr_b16 v[58:59], v6 offset:46080
    v_mfma_f32_32x32x16_bf16 v[80:95], v[40:43], v[36:39], v[80:95]
    ds_read_b128 v[48:51], v5 offset:32768
    ds_read_b128 v[52:55], v5 offset:36864
    v_mfma_f32_32x32x16_bf16 v[96:111], v[44:47], v[32:35], v[96:111]
    ds_read_b64_tr_b16 v[60:61], v11 offset:45056
    ds_read_b64_tr_b16 v[62:63], v11 offset:46080
    v_mfma_f32_16x16x32_bf16 v[28:31], v[24:27], v[40:43], v[28:31]
    v_mfma_f32_32x32x16_bf16 v[112:127], v[44:47], v[36:39], v[112:127]
    s_waitcnt lgkmcnt(0)
    s_barrier
    v_mfma_f32_32x32x16_bf16 v[64:79], v[56:59], v[48:51], v[64:79]
    ds_read_b64_tr_b16 v[40:41], v164 offset:0
    ds_read_b64_tr_b16 v[42:43], v164 offset:1024
    v_mfma_f32_32x32x16_bf16 v[80:95], v[56:59], v[52:55], v[80:95]
    ds_read_b128 v[32:35], v160 offset:0
    ds_read_b128 v[36:39], v160 offset:4096
    v_mfma_f32_32x32x16_bf16 v[96:111], v[60:63], v[48:51], v[96:111]
    ds_read_b64_tr_b16 v[44:45], v165 offset:0
    ds_read_b64_tr_b16 v[46:47], v165 offset:1024
    v_mfma_f32_16x16x32_bf16 v[28:31], v[24:27], v[56:59], v[28:31]
    v_mfma_f32_32x32x16_bf16 v[112:127], v[60:63], v[52:55], v[112:127]
    s_waitcnt lgkmcnt(0)
    v_mfma_f32_32x32x16_bf16 v[64:79], v[40:43], v[32:35], v[64:79]
    ds_read_b64_tr_b16 v[56:57], v164 offset:4096
    ds_read_b64_tr_b16 v[58:59], v164 offset:5120
    v_mfma_f32_32x32x16_bf16 v[80:95], v[40:43], v[36:39], v[80:95]
    ds_read_b128 v[48:51], v161 offset:0
    ds_read_b128 v[52:55], v161 offset:4096
    v_mfma_f32_32x32x16_bf16 v[96:111], v[44:47], v[32:35], v[96:111]
    ds_read_b64_tr_b16 v[60:61], v165 offset:4096
    ds_read_b64_tr_b16 v[62:63], v165 offset:5120
    v_mfma_f32_16x16x32_bf16 v[28:31], v[24:27], v[40:43], v[28:31]
    v_mfma_f32_32x32x16_bf16 v[112:127], v[44:47], v[36:39], v[112:127]
    s_waitcnt lgkmcnt(0)
    v_and_b32 v128, 15, v1
    v_lshlrev_b32 v128, 2, v128
    v_add_u32 v128, 128, v128
    v_mov_b32 v129, 1
    s_cmp_lg_u32 s3, 3
    s_cbranch_scc1 SF6
    buffer_load_dword v130, v128, s[76:79], 0 offen sc1
SF6:
    v_mfma_f32_32x32x16_bf16 v[64:79], v[56:59], v[48:51], v[64:79]
    ds_read_b64_tr_b16 v[40:41], v164 offset:8192
    ds_read_b64_tr_b16 v[42:43], v164 offset:9216
    v_mfma_f32_32x32x16_bf16 v[80:95], v[56:59], v[52:55], v[80:95]
    ds_read_b128 v[32:35], v162 offset:0
    ds_read_b128 v[36:39], v162 offset:4096
    v_mfma_f32_32x32x16_bf16 v[96:111], v[60:63], v[48:51], v[96:111]
    ds_read_b64_tr_b16 v[44:45], v165 offset:8192
    ds_read_b64_tr_b16 v[46:47], v165 offset:9216
    v_mfma_f32_16x16x32_bf16 v[28:31], v[24:27], v[56:59], v[28:31]
    v_mfma_f32_32x32x16_bf16 v[112:127], v[60:63], v[52:55], v[112:127]
    s_waitcnt lgkmcnt(0)
    v_mfma_f32_32x32x16_bf16 v[64:79], v[40:43], v[32:35], v[64:79]
    ds_read_b64_tr_b16 v[56:57], v164 offset:12288
    ds_read_b64_tr_b16 v[58:59], v164 offset:13312
    v_mfma_f32_32x32x16_bf16 v[80:95], v[40:43], v[36:39], v[80:95]
    ds_read_b128 v[48:51], v163 offset:0
    ds_read_b128 v[52:55], v163 offset:4096
    v_mfma_f32_32x32x16_bf16 v[96:111], v[44:47], v[32:35], v[96:111]
    ds_read_b64_tr_b16 v[60:61], v165 offset:12288
    ds_read_b64_tr_b16 v[62:63], v165 offset:13312
    v_mfma_f32_16x16x32_bf16 v[28:31], v[24:27], v[40:43], v[28:31]
    v_mfma_f32_32x32x16_bf16 v[112:127], v[44:47], v[36:39], v[112:127]
    s_waitcnt lgkmcnt(0)
    s_barrier
    v_mfma_f32_32x32x16_bf16 v[64:79], v[56:59], v[48:51], v[64:79]
    ds_read_b64_tr_b16 v[40:41], v164 offset:32768
    ds_read_b64_tr_b16 v[42:43], v164 offset:33792
    v_mfma_f32_32x32x16_bf16 v[80:95], v[56:59], v[52:55], v[80:95]
    ds_read_b128 v[32:35], v160 offset:32768
    ds_read_b128 v[36:39], v160 offset:36864
    v_mfma_f32_32x32x16_bf16 v[96:111], v[60:63], v[48:51], v[96:111]
    ds_read_b64_tr_b16 v[44:45], v165 offset:32768
    ds_read_b64_tr_b16 v[46:47], v165 offset:33792
    v_mfma_f32_16x16x32_bf16 v[28:31], v[24:27], v[56:59], v[28:31]
    v_mfma_f32_32x32x16_bf16 v[112:127], v[60:63], v[52:55], v[112:127]
    s_waitcnt lgkmcnt(0)
    v_mfma_f32_32x32x16_bf16 v[64:79], v[40:43], v[32:35], v[64:79]
    ds_read_b64_tr_b16 v[56:57], v164 offset:36864
    ds_read_b64_tr_b16 v[58:59], v164 offset:37888
    v_mfma_f32_32x32x16_bf16 v[80:95], v[40:43], v[36:39], v[80:95]
    ds_read_b128 v[48:51], v161 offset:32768
    ds_read_b128 v[52:55], v161 offset:36864
    v_mfma_f32_32x32x16_bf16 v[96:111], v[44:47], v[32:35], v[96:111]
    ds_read_b64_tr_b16 v[60:61], v165 offset:36864
    ds_read_b64_tr_b16 v[62:63], v165 offset:37888
    v_mfma_f32_16x16x32_bf16 v[28:31], v[24:27], v[40:43], v[28:31]
    v_mfma_f32_32x32x16_bf16 v[112:127], v[44:47], v[36:39], v[112:127]
    s_waitcnt lgkmcnt(0)
    v_mfma_f32_32x32x16_bf16 v[64:79], v[56:59], v[48:51], v[64:79]
    ds_read_b64_tr_b16 v[40:41], v164 offset:40960
    ds_read_b64_tr_b16 v[42:43], v164 offset:41984
    v_mfma_f32_32x32x16_bf16 v[80:95], v[56:59], v[52:55], v[80:95]
    ds_read_b128 v[32:35], v162 offset:32768
    ds_read_b128 v[36:39], v162 offset:36864
    v_mfma_f32_32x32x16_bf16 v[96:111], v[60:63], v[48:51], v[96:111]
    ds_read_b64_tr_b16 v[44:45], v165 offset:40960
    ds_read_b64_tr_b16 v[46:47], v165 offset:41984
    v_mfma_f32_16x16x32_bf16 v[28:31], v[24:27], v[56:59], v[28:31]
    v_mfma_f32_32x32x16_bf16 v[112:127], v[60:63], v[52:55], v[112:127]
    s_waitcnt lgkmcnt(0)
    v_mfma_f32_32x32x16_bf16 v[64:79], v[40:43], v[32:35], v[64:79]
    ds_read_b64_tr_b16 v[56:57], v164 offset:45056
    ds_read_b64_tr_b16 v[58:59], v164 offset:46080
    v_mfma_f32_32x32x16_bf16 v[80:95], v[40:43], v[36:39], v[80:95]
    ds_read_b128 v[48:51], v163 offset:32768
    ds_read_b128 v[52:55], v163 offset:36864
    v_mfma_f32_32x32x16_bf16 v[96:111], v[44:47], v[32:35], v[96:111]
    ds_read_b64_tr_b16 v[60:61], v165 offset:45056
    ds_read_b64_tr_b16 v[62:63], v165 offset:46080
    v_mfma_f32_16x16x32_bf16 v[28:31], v[24:27], v[40:43], v[28:31]
    v_mfma_f32_32x32x16_bf16 v[112:127], v[44:47], v[36:39], v[112:127]
    s_waitcnt lgkmcnt(0)
    s_barrier
    v_mfma_f32_32x32x16_bf16 v[64:79], v[56:59], v[48:51], v[64:79]
    ds_read_b64_tr_b16 v[40:41], v6 offset:0
    ds_read_b64_tr_b16 v[42:43], v6 offset:1024
    v_mfma_f32_32x32x16_bf16 v[80:95], v[56:59], v[52:55], v[80:95]
    ds_read_b128 v[32:35], v2 offset:0
    ds_read_b128 v[36:39], v2 offset:4096
    v_mfma_f32_32x32x16_bf16 v[96:111], v[60:63], v[48:51], v[96:111]
    ds_read_b64_tr_b16 v[44:45], v11 offset:0
    ds_read_b64_tr_b16 v[46:47], v11 offset:1024
    v_mfma_f32_16x16x32_bf16 v[28:31], v[24:27], v[56:59], v[28:31]
    v_mfma_f32_32x32x16_bf16 v[112:127], v[60:63], v[52:55], v[112:127]
    s_waitcnt lgkmcnt(0)
    s_cmp_lg_u32 s3, 3
    s_cbranch_scc1 SL7
    s_waitcnt vmcnt(0)
    v_cmp_gt_u32 vcc, v129, v130
    s_nop 1
    s_cbranch_vccz SL7_GO
POLL8:
    buffer_load_dword v130, v128, s[76:79], 0 offen sc1
    s_waitcnt vmcnt(0)
    v_cmp_gt_u32 vcc, v129, v130
    s_nop 1
    s_cbranch_vccz POLL8_OK
    s_add_u32 s101, s101, 1
    s_cmp_gt_u32 s101, 0x40000
    s_cbranch_scc1 K_END
    s_sleep 4
    s_branch POLL8
POLL8_OK:
SL7_GO:
    s_mul_i32 s36, s32, 1536
    s_add_u32 s36, s36, 20860928
    v_lshlrev_b32 v128, 3, v1
    buffer_load_dwordx2 v[130:131], v128, s[16:19], s36 offen sc1
    buffer_load_dwordx2 v[132:133], v128, s[16:19], s36 offen offset:512 sc1
    buffer_load_dwordx2 v[134:135], v128, s[16:19], s36 offen offset:1024 sc1
    v_add_u32 v128, 131072, v128
SL7:
    v_mfma_f32_32x32x16_bf16 v[64:79], v[40:43], v[32:35], v[64:79]
    ds_read_b64_tr_b16 v[56:57], v6 offset:4096
    ds_read_b64_tr_b16 v[58:59], v6 offset:5120
    v_mfma_f32_32x32x16_bf16 v[80:95], v[40:43], v[36:39], v[80:95]
    ds_read_b128 v[48:51], v3 offset:0
    ds_read_b128 v[52:55], v3 offset:4096
    v_mfma_f32_32x32x16_bf16 v[96:111], v[44:47], v[32:35], v[96:111]
    ds_read_b64_tr_b16 v[60:61], v11 offset:4096
    ds_read_b64_tr_b16 v[62:63], v11 offset:5120
    v_mfma_f32_16x16x32_bf16 v[28:31], v[24:27], v[40:43], v[28:31]
    v_mfma_f32_32x32x16_bf16 v[112:127], v[44:47], v[36:39], v[112:127]
    s_waitcnt lgkmcnt(0)
    v_mfma_f32_32x32x16_bf16 v[64:79], v[56:59], v[48:51], v[64:79]
    ds_read_b64_tr_b16 v[40:41], v6 offset:8192
    ds_read_b64_tr_b16 v[42:43], v6 offset:9216
    v_mfma_f32_32x32x16_bf16 v[80:95], v[56:59], v[52:55], v[80:95]
    ds_read_b128 v[32:35], v4 offset:0
    ds_read_b128 v[36:39], v4 offset:4096
    v_mfma_f32_32x32x16_bf16 v[96:111], v[60:63], v[48:51], v[96:111]
    ds_read_b64_tr_b16 v[44:45], v11 offset:8192
    ds_read_b64_tr_b16 v[46:47], v11 offset:9216
    v_mfma_f32_16x16x32_bf16 v[28:31], v[24:27], v[56:59], v[28:31]
    v_mfma_f32_32x32x16_bf16 v[112:127], v[60:63], v[52:55], v[112:127]
    s_waitcnt lgkmcnt(0)
    v_mfma_f32_32x32x16_bf16 v[64:79], v[40:43], v[32:35], v[64:79]
    ds_read_b64_tr_b16 v[56:57], v6 offset:12288
    ds_read_b64_tr_b16 v[58:59], v6 offset:13312
    v_mfma_f32_32x32x16_bf16 v[80:95], v[40:43], v[36:39], v[80:95]
    ds_read_b128 v[48:51], v5 offset:0
    ds_read_b128 v[52:55], v5 offset:4096
    v_mfma_f32_32x32x16_bf16 v[96:111], v[44:47], v[32:35], v[96:111]
    ds_read_b64_tr_b16 v[60:61], v11 offset:12288
    ds_read_b64_tr_b16 v[62:63], v11 offset:13312
    v_mfma_f32_16x16x32_bf16 v[28:31], v[24:27], v[40:43], v[28:31]
    v_mfma_f32_32x32x16_bf16 v[112:127], v[44:47], v[36:39], v[112:127]
    s_waitcnt lgkmcnt(0)
    s_barrier
    v_mfma_f32_32x32x16_bf16 v[64:79], v[56:59], v[48:51], v[64:79]
    ds_read_b64_tr_b16 v[40:41], v6 offset:32768
    ds_read_b64_tr_b16 v[42:43], v6 offset:33792
    v_mfma_f32_32x32x16_bf16 v[80:95], v[56:59], v[52:55], v[80:95]
    ds_read_b128 v[32:35], v2 offset:32768
    ds_read_b128 v[36:39], v2 offset:36864
    v_mfma_f32_32x32x16_bf16 v[96:111], v[60:63], v[48:51], v[96:111]
    ds_read_b64_tr_b16 v[44:45], v11 offset:32768
    ds_read_b64_tr_b16 v[46:47], v11 offset:33792
    v_mfma_f32_16x16x32_bf16 v[28:31], v[24:27], v[56:59], v[28:31]
    v_mfma_f32_32x32x16_bf16 v[112:127], v[60:63], v[52:55], v[112:127]
    s_waitcnt lgkmcnt(0)
    v_mfma_f32_32x32x16_bf16 v[64:79], v[40:43], v[32:35], v[64:79]
    ds_read_b64_tr_b16 v[56:57], v6 offset:36864
    ds_read_b64_tr_b16 v[58:59], v6 offset:37888
    v_mfma_f32_32x32x16_bf16 v[80:95], v[40:43], v[36:39], v[80:95]
    ds_read_b128 v[48:51], v3 offset:32768
    ds_read_b128 v[52:55], v3 offset:36864
    v_mfma_f32_32x32x16_bf16 v[96:111], v[44:47], v[32:35], v[96:111]
    ds_read_b64_tr_b16 v[60:61], v11 offset:36864
    ds_read_b64_tr_b16 v[62:63], v11 offset:37888
    v_mfma_f32_16x16x32_bf16 v[28:31], v[24:27], v[40:43], v[28:31]
    v_mfma_f32_32x32x16_bf16 v[112:127], v[44:47], v[36:39], v[112:127]
    s_waitcnt lgkmcnt(0)
    v_mfma_f32_32x32x16_bf16 v[64:79], v[56:59], v[48:51], v[64:79]
    ds_read_b64_tr_b16 v[40:41], v6 offset:40960
    ds_read_b64_tr_b16 v[42:43], v6 offset:41984
    v_mfma_f32_32x32x16_bf16 v[80:95], v[56:59], v[52:55], v[80:95]
    ds_read_b128 v[32:35], v4 offset:32768
    ds_read_b128 v[36:39], v4 offset:36864
    v_mfma_f32_32x32x16_bf16 v[96:111], v[60:63], v[48:51], v[96:111]
    ds_read_b64_tr_b16 v[44:45], v11 offset:40960
    ds_read_b64_tr_b16 v[46:47], v11 offset:41984
    v_mfma_f32_16x16x32_bf16 v[28:31], v[24:27], v[56:59], v[28:31]
    v_mfma_f32_32x32x16_bf16 v[112:127], v[60:63], v[52:55], v[112:127]
    s_waitcnt lgkmcnt(0)
    v_mfma_f32_32x32x16_bf16 v[64:79], v[40:43], v[32:35], v[64:79]
    ds_read_b64_tr_b16 v[56:57], v6 offset:45056
    ds_read_b64_tr_b16 v[58:59], v6 offset:46080
    v_mfma_f32_32x32x16_bf16 v[80:95], v[40:43], v[36:39], v[80:95]
    ds_read_b128 v[48:51], v5 offset:32768
    ds_read_b128 v[52:55], v5 offset:36864
    v_mfma_f32_32x32x16_bf16 v[96:111], v[44:47], v[32:35], v[96:111]
    ds_read_b64_tr_b16 v[60:61], v11 offset:45056
    ds_read_b64_tr_b16 v[62:63], v11 offset:46080
    v_mfma_f32_16x16x32_bf16 v[28:31], v[24:27], v[40:43], v[28:31]
    v_mfma_f32_32x32x16_bf16 v[112:127], v[44:47], v[36:39], v[112:127]
    s_waitcnt lgkmcnt(0)
    v_mfma_f32_32x32x16_bf16 v[64:79], v[56:59], v[48:51], v[64:79]
    v_mfma_f32_32x32x16_bf16 v[80:95], v[56:59], v[52:55], v[80:95]
    v_mfma_f32_32x32x16_bf16 v[96:111], v[60:63], v[48:51], v[96:111]
    v_mfma_f32_16x16x32_bf16 v[28:31], v[24:27], v[56:59], v[28:31]
    v_mfma_f32_32x32x16_bf16 v[112:127], v[60:63], v[52:55], v[112:127]
    s_cmp_lg_u32 s3, 3
    s_cbranch_scc1 SS9
    s_waitcnt vmcnt(0)
    ds_write_b64 v128, v[130:131]
    ds_write_b64 v128, v[132:133] offset:512
    ds_write_b64 v128, v[134:135] offset:1024
SS9:
    s_lshl_b32 s36, s35, 8
    s_lshl_b32 s37, s34, 7
    s_add_u32 s36, s36, s37
    s_add_u32 s36, s36, 132608
    v_lshl_add_u32 v9, v1, 2, s36
    s_mov_b64 exec, 0xffff
    s_nop 3
    ds_write_b32 v9, v28
    ds_write_b32 v9, v29 offset:64
    s_mov_b64 exec, -1
    s_waitcnt vmcnt(0) lgkmcnt(0)
    s_barrier
    s_lshl_b32 s36, s34, 8
    s_add_u32 s36, s36, 131072
    v_lshl_add_u32 v9, v7, 2, s36
    s_lshl_b32 s36, s35, 8
    s_lshl_b32 s37, s34, 7
    s_add_u32 s36, s36, s37
    s_add_u32 s36, s36, 132608
    v_lshl_add_u32 v10, v8, 4, s36
    v_xor_b32 v28, 0x80, v10
    ds_read_b32 v20, v9
    ds_read_b32 v21, v9 offset:128
    ds_read_b32 v22, v9 offset:512
    ds_read_b32 v23, v9 offset:640
    ds_read_b128 v[128:131], v10 offset:0
    ds_read_b128 v[132:135], v10 offset:32
    ds_read_b128 v[136:139], v10 offset:64
    ds_read_b128 v[140:143], v10 offset:96
    ds_read_b128 v[144:147], v28 offset:0
    ds_read_b128 v[148:151], v28 offset:32
    ds_read_b128 v[152:155], v28 offset:64
    ds_read_b128 v[156:159], v28 offset:96
    s_cmp_lt_u32 s33, 5
    s_cselect_b32 s36, 0x3ea52b5c, 1.0
    s_waitcnt lgkmcnt(0)
    v_mul_f32 v22, s36, v22
    v_mul_f32 v23, s36, v23
    v_fma_f32 v64, -v20, v128, v64
    v_fma_f32 v65, -v20, v129, v65
    v_fma_f32 v66, -v20, v130, v66
    v_fma_f32 v67, -v20, v131, v67
    v_mul_f32 v64, v22, v64
    v_mul_f32 v65, v22, v65
    v_mul_f32 v66, v22, v66
    v_mul_f32 v67, v22, v67
    v_cvt_pk_bf16_f32 v64, v64, v65
    v_cvt_pk_bf16_f32 v65, v66, v67
    buffer_store_dwordx2 v[64:65], v12, s[16:19], s44 offen sc1
    v_fma_f32 v68, -v20, v132, v68
    v_fma_f32 v69, -v20, v133, v69
    v_fma_f32 v70, -v20, v134, v70
    v_fma_f32 v71, -v20, v135, v71
    v_mul_f32 v68, v22, v68
    v_mul_f32 v69, v22, v69
    v_mul_f32 v70, v22, v70
    v_mul_f32 v71, v22, v71
    v_cvt_pk_bf16_f32 v68, v68, v69
    v_cvt_pk_bf16_f32 v69, v70, v71
    buffer_store_dwordx2 v[68:69], v13, s[16:19], s44 offen sc1
    v_fma_f32 v72, -v20, v136, v72
    v_fma_f32 v73, -v20, v137, v73
    v_fma_f32 v74, -v20, v138, v74
    v_fma_f32 v75, -v20, v139, v75
    v_mul_f32 v72, v22, v72
    v_mul_f32 v73, v22, v73
    v_mul_f32 v74, v22, v74
    v_mul_f32 v75, v22, v75
    v_cvt_pk_bf16_f32 v72, v72, v73
    v_cvt_pk_bf16_f32 v73, v74, v75
    buffer_store_dwordx2 v[72:73], v14, s[16:19], s44 offen sc1
    v_fma_f32 v76, -v20, v140, v76
    v_fma_f32 v77, -v20, v141, v77
    v_fma_f32 v78, -v20, v142, v78
    v_fma_f32 v79, -v20, v143, v79
    v_mul_f32 v76, v22, v76
    v_mul_f32 v77, v22, v77
    v_mul_f32 v78, v22, v78
    v_mul_f32 v79, v22, v79
    v_cvt_pk_bf16_f32 v76, v76, v77
    v_cvt_pk_bf16_f32 v77, v78, v79
    buffer_store_dwordx2 v[76:77], v15, s[16:19], s44 offen sc1
    v_fma_f32 v96, -v20, v144, v96
    v_fma_f32 v97, -v20, v145, v97
    v_fma_f32 v98, -v20, v146, v98
    v_fma_f32 v99, -v20, v147, v99
    v_mul_f32 v96, v22, v96
    v_mul_f32 v97, v22, v97
    v_mul_f32 v98, v22, v98
    v_mul_f32 v99, v22, v99
    v_cvt_pk_bf16_f32 v96, v96, v97
    v_cvt_pk_bf16_f32 v97, v98, v99
    buffer_store_dwordx2 v[96:97], v16, s[16:19], s44 offen sc1
    v_fma_f32 v100, -v20, v148, v100
    v_fma_f32 v101, -v20, v149, v101
    v_fma_f32 v102, -v20, v150, v102
    v_fma_f32 v103, -v20, v151, v103
    v_mul_f32 v100, v22, v100
    v_mul_f32 v101, v22, v101
    v_mul_f32 v102, v22, v102
    v_mul_f32 v103, v22, v103
    v_cvt_pk_bf16_f32 v100, v100, v101
    v_cvt_pk_bf16_f32 v101, v102, v103
    buffer_store_dwordx2 v[100:101], v17, s[16:19], s44 offen sc1
    v_fma_f32 v104, -v20, v152, v104
    v_fma_f32 v105, -v20, v153, v105
    v_fma_f32 v106, -v20, v154, v106
    v_fma_f32 v107, -v20, v155, v107
    v_mul_f32 v104, v22, v104
    v_mul_f32 v105, v22, v105
    v_mul_f32 v106, v22, v106
    v_mul_f32 v107, v22, v107
    v_cvt_pk_bf16_f32 v104, v104, v105
    v_cvt_pk_bf16_f32 v105, v106, v107
    buffer_store_dwordx2 v[104:105], v18, s[16:19], s44 offen sc1
    v_fma_f32 v108, -v20, v156, v108
    v_fma_f32 v109, -v20, v157, v109
    v_fma_f32 v110, -v20, v158, v110
    v_fma_f32 v111, -v20, v159, v111
    v_mul_f32 v108, v22, v108
    v_mul_f32 v109, v22, v109
    v_mul_f32 v110, v22, v110
    v_mul_f32 v111, v22, v111
    v_cvt_pk_bf16_f32 v108, v108, v109
    v_cvt_pk_bf16_f32 v109, v110, v111
    buffer_store_dwordx2 v[108:109], v19, s[16:19], s44 offen sc1
    v_fma_f32 v80, -v21, v128, v80
    v_fma_f32 v81, -v21, v129, v81
    v_fma_f32 v82, -v21, v130, v82
    v_fma_f32 v83, -v21, v131, v83
    v_mul_f32 v80, v23, v80
    v_mul_f32 v81, v23, v81
    v_mul_f32 v82, v23, v82
    v_mul_f32 v83, v23, v83
    v_cvt_pk_bf16_f32 v80, v80, v81
    v_cvt_pk_bf16_f32 v81, v82, v83
    buffer_store_dwordx2 v[80:81], v12, s[16:19], s45 offen sc1
    v_fma_f32 v84, -v21, v132, v84
    v_fma_f32 v85, -v21, v133, v85
    v_fma_f32 v86, -v21, v134, v86
    v_fma_f32 v87, -v21, v135, v87
    v_mul_f32 v84, v23, v84
    v_mul_f32 v85, v23, v85
    v_mul_f32 v86, v23, v86
    v_mul_f32 v87, v23, v87
    v_cvt_pk_bf16_f32 v84, v84, v85
    v_cvt_pk_bf16_f32 v85, v86, v87
    buffer_store_dwordx2 v[84:85], v13, s[16:19], s45 offen sc1
    v_fma_f32 v88, -v21, v136, v88
    v_fma_f32 v89, -v21, v137, v89
    v_fma_f32 v90, -v21, v138, v90
    v_fma_f32 v91, -v21, v139, v91
    v_mul_f32 v88, v23, v88
    v_mul_f32 v89, v23, v89
    v_mul_f32 v90, v23, v90
    v_mul_f32 v91, v23, v91
    v_cvt_pk_bf16_f32 v88, v88, v89
    v_cvt_pk_bf16_f32 v89, v90, v91
    buffer_store_dwordx2 v[88:89], v14, s[16:19], s45 offen sc1
    v_fma_f32 v92, -v21, v140, v92
    v_fma_f32 v93, -v21, v141, v93
    v_fma_f32 v94, -v21, v142, v94
    v_fma_f32 v95, -v21, v143, v95
    v_mul_f32 v92, v23, v92
    v_mul_f32 v93, v23, v93
    v_mul_f32 v94, v23, v94
    v_mul_f32 v95, v23, v95
    v_cvt_pk_bf16_f32 v92, v92, v93
    v_cvt_pk_bf16_f32 v93, v94, v95
    buffer_store_dwordx2 v[92:93], v15, s[16:19], s45 offen sc1
    v_fma_f32 v112, -v21, v144, v112
    v_fma_f32 v113, -v21, v145, v113
    v_fma_f32 v114, -v21, v146, v114
    v_fma_f32 v115, -v21, v147, v115
    v_mul_f32 v112, v23, v112
    v_mul_f32 v113, v23, v113
    v_mul_f32 v114, v23, v114
    v_mul_f32 v115, v23, v115
    v_cvt_pk_bf16_f32 v112, v112, v113
    v_cvt_pk_bf16_f32 v113, v114, v115
    buffer_store_dwordx2 v[112:113], v16, s[16:19], s45 offen sc1
    v_fma_f32 v116, -v21, v148, v116
    v_fma_f32 v117, -v21, v149, v117
    v_fma_f32 v118, -v21, v150, v118
    v_fma_f32 v119, -v21, v151, v119
    v_mul_f32 v116, v23, v116
    v_mul_f32 v117, v23, v117
    v_mul_f32 v118, v23, v118
    v_mul_f32 v119, v23, v119
    v_cvt_pk_bf16_f32 v116, v116, v117
    v_cvt_pk_bf16_f32 v117, v118, v119
    buffer_store_dwordx2 v[116:117], v17, s[16:19], s45 offen sc1
    v_fma_f32 v120, -v21, v152, v120
    v_fma_f32 v121, -v21, v153, v121
    v_fma_f32 v122, -v21, v154, v122
    v_fma_f32 v123, -v21, v155, v123
    v_mul_f32 v120, v23, v120
    v_mul_f32 v121, v23, v121
    v_mul_f32 v122, v23, v122
    v_mul_f32 v123, v23, v123
    v_cvt_pk_bf16_f32 v120, v120, v121
    v_cvt_pk_bf16_f32 v121, v122, v123
    buffer_store_dwordx2 v[120:121], v18, s[16:19], s45 offen sc1
    v_fma_f32 v124, -v21, v156, v124
    v_fma_f32 v125, -v21, v157, v125
    v_fma_f32 v126, -v21, v158, v126
    v_fma_f32 v127, -v21, v159, v127
    v_mul_f32 v124, v23, v124
    v_mul_f32 v125, v23, v125
    v_mul_f32 v126, v23, v126
    v_mul_f32 v127, v23, v127
    v_cvt_pk_bf16_f32 v124, v124, v125
    v_cvt_pk_bf16_f32 v125, v126, v127
    buffer_store_dwordx2 v[124:125], v19, s[16:19], s45 offen sc1
    s_branch M_G2
M_V:
    s_sub_u32 s36, s33, 10
    s_lshl_b32 s36, s36, 7
    s_lshl_b32 s37, s35, 6
    s_add_u32 s36, s36, s37
    s_lshl_b32 s37, s32, 2
    s_lshl_b32 s38, s34, 1
    s_add_u32 s37, s37, s38
    s_mul_i32 s44, s37, 2560
    s_add_u32 s44, s44, 2622720
    s_mov_b32 s37, 163840
    s_lshl_b32 s38, s34, 5
    s_add_u32 s38, s38, s36
    v_add_u32 v20, s38, v7
    v_mul_u32_u24 v21, 3277, v20
    v_lshrrev_b32 v21, 16, v21
    v_mul_u32_u24 v22, 20, v21
    v_sub_u32 v20, v20, v22
    v_mul_lo_u32 v12, v21, s37
    v_lshl_add_u32 v12, v20, 4, v12
    v_mul_u32_u24 v22, 320, v8
    v_add_u32 v12, v12, v22
    s_lshl_b32 s38, s43, 5
    s_add_u32 s38, s38, s36
    v_add_u32 v20, s38, v7
    v_mul_u32_u24 v21, 3277, v20
    v_lshrrev_b32 v21, 16, v21
    v_mul_u32_u24 v22, 20, v21
    v_sub_u32 v20, v20, v22
    v_mul_lo_u32 v13, v21, s37
    v_lshl_add_u32 v13, v20, 4, v13
    v_mul_u32_u24 v22, 320, v8
    v_add_u32 v13, v13, v22
    s_barrier
    ds_read_b64_tr_b16 v[40:41], v6 offset:0
    ds_read_b64_tr_b16 v[42:43], v6 offset:1024
    ds_read_b128 v[32:35], v2 offset:0
    ds_read_b128 v[36:39], v2 offset:4096
    ds_read_b64_tr_b16 v[44:45], v11 offset:0
    ds_read_b64_tr_b16 v[46:47], v11 offset:1024
    s_waitcnt lgkmcnt(0)
    v_mfma_f32_32x32x16_bf16 v[64:79], v[32:35], v[40:43], 0
    ds_read_b64_tr_b16 v[56:57], v6 offset:4096
    ds_read_b64_tr_b16 v[58:59], v6 offset:5120
    v_mfma_f32_32x32x16_bf16 v[96:111], v[36:39], v[40:43], 0
    ds_read_b128 v[48:51], v3 offset:0
    ds_read_b128 v[52:55], v3 offset:4096
    v_mfma_f32_32x32x16_bf16 v[80:95], v[32:35], v[44:47], 0
    ds_read_b64_tr_b16 v[60:61], v11 offset:4096
    ds_read_b64_tr_b16 v[62:63], v11 offset:5120
    v_mfma_f32_16x16x32_bf16 v[28:31], v[24:27], v[40:43], 0
    v_mfma_f32_32x32x16_bf16 v[112:127], v[36:39], v[44:47], 0
    s_waitcnt lgkmcnt(0)
    v_mfma_f32_32x32x16_bf16 v[64:79], v[48:51], v[56:59], v[64:79]
    ds_read_b64_tr_b16 v[40:41], v6 offset:8192
    ds_read_b64_tr_b16 v[42:43], v6 offset:9216
    v_mfma_f32_32x32x16_bf16 v[96:111], v[52:55], v[56:59], v[96:111]
    ds_read_b128 v[32:35], v4 offset:0
    ds_read_b128 v[36:39], v4 offset:4096
    v_mfma_f32_32x32x16_bf16 v[80:95], v[48:51], v[60:63], v[80:95]
    ds_read_b64_tr_b16 v[44:45], v11 offset:8192
    ds_read_b64_tr_b16 v[46:47], v11 offset:9216
    v_mfma_f32_16x16x32_bf16 v[28:31], v[24:27], v[56:59], v[28:31]
    v_mfma_f32_32x32x16_bf16 v[112:127], v[52:55], v[60:63], v[112:127]
    s_waitcnt lgkmcnt(0)
    v_mfma_f32_32x32x16_bf16 v[64:79], v[32:35], v[40:43], v[64:79]
    ds_read_b64_tr_b16 v[56:57], v6 offset:12288
    ds_read_b64_tr_b16 v[58:59], v6 offset:13312
    v_mfma_f32_32x32x16_bf16 v[96:111], v[36:39], v[40:43], v[96:111]
    ds_read_b128 v[48:51], v5 offset:0
    ds_read_b128 v[52:55], v5 offset:4096
    v_mfma_f32_32x32x16_bf16 v[80:95], v[32:35], v[44:47], v[80:95]
    ds_read_b64_tr_b16 v[60:61], v11 offset:12288
    ds_read_b64_tr_b16 v[62:63], v11 offset:13312
    v_mfma_f32_16x16x32_bf16 v[28:31], v[24:27], v[40:43], v[28:31]
    v_mfma_f32_32x32x16_bf16 v[112:127], v[36:39], v[44:47], v[112:127]
    s_waitcnt lgkmcnt(0)
    s_barrier
    v_mfma_f32_32x32x16_bf16 v[64:79], v[48:51], v[56:59], v[64:79]
    ds_read_b64_tr_b16 v[40:41], v6 offset:32768
    ds_read_b64_tr_b16 v[42:43], v6 offset:33792
    v_mfma_f32_32x32x16_bf16 v[96:111], v[52:55], v[56:59], v[96:111]
    ds_read_b128 v[32:35], v2 offset:32768
    ds_read_b128 v[36:39], v2 offset:36864
    v_mfma_f32_32x32x16_bf16 v[80:95], v[48:51], v[60:63], v[80:95]
    ds_read_b64_tr_b16 v[44:45], v11 offset:32768
    ds_read_b64_tr_b16 v[46:47], v11 offset:33792
    v_mfma_f32_16x16x32_bf16 v[28:31], v[24:27], v[56:59], v[28:31]
    v_mfma_f32_32x32x16_bf16 v[112:127], v[52:55], v[60:63], v[112:127]
    s_waitcnt lgkmcnt(0)
    v_mfma_f32_32x32x16_bf16 v[64:79], v[32:35], v[40:43], v[64:79]
    ds_read_b64_tr_b16 v[56:57], v6 offset:36864
    ds_read_b64_tr_b16 v[58:59], v6 offset:37888
    v_mfma_f32_32x32x16_bf16 v[96:111], v[36:39], v[40:43], v[96:111]
    ds_read_b128 v[48:51], v3 offset:32768
    ds_read_b128 v[52:55], v3 offset:36864
    v_mfma_f32_32x32x16_bf16 v[80:95], v[32:35], v[44:47], v[80:95]
    ds_read_b64_tr_b16 v[60:61], v11 offset:36864
    ds_read_b64_tr_b16 v[62:63], v11 offset:37888
    v_mfma_f32_16x16x32_bf16 v[28:31], v[24:27], v[40:43], v[28:31]
    v_mfma_f32_32x32x16_bf16 v[112:127], v[36:39], v[44:47], v[112:127]
    s_waitcnt lgkmcnt(0)
    v_mfma_f32_32x32x16_bf16 v[64:79], v[48:51], v[56:59], v[64:79]
    ds_read_b64_tr_b16 v[40:41], v6 offset:40960
    ds_read_b64_tr_b16 v[42:43], v6 offset:41984
    v_mfma_f32_32x32x16_bf16 v[96:111], v[52:55], v[56:59], v[96:111]
    ds_read_b128 v[32:35], v4 offset:32768
    ds_read_b128 v[36:39], v4 offset:36864
    v_mfma_f32_32x32x16_bf16 v[80:95], v[48:51], v[60:63], v[80:95]
    ds_read_b64_tr_b16 v[44:45], v11 offset:40960
    ds_read_b64_tr_b16 v[46:47], v11 offset:41984
    v_mfma_f32_16x16x32_bf16 v[28:31], v[24:27], v[56:59], v[28:31]
    v_mfma_f32_32x32x16_bf16 v[112:127], v[52:55], v[60:63], v[112:127]
    s_waitcnt lgkmcnt(0)
    v_mfma_f32_32x32x16_bf16 v[64:79], v[32:35], v[40:43], v[64:79]
    ds_read_b64_tr_b16 v[56:57], v6 offset:45056
    ds_read_b64_tr_b16 v[58:59], v6 offset:46080
    v_mfma_f32_32x32x16_bf16 v[96:111], v[36:39], v[40:43], v[96:111]
    ds_read_b128 v[48:51], v5 offset:32768
    ds_read_b128 v[52:55], v5 offset:36864
    v_mfma_f32_32x32x16_bf16 v[80:95], v[32:35], v[44:47], v[80:95]
    ds_read_b64_tr_b16 v[60:61], v11 offset:45056
    ds_read_b64_tr_b16 v[62:63], v11 offset:46080
    v_mfma_f32_16x16x32_bf16 v[28:31], v[24:27], v[40:43], v[28:31]
    v_mfma_f32_32x32x16_bf16 v[112:127], v[36:39], v[44:47], v[112:127]
    s_waitcnt lgkmcnt(0)
    s_barrier
    v_mfma_f32_32x32x16_bf16 v[64:79], v[48:51], v[56:59], v[64:79]
    ds_read_b64_tr_b16 v[40:41], v164 offset:0
    ds_read_b64_tr_b16 v[42:43], v164 offset:1024
    v_mfma_f32_32x32x16_bf16 v[96:111], v[52:55], v[56:59], v[96:111]
    ds_read_b128 v[32:35], v160 offset:0
    ds_read_b128 v[36:39], v160 offset:4096
    v_mfma_f32_32x32x16_bf16 v[80:95], v[48:51], v[60:63], v[80:95]
    ds_read_b64_tr_b16 v[44:45], v165 offset:0
    ds_read_b64_tr_b16 v[46:47], v165 offset:1024
    v_mfma_f32_16x16x32_bf16 v[28:31], v[24:27], v[56:59], v[28:31]
    v_mfma_f32_32x32x16_bf16 v[112:127], v[52:55], v[60:63], v[112:127]
    s_waitcnt lgkmcnt(0)
    v_mfma_f32_32x32x16_bf16 v[64:79], v[32:35], v[40:43], v[64:79]
    ds_read_b64_tr_b16 v[56:57], v164 offset:4096
    ds_read_b64_tr_b16 v[58:59], v164 offset:5120
    v_mfma_f32_32x32x16_bf16 v[96:111], v[36:39], v[40:43], v[96:111]
    ds_read_b128 v[48:51], v161 offset:0
    ds_read_b128 v[52:55], v161 offset:4096
    v_mfma_f32_32x32x16_bf16 v[80:95], v[32:35], v[44:47], v[80:95]
    ds_read_b64_tr_b16 v[60:61], v165 offset:4096
    ds_read_b64_tr_b16 v[62:63], v165 offset:5120
    v_mfma_f32_16x16x32_bf16 v[28:31], v[24:27], v[40:43], v[28:31]
    v_mfma_f32_32x32x16_bf16 v[112:127], v[36:39], v[44:47], v[112:127]
    s_waitcnt lgkmcnt(0)
    v_mfma_f32_32x32x16_bf16 v[64:79], v[48:51], v[56:59], v[64:79]
    ds_read_b64_tr_b16 v[40:41], v164 offset:8192
    ds_read_b64_tr_b16 v[42:43], v164 offset:9216
    v_mfma_f32_32x32x16_bf16 v[96:111], v[52:55], v[56:59], v[96:111]
    ds_read_b128 v[32:35], v162 offset:0
    ds_read_b128 v[36:39], v162 offset:4096
    v_mfma_f32_32x32x16_bf16 v[80:95], v[48:51], v[60:63], v[80:95]
    ds_read_b64_tr_b16 v[44:45], v165 offset:8192
    ds_read_b64_tr_b16 v[46:47], v165 offset:9216
    v_mfma_f32_16x16x32_bf16 v[28:31], v[24:27], v[56:59], v[28:31]
    v_mfma_f32_32x32x16_bf16 v[112:127], v[52:55], v[60:63], v[112:127]
    s_waitcnt lgkmcnt(0)
    v_mfma_f32_32x32x16_bf16 v[64:79], v[32:35], v[40:43], v[64:79]
    ds_read_b64_tr_b16 v[56:57], v164 offset:12288
    ds_read_b64_tr_b16 v[58:59], v164 offset:13312
    v_mfma_f32_32x32x16_bf16 v[96:111], v[36:39], v[40:43], v[96:111]
    ds_read_b128 v[48:51], v163 offset:0
    ds_read_b128 v[52:55], v163 offset:4096
    v_mfma_f32_32x32x16_bf16 v[80:95], v[32:35], v[44:47], v[80:95]
    ds_read_b64_tr_b16 v[60:61], v165 offset:12288
    ds_read_b64_tr_b16 v[62:63], v165 offset:13312
    v_mfma_f32_16x16x32_bf16 v[28:31], v[24:27], v[40:43], v[28:31]
    v_mfma_f32_32x32x16_bf16 v[112:127], v[36:39], v[44:47], v[112:127]
    s_waitcnt lgkmcnt(0)
    s_barrier
    v_mfma_f32_32x32x16_bf16 v[64:79], v[48:51], v[56:59], v[64:79]
    ds_read_b64_tr_b16 v[40:41], v164 offset:32768
    ds_read_b64_tr_b16 v[42:43], v164 offset:33792
    v_mfma_f32_32x32x16_bf16 v[96:111], v[52:55], v[56:59], v[96:111]
    ds_read_b128 v[32:35], v160 offset:32768
    ds_read_b128 v[36:39], v160 offset:36864
    v_mfma_f32_32x32x16_bf16 v[80:95], v[48:51], v[60:63], v[80:95]
    ds_read_b64_tr_b16 v[44:45], v165 offset:32768
    ds_read_b64_tr_b16 v[46:47], v165 offset:33792
    v_mfma_f32_16x16x32_bf16 v[28:31], v[24:27], v[56:59], v[28:31]
    v_mfma_f32_32x32x16_bf16 v[112:127], v[52:55], v[60:63], v[112:127]
    s_waitcnt lgkmcnt(0)
    v_mfma_f32_32x32x16_bf16 v[64:79], v[32:35], v[40:43], v[64:79]
    ds_read_b64_tr_b16 v[56:57], v164 offset:36864
    ds_read_b64_tr_b16 v[58:59], v164 offset:37888
    v_mfma_f32_32x32x16_bf16 v[96:111], v[36:39], v[40:43], v[96:111]
    ds_read_b128 v[48:51], v161 offset:32768
    ds_read_b128 v[52:55], v161 offset:36864
    v_mfma_f32_32x32x16_bf16 v[80:95], v[32:35], v[44:47], v[80:95]
    ds_read_b64_tr_b16 v[60:61], v165 offset:36864
    ds_read_b64_tr_b16 v[62:63], v165 offset:37888
    v_mfma_f32_16x16x32_bf16 v[28:31], v[24:27], v[40:43], v[28:31]
    v_mfma_f32_32x32x16_bf16 v[112:127], v[36:39], v[44:47], v[112:127]
    s_waitcnt lgkmcnt(0)
    v_mfma_f32_32x32x16_bf16 v[64:79], v[48:51], v[56:59], v[64:79]
    ds_read_b64_tr_b16 v[40:41], v164 offset:40960
    ds_read_b64_tr_b16 v[42:43], v164 offset:41984
    v_mfma_f32_32x32x16_bf16 v[96:111], v[52:55], v[56:59], v[96:111]
    ds_read_b128 v[32:35], v162 offset:32768
    ds_read_b128 v[36:39], v162 offset:36864
    v_mfma_f32_32x32x16_bf16 v[80:95], v[48:51], v[60:63], v[80:95]
    ds_read_b64_tr_b16 v[44:45], v165 offset:40960
    ds_read_b64_tr_b16 v[46:47], v165 offset:41984
    v_mfma_f32_16x16x32_bf16 v[28:31], v[24:27], v[56:59], v[28:31]
    v_mfma_f32_32x32x16_bf16 v[112:127], v[52:55], v[60:63], v[112:127]
    s_waitcnt lgkmcnt(0)
    v_mfma_f32_32x32x16_bf16 v[64:79], v[32:35], v[40:43], v[64:79]
    ds_read_b64_tr_b16 v[56:57], v164 offset:45056
    ds_read_b64_tr_b16 v[58:59], v164 offset:46080
    v_mfma_f32_32x32x16_bf16 v[96:111], v[36:39], v[40:43], v[96:111]
    ds_read_b128 v[48:51], v163 offset:32768
    ds_read_b128 v[52:55], v163 offset:36864
    v_mfma_f32_32x32x16_bf16 v[80:95], v[32:35], v[44:47], v[80:95]
    ds_read_b64_tr_b16 v[60:61], v165 offset:45056
    ds_read_b64_tr_b16 v[62:63], v165 offset:46080
    v_mfma_f32_16x16x32_bf16 v[28:31], v[24:27], v[40:43], v[28:31]
    v_mfma_f32_32x32x16_bf16 v[112:127], v[36:39], v[44:47], v[112:127]
    s_waitcnt lgkmcnt(0)
    s_barrier
    v_mfma_f32_32x32x16_bf16 v[64:79], v[48:51], v[56:59], v[64:79]
    ds_read_b64_tr_b16 v[40:41], v6 offset:0
    ds_read_b64_tr_b16 v[42:43], v6 offset:1024
    v_mfma_f32_32x32x16_bf16 v[96:111], v[52:55], v[56:59], v[96:111]
    ds_read_b128 v[32:35], v2 offset:0
    ds_read_b128 v[36:39], v2 offset:4096
    v_mfma_f32_32x32x16_bf16 v[80:95], v[48:51], v[60:63], v[80:95]
    ds_read_b64_tr_b16 v[44:45], v11 offset:0
    ds_read_b64_tr_b16 v[46:47], v11 offset:1024
    v_mfma_f32_16x16x32_bf16 v[28:31], v[24:27], v[56:59], v[28:31]
    v_mfma_f32_32x32x16_bf16 v[112:127], v[52:55], v[60:63], v[112:127]
    s_waitcnt lgkmcnt(0)
    v_mfma_f32_32x32x16_bf16 v[64:79], v[32:35], v[40:43], v[64:79]
    ds_read_b64_tr_b16 v[56:57], v6 offset:4096
    ds_read_b64_tr_b16 v[58:59], v6 offset:5120
    v_mfma_f32_32x32x16_bf16 v[96:111], v[36:39], v[40:43], v[96:111]
    ds_read_b128 v[48:51], v3 offset:0
    ds_read_b128 v[52:55], v3 offset:4096
    v_mfma_f32_32x32x16_bf16 v[80:95], v[32:35], v[44:47], v[80:95]
    ds_read_b64_tr_b16 v[60:61], v11 offset:4096
    ds_read_b64_tr_b16 v[62:63], v11 offset:5120
    v_mfma_f32_16x16x32_bf16 v[28:31], v[24:27], v[40:43], v[28:31]
    v_mfma_f32_32x32x16_bf16 v[112:127], v[36:39], v[44:47], v[112:127]
    s_waitcnt lgkmcnt(0)
    v_mfma_f32_32x32x16_bf16 v[64:79], v[48:51], v[56:59], v[64:79]
    ds_read_b64_tr_b16 v[40:41], v6 offset:8192
    ds_read_b64_tr_b16 v[42:43], v6 offset:9216
    v_mfma_f32_32x32x16_bf16 v[96:111], v[52:55], v[56:59], v[96:111]
    ds_read_b128 v[32:35], v4 offset:0
    ds_read_b128 v[36:39], v4 offset:4096
    v_mfma_f32_32x32x16_bf16 v[80:95], v[48:51], v[60:63], v[80:95]
    ds_read_b64_tr_b16 v[44:45], v11 offset:8192
    ds_read_b64_tr_b16 v[46:47], v11 offset:9216
    v_mfma_f32_16x16x32_bf16 v[28:31], v[24:27], v[56:59], v[28:31]
    v_mfma_f32_32x32x16_bf16 v[112:127], v[52:55], v[60:63], v[112:127]
    s_waitcnt lgkmcnt(0)
    v_mfma_f32_32x32x16_bf16 v[64:79], v[32:35], v[40:43], v[64:79]
    ds_read_b64_tr_b16 v[56:57], v6 offset:12288
    ds_read_b64_tr_b16 v[58:59], v6 offset:13312
    v_mfma_f32_32x32x16_bf16 v[96:111], v[36:39], v[40:43], v[96:111]
    ds_read_b128 v[48:51], v5 offset:0
    ds_read_b128 v[52:55], v5 offset:4096
    v_mfma_f32_32x32x16_bf16 v[80:95], v[32:35], v[44:47], v[80:95]
    ds_read_b64_tr_b16 v[60:61], v11 offset:12288
    ds_read_b64_tr_b16 v[62:63], v11 offset:13312
    v_mfma_f32_16x16x32_bf16 v[28:31], v[24:27], v[40:43], v[28:31]
    v_mfma_f32_32x32x16_bf16 v[112:127], v[36:39], v[44:47], v[112:127]
    s_waitcnt lgkmcnt(0)
    s_barrier
    v_mfma_f32_32x32x16_bf16 v[64:79], v[48:51], v[56:59], v[64:79]
    ds_read_b64_tr_b16 v[40:41], v6 offset:32768
    ds_read_b64_tr_b16 v[42:43], v6 offset:33792
    v_mfma_f32_32x32x16_bf16 v[96:111], v[52:55], v[56:59], v[96:111]
    ds_read_b128 v[32:35], v2 offset:32768
    ds_read_b128 v[36:39], v2 offset:36864
    v_mfma_f32_32x32x16_bf16 v[80:95], v[48:51], v[60:63], v[80:95]
    ds_read_b64_tr_b16 v[44:45], v11 offset:32768
    ds_read_b64_tr_b16 v[46:47], v11 offset:33792
    v_mfma_f32_16x16x32_bf16 v[28:31], v[24:27], v[56:59], v[28:31]
    v_mfma_f32_32x32x16_bf16 v[112:127], v[52:55], v[60:63], v[112:127]
    s_waitcnt lgkmcnt(0)
    v_mfma_f32_32x32x16_bf16 v[64:79], v[32:35], v[40:43], v[64:79]
    ds_read_b64_tr_b16 v[56:57], v6 offset:36864
    ds_read_b64_tr_b16 v[58:59], v6 offset:37888
    v_mfma_f32_32x32x16_bf16 v[96:111], v[36:39], v[40:43], v[96:111]
    ds_read_b128 v[48:51], v3 offset:32768
    ds_read_b128 v[52:55], v3 offset:36864
    v_mfma_f32_32x32x16_bf16 v[80:95], v[32:35], v[44:47], v[80:95]
    ds_read_b64_tr_b16 v[60:61], v11 offset:36864
    ds_read_b64_tr_b16 v[62:63], v11 offset:37888
    v_mfma_f32_16x16x32_bf16 v[28:31], v[24:27], v[40:43], v[28:31]
    v_mfma_f32_32x32x16_bf16 v[112:127], v[36:39], v[44:47], v[112:127]
    s_waitcnt lgkmcnt(0)
    v_mfma_f32_32x32x16_bf16 v[64:79], v[48:51], v[56:59], v[64:79]
    ds_read_b64_tr_b16 v[40:41], v6 offset:40960
    ds_read_b64_tr_b16 v[42:43], v6 offset:41984
    v_mfma_f32_32x32x16_bf16 v[96:111], v[52:55], v[56:59], v[96:111]
    ds_read_b128 v[32:35], v4 offset:32768
    ds_read_b128 v[36:39], v4 offset:36864
    v_mfma_f32_32x32x16_bf16 v[80:95], v[48:51], v[60:63], v[80:95]
    ds_read_b64_tr_b16 v[44:45], v11 offset:40960
    ds_read_b64_tr_b16 v[46:47], v11 offset:41984
    v_mfma_f32_16x16x32_bf16 v[28:31], v[24:27], v[56:59], v[28:31]
    v_mfma_f32_32x32x16_bf16 v[112:127], v[52:55], v[60:63], v[112:127]
    s_waitcnt lgkmcnt(0)
    v_mfma_f32_32x32x16_bf16 v[64:79], v[32:35], v[40:43], v[64:79]
    ds_read_b64_tr_b16 v[56:57], v6 offset:45056
    ds_read_b64_tr_b16 v[58:59], v6 offset:46080
    v_mfma_f32_32x32x16_bf16 v[96:111], v[36:39], v[40:43], v[96:111]
    ds_read_b128 v[48:51], v5 offset:32768
    ds_read_b128 v[52:55], v5 offset:36864
    v_mfma_f32_32x32x16_bf16 v[80:95], v[32:35], v[44:47], v[80:95]
    ds_read_b64_tr_b16 v[60:61], v11 offset:45056
    ds_read_b64_tr_b16 v[62:63], v11 offset:46080
    v_mfma_f32_16x16x32_bf16 v[28:31], v[24:27], v[40:43], v[28:31]
    v_mfma_f32_32x32x16_bf16 v[112:127], v[36:39], v[44:47], v[112:127]
    s_waitcnt lgkmcnt(0)
    s_barrier
    v_mfma_f32_32x32x16_bf16 v[64:79], v[48:51], v[56:59], v[64:79]
    ds_read_b64_tr_b16 v[40:41], v164 offset:0
    ds_read_b64_tr_b16 v[42:43], v164 offset:1024
    v_mfma_f32_32x32x16_bf16 v[96:111], v[52:55], v[56:59], v[96:111]
    ds_read_b128 v[32:35], v160 offset:0
    ds_read_b128 v[36:39], v160 offset:4096
    v_mfma_f32_32x32x16_bf16 v[80:95], v[48:51], v[60:63], v[80:95]
    ds_read_b64_tr_b16 v[44:45], v165 offset:0
    ds_read_b64_tr_b16 v[46:47], v165 offset:1024
    v_mfma_f32_16x16x32_bf16 v[28:31], v[24:27], v[56:59], v[28:31]
    v_mfma_f32_32x32x16_bf16 v[112:127], v[52:55], v[60:63], v[112:127]
    s_waitcnt lgkmcnt(0)
    v_mfma_f32_32x32x16_bf16 v[64:79], v[32:35], v[40:43], v[64:79]
    ds_read_b64_tr_b16 v[56:57], v164 offset:4096
    ds_read_b64_tr_b16 v[58:59], v164 offset:5120
    v_mfma_f32_32x32x16_bf16 v[96:111], v[36:39], v[40:43], v[96:111]
    ds_read_b128 v[48:51], v161 offset:0
    ds_read_b128 v[52:55], v161 offset:4096
    v_mfma_f32_32x32x16_bf16 v[80:95], v[32:35], v[44:47], v[80:95]
    ds_read_b64_tr_b16 v[60:61], v165 offset:4096
    ds_read_b64_tr_b16 v[62:63], v165 offset:5120
    v_mfma_f32_16x16x32_bf16 v[28:31], v[24:27], v[40:43], v[28:31]
    v_mfma_f32_32x32x16_bf16 v[112:127], v[36:39], v[44:47], v[112:127]
    s_waitcnt lgkmcnt(0)
    v_and_b32 v128, 15, v1
    v_lshlrev_b32 v128, 2, v128
    v_add_u32 v128, 128, v128
    v_mov_b32 v129, 1
    s_cmp_lg_u32 s3, 3
    s_cbranch_scc1 SF10
    buffer_load_dword v130, v128, s[76:79], 0 offen sc1
SF10:
    v_mfma_f32_32x32x16_bf16 v[64:79], v[48:51], v[56:59], v[64:79]
    ds_read_b64_tr_b16 v[40:41], v164 offset:8192
    ds_read_b64_tr_b16 v[42:43], v164 offset:9216
    v_mfma_f32_32x32x16_bf16 v[96:111], v[52:55], v[56:59], v[96:111]
    ds_read_b128 v[32:35], v162 offset:0
    ds_read_b128 v[36:39], v162 offset:4096
    v_mfma_f32_32x32x16_bf16 v[80:95], v[48:51], v[60:63], v[80:95]
    ds_read_b64_tr_b16 v[44:45], v165 offset:8192
    ds_read_b64_tr_b16 v[46:47], v165 offset:9216
    v_mfma_f32_16x16x32_bf16 v[28:31], v[24:27], v[56:59], v[28:31]
    v_mfma_f32_32x32x16_bf16 v[112:127], v[52:55], v[60:63], v[112:127]
    s_waitcnt lgkmcnt(0)
    v_mfma_f32_32x32x16_bf16 v[64:79], v[32:35], v[40:43], v[64:79]
    ds_read_b64_tr_b16 v[56:57], v164 offset:12288
    ds_read_b64_tr_b16 v[58:59], v164 offset:13312
    v_mfma_f32_32x32x16_bf16 v[96:111], v[36:39], v[40:43], v[96:111]
    ds_read_b128 v[48:51], v163 offset:0
    ds_read_b128 v[52:55], v163 offset:4096
    v_mfma_f32_32x32x16_bf16 v[80:95], v[32:35], v[44:47], v[80:95]
    ds_read_b64_tr_b16 v[60:61], v165 offset:12288
    ds_read_b64_tr_b16 v[62:63], v165 offset:13312
    v_mfma_f32_16x16x32_bf16 v[28:31], v[24:27], v[40:43], v[28:31]
    v_mfma_f32_32x32x16_bf16 v[112:127], v[36:39], v[44:47], v[112:127]
    s_waitcnt lgkmcnt(0)
    s_barrier
    v_mfma_f32_32x32x16_bf16 v[64:79], v[48:51], v[56:59], v[64:79]
    ds_read_b64_tr_b16 v[40:41], v164 offset:32768
    ds_read_b64_tr_b16 v[42:43], v164 offset:33792
    v_mfma_f32_32x32x16_bf16 v[96:111], v[52:55], v[56:59], v[96:111]
    ds_read_b128 v[32:35], v160 offset:32768
    ds_read_b128 v[36:39], v160 offset:36864
    v_mfma_f32_32x32x16_bf16 v[80:95], v[48:51], v[60:63], v[80:95]
    ds_read_b64_tr_b16 v[44:45], v165 offset:32768
    ds_read_b64_tr_b16 v[46:47], v165 offset:33792
    v_mfma_f32_16x16x32_bf16 v[28:31], v[24:27], v[56:59], v[28:31]
    v_mfma_f32_32x32x16_bf16 v[112:127], v[52:55], v[60:63], v[112:127]
    s_waitcnt lgkmcnt(0)
    v_mfma_f32_32x32x16_bf16 v[64:79], v[32:35], v[40:43], v[64:79]
    ds_read_b64_tr_b16 v[56:57], v164 offset:36864
    ds_read_b64_tr_b16 v[58:59], v164 offset:37888
    v_mfma_f32_32x32x16_bf16 v[96:111], v[36:39], v[40:43], v[96:111]
    ds_read_b128 v[48:51], v161 offset:32768
    ds_read_b128 v[52:55], v161 offset:36864
    v_mfma_f32_32x32x16_bf16 v[80:95], v[32:35], v[44:47], v[80:95]
    ds_read_b64_tr_b16 v[60:61], v165 offset:36864
    ds_read_b64_tr_b16 v[62:63], v165 offset:37888
    v_mfma_f32_16x16x32_bf16 v[28:31], v[24:27], v[40:43], v[28:31]
    v_mfma_f32_32x32x16_bf16 v[112:127], v[36:39], v[44:47], v[112:127]
    s_waitcnt lgkmcnt(0)
    v_mfma_f32_32x32x16_bf16 v[64:79], v[48:51], v[56:59], v[64:79]
    ds_read_b64_tr_b16 v[40:41], v164 offset:40960
    ds_read_b64_tr_b16 v[42:43], v164 offset:41984
    v_mfma_f32_32x32x16_bf16 v[96:111], v[52:55], v[56:59], v[96:111]
    ds_read_b128 v[32:35], v162 offset:32768
    ds_read_b128 v[36:39], v162 offset:36864
    v_mfma_f32_32x32x16_bf16 v[80:95], v[48:51], v[60:63], v[80:95]
    ds_read_b64_tr_b16 v[44:45], v165 offset:40960
    ds_read_b64_tr_b16 v[46:47], v165 offset:41984
    v_mfma_f32_16x16x32_bf16 v[28:31], v[24:27], v[56:59], v[28:31]
    v_mfma_f32_32x32x16_bf16 v[112:127], v[52:55], v[60:63], v[112:127]
    s_waitcnt lgkmcnt(0)
    v_mfma_f32_32x32x16_bf16 v[64:79], v[32:35], v[40:43], v[64:79]
    ds_read_b64_tr_b16 v[56:57], v164 offset:45056
    ds_read_b64_tr_b16 v[58:59], v164 offset:46080
    v_mfma_f32_32x32x16_bf16 v[96:111], v[36:39], v[40:43], v[96:111]
    ds_read_b128 v[48:51], v163 offset:32768
    ds_read_b128 v[52:55], v163 offset:36864
    v_mfma_f32_32x32x16_bf16 v[80:95], v[32:35], v[44:47], v[80:95]
    ds_read_b64_tr_b16 v[60:61], v165 offset:45056
    ds_read_b64_tr_b16 v[62:63], v165 offset:46080
    v_mfma_f32_16x16x32_bf16 v[28:31], v[24:27], v[40:43], v[28:31]
    v_mfma_f32_32x32x16_bf16 v[112:127], v[36:39], v[44:47], v[112:127]
    s_waitcnt lgkmcnt(0)
    s_barrier
    v_mfma_f32_32x32x16_bf16 v[64:79], v[48:51], v[56:59], v[64:79]
    ds_read_b64_tr_b16 v[40:41], v6 offset:0
    ds_read_b64_tr_b16 v[42:43], v6 offset:1024
    v_mfma_f32_32x32x16_bf16 v[96:111], v[52:55], v[56:59], v[96:111]
    ds_read_b128 v[32:35], v2 offset:0
    ds_read_b128 v[36:39], v2 offset:4096
    v_mfma_f32_32x32x16_bf16 v[80:95], v[48:51], v[60:63], v[80:95]
    ds_read_b64_tr_b16 v[44:45], v11 offset:0
    ds_read_b64_tr_b16 v[46:47], v11 offset:1024
    v_mfma_f32_16x16x32_bf16 v[28:31], v[24:27], v[56:59], v[28:31]
    v_mfma_f32_32x32x16_bf16 v[112:127], v[52:55], v[60:63], v[112:127]
    s_waitcnt lgkmcnt(0)
    s_cmp_lg_u32 s3, 3
    s_cbranch_scc1 SL11
    s_waitcnt vmcnt(0)
    v_cmp_gt_u32 vcc, v129, v130
    s_nop 1
    s_cbranch_vccz SL11_GO
POLL12:
    buffer_load_dword v130, v128, s[76:79], 0 offen sc1
    s_waitcnt vmcnt(0)
    v_cmp_gt_u32 vcc, v129, v130
    s_nop 1
    s_cbranch_vccz POLL12_OK
    s_add_u32 s101, s101, 1
    s_cmp_gt_u32 s101, 0x40000
    s_cbranch_scc1 K_END
    s_sleep 4
    s_branch POLL12
POLL12_OK:
SL11_GO:
    s_mul_i32 s36, s32, 1536
    s_add_u32 s36, s36, 20860928
    v_lshlrev_b32 v128, 3, v1
    buffer_load_dwordx2 v[130:131], v128, s[16:19], s36 offen sc1
    buffer_load_dwordx2 v[132:133], v128, s[16:19], s36 offen offset:512 sc1
    buffer_load_dwordx2 v[134:135], v128, s[16:19], s36 offen offset:1024 sc1
    v_add_u32 v128, 131072, v128
SL11:
    v_mfma_f32_32x32x16_bf16 v[64:79], v[32:35], v[40:43], v[64:79]
    ds_read_b64_tr_b16 v[56:57], v6 offset:4096
    ds_read_b64_tr_b16 v[58:59], v6 offset:5120
    v_mfma_f32_32x32x16_bf16 v[96:111], v[36:39], v[40:43], v[96:111]
    ds_read_b128 v[48:51], v3 offset:0
    ds_read_b128 v[52:55], v3 offset:4096
    v_mfma_f32_32x32x16_bf16 v[80:95], v[32:35], v[44:47], v[80:95]
    ds_read_b64_tr_b16 v[60:61], v11 offset:4096
    ds_read_b64_tr_b16 v[62:63], v11 offset:5120
    v_mfma_f32_16x16x32_bf16 v[28:31], v[24:27], v[40:43], v[28:31]
    v_mfma_f32_32x32x16_bf16 v[112:127], v[36:39], v[44:47], v[112:127]
    s_waitcnt lgkmcnt(0)
    v_mfma_f32_32x32x16_bf16 v[64:79], v[48:51], v[56:59], v[64:79]
    ds_read_b64_tr_b16 v[40:41], v6 offset:8192
    ds_read_b64_tr_b16 v[42:43], v6 offset:9216
    v_mfma_f32_32x32x16_bf16 v[96:111], v[52:55], v[56:59], v[96:111]
    ds_read_b128 v[32:35], v4 offset:0
    ds_read_b128 v[36:39], v4 offset:4096
    v_mfma_f32_32x32x16_bf16 v[80:95], v[48:51], v[60:63], v[80:95]
    ds_read_b64_tr_b16 v[44:45], v11 offset:8192
    ds_read_b64_tr_b16 v[46:47], v11 offset:9216
    v_mfma_f32_16x16x32_bf16 v[28:31], v[24:27], v[56:59], v[28:31]
    v_mfma_f32_32x32x16_bf16 v[112:127], v[52:55], v[60:63], v[112:127]
    s_waitcnt lgkmcnt(0)
    v_mfma_f32_32x32x16_bf16 v[64:79], v[32:35], v[40:43], v[64:79]
    ds_read_b64_tr_b16 v[56:57], v6 offset:12288
    ds_read_b64_tr_b16 v[58:59], v6 offset:13312
    v_mfma_f32_32x32x16_bf16 v[96:111], v[36:39], v[40:43], v[96:111]
    ds_read_b128 v[48:51], v5 offset:0
    ds_read_b128 v[52:55], v5 offset:4096
    v_mfma_f32_32x32x16_bf16 v[80:95], v[32:35], v[44:47], v[80:95]
    ds_read_b64_tr_b16 v[60:61], v11 offset:12288
    ds_read_b64_tr_b16 v[62:63], v11 offset:13312
    v_mfma_f32_16x16x32_bf16 v[28:31], v[24:27], v[40:43], v[28:31]
    v_mfma_f32_32x32x16_bf16 v[112:127], v[36:39], v[44:47], v[112:127]
    s_waitcnt lgkmcnt(0)
    s_barrier
    v_mfma_f32_32x32x16_bf16 v[64:79], v[48:51], v[56:59], v[64:79]
    ds_read_b64_tr_b16 v[40:41], v6 offset:32768
    ds_read_b64_tr_b16 v[42:43], v6 offset:33792
    v_mfma_f32_32x32x16_bf16 v[96:111], v[52:55], v[56:59], v[96:111]
    ds_read_b128 v[32:35], v2 offset:32768
    ds_read_b128 v[36:39], v2 offset:36864
    v_mfma_f32_32x32x16_bf16 v[80:95], v[48:51], v[60:63], v[80:95]
    ds_read_b64_tr_b16 v[44:45], v11 offset:32768
    ds_read_b64_tr_b16 v[46:47], v11 offset:33792
    v_mfma_f32_16x16x32_bf16 v[28:31], v[24:27], v[56:59], v[28:31]
    v_mfma_f32_32x32x16_bf16 v[112:127], v[52:55], v[60:63], v[112:127]
    s_waitcnt lgkmcnt(0)
    v_mfma_f32_32x32x16_bf16 v[64:79], v[32:35], v[40:43], v[64:79]
    ds_read_b64_tr_b16 v[56:57], v6 offset:36864
    ds_read_b64_tr_b16 v[58:59], v6 offset:37888
    v_mfma_f32_32x32x16_bf16 v[96:111], v[36:39], v[40:43], v[96:111]
    ds_read_b128 v[48:51], v3 offset:32768
    ds_read_b128 v[52:55], v3 offset:36864
    v_mfma_f32_32x32x16_bf16 v[80:95], v[32:35], v[44:47], v[80:95]
    ds_read_b64_tr_b16 v[60:61], v11 offset:36864
    ds_read_b64_tr_b16 v[62:63], v11 offset:37888
    v_mfma_f32_16x16x32_bf16 v[28:31], v[24:27], v[40:43], v[28:31]
    v_mfma_f32_32x32x16_bf16 v[112:127], v[36:39], v[44:47], v[112:127]
    s_waitcnt lgkmcnt(0)
    v_mfma_f32_32x32x16_bf16 v[64:79], v[48:51], v[56:59], v[64:79]
    ds_read_b64_tr_b16 v[40:41], v6 offset:40960
    ds_read_b64_tr_b16 v[42:43], v6 offset:41984
    v_mfma_f32_32x32x16_bf16 v[96:111], v[52:55], v[56:59], v[96:111]
    ds_read_b128 v[32:35], v4 offset:32768
    ds_read_b128 v[36:39], v4 offset:36864
    v_mfma_f32_32x32x16_bf16 v[80:95], v[48:51], v[60:63], v[80:95]
    ds_read_b64_tr_b16 v[44:45], v11 offset:40960
    ds_read_b64_tr_b16 v[46:47], v11 offset:41984
    v_mfma_f32_16x16x32_bf16 v[28:31], v[24:27], v[56:59], v[28:31]
    v_mfma_f32_32x32x16_bf16 v[112:127], v[52:55], v[60:63], v[112:127]
    s_waitcnt lgkmcnt(0)
    v_mfma_f32_32x32x16_bf16 v[64:79], v[32:35], v[40:43], v[64:79]
    ds_read_b64_tr_b16 v[56:57], v6 offset:45056
    ds_read_b64_tr_b16 v[58:59], v6 offset:46080
    v_mfma_f32_32x32x16_bf16 v[96:111], v[36:39], v[40:43], v[96:111]
    ds_read_b128 v[48:51], v5 offset:32768
    ds_read_b128 v[52:55], v5 offset:36864
    v_mfma_f32_32x32x16_bf16 v[80:95], v[32:35], v[44:47], v[80:95]
    ds_read_b64_tr_b16 v[60:61], v11 offset:45056
    ds_read_b64_tr_b16 v[62:63], v11 offset:46080
    v_mfma_f32_16x16x32_bf16 v[28:31], v[24:27], v[40:43], v[28:31]
    v_mfma_f32_32x32x16_bf16 v[112:127], v[36:39], v[44:47], v[112:127]
    s_waitcnt lgkmcnt(0)
    v_mfma_f32_32x32x16_bf16 v[64:79], v[48:51], v[56:59], v[64:79]
    v_mfma_f32_32x32x16_bf16 v[96:111], v[52:55], v[56:59], v[96:111]
    v_mfma_f32_32x32x16_bf16 v[80:95], v[48:51], v[60:63], v[80:95]
    v_mfma_f32_16x16x32_bf16 v[28:31], v[24:27], v[56:59], v[28:31]
    v_mfma_f32_32x32x16_bf16 v[112:127], v[52:55], v[60:63], v[112:127]
    s_cmp_lg_u32 s3, 3
    s_cbranch_scc1 SS13
    s_waitcnt vmcnt(0)
    ds_write_b64 v128, v[130:131]
    ds_write_b64 v128, v[132:133] offset:512
    ds_write_b64 v128, v[134:135] offset:1024
SS13:
    s_lshl_b32 s36, s35, 8
    s_lshl_b32 s37, s34, 7
    s_add_u32 s36, s36, s37
    s_add_u32 s36, s36, 132608
    v_lshl_add_u32 v9, v1, 2, s36
    s_mov_b64 exec, 0xffff
    s_nop 3
    ds_write_b32 v9, v28
    ds_write_b32 v9, v29 offset:64
    s_mov_b64 exec, -1
    s_waitcnt vmcnt(0) lgkmcnt(0)
    s_barrier
    s_lshl_b32 s36, s35, 8
    s_lshl_b32 s37, s34, 7
    s_add_u32 s36, s36, s37
    s_add_u32 s36, s36, 132608
    v_lshl_add_u32 v9, v7, 2, s36
    v_xor_b32 v28, 0x80, v9
    s_lshl_b32 s36, s34, 8
    s_add_u32 s36, s36, 131584
    v_lshl_add_u32 v10, v8, 4, s36
    ds_read_b32 v20, v9
    ds_read_b32 v21, v28
    ds_read_b128 v[128:131], v10 offset:0
    ds_read_b128 v[32:35], v10 offset:512
    ds_read_b128 v[132:135], v10 offset:32
    ds_read_b128 v[36:39], v10 offset:544
    ds_read_b128 v[136:139], v10 offset:64
    ds_read_b128 v[40:43], v10 offset:576
    ds_read_b128 v[140:143], v10 offset:96
    ds_read_b128 v[44:47], v10 offset:608
    ds_read_b128 v[144:147], v10 offset:128
    ds_read_b128 v[48:51], v10 offset:640
    ds_read_b128 v[148:151], v10 offset:160
    ds_read_b128 v[52:55], v10 offset:672
    ds_read_b128 v[152:155], v10 offset:192
    ds_read_b128 v[56:59], v10 offset:704
    ds_read_b128 v[156:159], v10 offset:224
    ds_read_b128 v[60:63], v10 offset:736
    s_waitcnt lgkmcnt(0)
    v_mul_f32 v64, v128, v64
    v_mul_f32 v65, v129, v65
    v_mul_f32 v66, v130, v66
    v_mul_f32 v67, v131, v67
    v_mul_f32 v68, v132, v68
    v_mul_f32 v69, v133, v69
    v_mul_f32 v70, v134, v70
    v_mul_f32 v71, v135, v71
    v_fma_f32 v64, -v32, v20, v64
    v_fma_f32 v65, -v33, v20, v65
    v_fma_f32 v66, -v34, v20, v66
    v_fma_f32 v67, -v35, v20, v67
    v_fma_f32 v68, -v36, v20, v68
    v_fma_f32 v69, -v37, v20, v69
    v_fma_f32 v70, -v38, v20, v70
    v_fma_f32 v71, -v39, v20, v71
    v_cvt_pk_bf16_f32 v64, v64, v65
    v_cvt_pk_bf16_f32 v65, v66, v67
    v_cvt_pk_bf16_f32 v66, v68, v69
    v_cvt_pk_bf16_f32 v67, v70, v71
    buffer_store_dwordx4 v[64:67], v12, s[16:19], s44 offen offset:0 sc1
    v_mul_f32 v72, v136, v72
    v_mul_f32 v73, v137, v73
    v_mul_f32 v74, v138, v74
    v_mul_f32 v75, v139, v75
    v_mul_f32 v76, v140, v76
    v_mul_f32 v77, v141, v77
    v_mul_f32 v78, v142, v78
    v_mul_f32 v79, v143, v79
    v_fma_f32 v72, -v40, v20, v72
    v_fma_f32 v73, -v41, v20, v73
    v_fma_f32 v74, -v42, v20, v74
    v_fma_f32 v75, -v43, v20, v75
    v_fma_f32 v76, -v44, v20, v76
    v_fma_f32 v77, -v45, v20, v77
    v_fma_f32 v78, -v46, v20, v78
    v_fma_f32 v79, -v47, v20, v79
    v_cvt_pk_bf16_f32 v72, v72, v73
    v_cvt_pk_bf16_f32 v73, v74, v75
    v_cvt_pk_bf16_f32 v74, v76, v77
    v_cvt_pk_bf16_f32 v75, v78, v79
    buffer_store_dwordx4 v[72:75], v12, s[16:19], s44 offen offset:640 sc1
    v_mul_f32 v80, v128, v80
    v_mul_f32 v81, v129, v81
    v_mul_f32 v82, v130, v82
    v_mul_f32 v83, v131, v83
    v_mul_f32 v84, v132, v84
    v_mul_f32 v85, v133, v85
    v_mul_f32 v86, v134, v86
    v_mul_f32 v87, v135, v87
    v_fma_f32 v80, -v32, v21, v80
    v_fma_f32 v81, -v33, v21, v81
    v_fma_f32 v82, -v34, v21, v82
    v_fma_f32 v83, -v35, v21, v83
    v_fma_f32 v84, -v36, v21, v84
    v_fma_f32 v85, -v37, v21, v85
    v_fma_f32 v86, -v38, v21, v86
    v_fma_f32 v87, -v39, v21, v87
    v_cvt_pk_bf16_f32 v80, v80, v81
    v_cvt_pk_bf16_f32 v81, v82, v83
    v_cvt_pk_bf16_f32 v82, v84, v85
    v_cvt_pk_bf16_f32 v83, v86, v87
    buffer_store_dwordx4 v[80:83], v13, s[16:19], s44 offen offset:0 sc1
    v_mul_f32 v88, v136, v88
    v_mul_f32 v89, v137, v89
    v_mul_f32 v90, v138, v90
    v_mul_f32 v91, v139, v91
    v_mul_f32 v92, v140, v92
    v_mul_f32 v93, v141, v93
    v_mul_f32 v94, v142, v94
    v_mul_f32 v95, v143, v95
    v_fma_f32 v88, -v40, v21, v88
    v_fma_f32 v89, -v41, v21, v89
    v_fma_f32 v90, -v42, v21, v90
    v_fma_f32 v91, -v43, v21, v91
    v_fma_f32 v92, -v44, v21, v92
    v_fma_f32 v93, -v45, v21, v93
    v_fma_f32 v94, -v46, v21, v94
    v_fma_f32 v95, -v47, v21, v95
    v_cvt_pk_bf16_f32 v88, v88, v89
    v_cvt_pk_bf16_f32 v89, v90, v91
    v_cvt_pk_bf16_f32 v90, v92, v93
    v_cvt_pk_bf16_f32 v91, v94, v95
    buffer_store_dwordx4 v[88:91], v13, s[16:19], s44 offen offset:640 sc1
    v_mul_f32 v96, v144, v96
    v_mul_f32 v97, v145, v97
    v_mul_f32 v98, v146, v98
    v_mul_f32 v99, v147, v99
    v_mul_f32 v100, v148, v100
    v_mul_f32 v101, v149, v101
    v_mul_f32 v102, v150, v102
    v_mul_f32 v103, v151, v103
    v_fma_f32 v96, -v48, v20, v96
    v_fma_f32 v97, -v49, v20, v97
    v_fma_f32 v98, -v50, v20, v98
    v_fma_f32 v99, -v51, v20, v99
    v_fma_f32 v100, -v52, v20, v100
    v_fma_f32 v101, -v53, v20, v101
    v_fma_f32 v102, -v54, v20, v102
    v_fma_f32 v103, -v55, v20, v103
    v_cvt_pk_bf16_f32 v96, v96, v97
    v_cvt_pk_bf16_f32 v97, v98, v99
    v_cvt_pk_bf16_f32 v98, v100, v101
    v_cvt_pk_bf16_f32 v99, v102, v103
    buffer_store_dwordx4 v[96:99], v12, s[16:19], s44 offen offset:2560 sc1
    v_mul_f32 v104, v152, v104
    v_mul_f32 v105, v153, v105
    v_mul_f32 v106, v154, v106
    v_mul_f32 v107, v155, v107
    v_mul_f32 v108, v156, v108
    v_mul_f32 v109, v157, v109
    v_mul_f32 v110, v158, v110
    v_mul_f32 v111, v159, v111
    v_fma_f32 v104, -v56, v20, v104
    v_fma_f32 v105, -v57, v20, v105
    v_fma_f32 v106, -v58, v20, v106
    v_fma_f32 v107, -v59, v20, v107
    v_fma_f32 v108, -v60, v20, v108
    v_fma_f32 v109, -v61, v20, v109
    v_fma_f32 v110, -v62, v20, v110
    v_fma_f32 v111, -v63, v20, v111
    v_cvt_pk_bf16_f32 v104, v104, v105
    v_cvt_pk_bf16_f32 v105, v106, v107
    v_cvt_pk_bf16_f32 v106, v108, v109
    v_cvt_pk_bf16_f32 v107, v110, v111
    buffer_store_dwordx4 v[104:107], v12, s[16:19], s44 offen offset:3200 sc1
    v_mul_f32 v112, v144, v112
    v_mul_f32 v113, v145, v113
    v_mul_f32 v114, v146, v114
    v_mul_f32 v115, v147, v115
    v_mul_f32 v116, v148, v116
    v_mul_f32 v117, v149, v117
    v_mul_f32 v118, v150, v118
    v_mul_f32 v119, v151, v119
    v_fma_f32 v112, -v48, v21, v112
    v_fma_f32 v113, -v49, v21, v113
    v_fma_f32 v114, -v50, v21, v114
    v_fma_f32 v115, -v51, v21, v115
    v_fma_f32 v116, -v52, v21, v116
    v_fma_f32 v117, -v53, v21, v117
    v_fma_f32 v118, -v54, v21, v118
    v_fma_f32 v119, -v55, v21, v119
    v_cvt_pk_bf16_f32 v112, v112, v113
    v_cvt_pk_bf16_f32 v113, v114, v115
    v_cvt_pk_bf16_f32 v114, v116, v117
    v_cvt_pk_bf16_f32 v115, v118, v119
    buffer_store_dwordx4 v[112:115], v13, s[16:19], s44 offen offset:2560 sc1
    v_mul_f32 v120, v152, v120
    v_mul_f32 v121, v153, v121
    v_mul_f32 v122, v154, v122
    v_mul_f32 v123, v155, v123
    v_mul_f32 v124, v156, v124
    v_mul_f32 v125, v157, v125
    v_mul_f32 v126, v158, v126
    v_mul_f32 v127, v159, v127
    v_fma_f32 v120, -v56, v21, v120
    v_fma_f32 v121, -v57, v21, v121
    v_fma_f32 v122, -v58, v21, v122
    v_fma_f32 v123, -v59, v21, v123
    v_fma_f32 v124, -v60, v21, v124
    v_fma_f32 v125, -v61, v21, v125
    v_fma_f32 v126, -v62, v21, v126
    v_fma_f32 v127, -v63, v21, v127
    v_cvt_pk_bf16_f32 v120, v120, v121
    v_cvt_pk_bf16_f32 v121, v122, v123
    v_cvt_pk_bf16_f32 v122, v124, v125
    v_cvt_pk_bf16_f32 v123, v126, v127
    buffer_store_dwordx4 v[120:123], v13, s[16:19], s44 offen offset:3200 sc1
    s_cmp_lg_u32 s33, 14
    s_cbranch_scc1 M_G2
    v_mov_b32 v12, 159312
    v_mov_b32 v13, 1
    v_mov_b32 v15, s82
    s_waitcnt vmcnt(0)
    s_mov_b64 exec, 1
    ds_add_rtn_u32 v14, v12, v13
    s_waitcnt lgkmcnt(0)
    v_readfirstlane_b32 s36, v14
    s_cmp_lg_u32 s36, 3
    s_cbranch_scc1 PUB14
    buffer_atomic_add v13, v15, s[16:19], 0 offen sc1
PUB14:
    s_mov_b64 exec, -1
    s_branch K_PREP
M_G2:
    s_setprio 3
    s_barrier
    ds_read_b64_tr_b16 v[40:41], v164 offset:0
    ds_read_b64_tr_b16 v[42:43], v164 offset:1024
    ds_read_b128 v[32:35], v160 offset:0
    ds_read_b128 v[36:39], v160 offset:4096
    ds_read_b64_tr_b16 v[44:45], v165 offset:0
    ds_read_b64_tr_b16 v[46:47], v165 offset:1024
    s_waitcnt lgkmcnt(0)
    v_mfma_f32_32x32x16_bf16 v[64:79], v[40:43], v[32:35], 0
    ds_read_b64_tr_b16 v[56:57], v164 offset:4096
    ds_read_b64_tr_b16 v[58:59], v164 offset:5120
    v_mfma_f32_32x32x16_bf16 v[80:95], v[40:43], v[36:39], 0
    ds_read_b128 v[48:51], v161 offset:0
    ds_read_b128 v[52:55], v161 offset:4096
    v_mfma_f32_32x32x16_bf16 v[96:111], v[44:47], v[32:35], 0
    ds_read_b64_tr_b16 v[60:61], v165 offset:4096
    ds_read_b64_tr_b16 v[62:63], v165 offset:5120
    v_mfma_f32_16x16x32_bf16 v[28:31], v[24:27], v[40:43], 0
    v_mfma_f32_32x32x16_bf16 v[112:127], v[44:47], v[36:39], 0
    s_waitcnt lgkmcnt(0)
    v_mfma_f32_32x32x16_bf16 v[64:79], v[56:59], v[48:51], v[64:79]
    ds_read_b64_tr_b16 v[40:41], v164 offset:8192
    ds_read_b64_tr_b16 v[42:43], v164 offset:9216
    v_mfma_f32_32x32x16_bf16 v[80:95], v[56:59], v[52:55], v[80:95]
    ds_read_b128 v[32:35], v162 offset:0
    ds_read_b128 v[36:39], v162 offset:4096
    v_mfma_f32_32x32x16_bf16 v[96:111], v[60:63], v[48:51], v[96:111]
    ds_read_b64_tr_b16 v[44:45], v165 offset:8192
    ds_read_b64_tr_b16 v[46:47], v165 offset:9216
    v_mfma_f32_16x16x32_bf16 v[28:31], v[24:27], v[56:59], v[28:31]
    v_mfma_f32_32x32x16_bf16 v[112:127], v[60:63], v[52:55], v[112:127]
    s_waitcnt lgkmcnt(0)
    v_mfma_f32_32x32x16_bf16 v[64:79], v[40:43], v[32:35], v[64:79]
    ds_read_b64_tr_b16 v[56:57], v164 offset:12288
    ds_read_b64_tr_b16 v[58:59], v164 offset:13312
    v_mfma_f32_32x32x16_bf16 v[80:95], v[40:43], v[36:39], v[80:95]
    ds_read_b128 v[48:51], v163 offset:0
    ds_read_b128 v[52:55], v163 offset:4096
    v_mfma_f32_32x32x16_bf16 v[96:111], v[44:47], v[32:35], v[96:111]
    ds_read_b64_tr_b16 v[60:61], v165 offset:12288
    ds_read_b64_tr_b16 v[62:63], v165 offset:13312
    v_mfma_f32_16x16x32_bf16 v[28:31], v[24:27], v[40:43], v[28:31]
    v_mfma_f32_32x32x16_bf16 v[112:127], v[44:47], v[36:39], v[112:127]
    s_waitcnt lgkmcnt(0)
    v_mov_b32 v128, 159312
    v_mov_b32 v129, 1
    v_mov_b32 v131, s82
    s_waitcnt vmcnt(0)
    s_mov_b64 exec, 1
    ds_add_rtn_u32 v130, v128, v129
    s_waitcnt lgkmcnt(0)
    v_readfirstlane_b32 s36, v130
    s_cmp_lg_u32 s36, 3
    s_cbranch_scc1 PUB15
    buffer_atomic_add v129, v131, s[16:19], 0 offen sc1
PUB15:
    s_mov_b64 exec, -1
    s_mov_b32 s56, s54
    s_mov_b32 s57, s55
    s_mov_b32 s58, 3456
    s_mov_b32 s59, 0x00020000
    v_lshlrev_b32 v9, 3, v8
    s_lshl_b32 s36, s33, 8
    s_lshl_b32 s37, s35, 7
    s_add_u32 s36, s36, s37
    s_lshl_b32 s37, s34, 6
    s_add_u32 s36, s36, s37
    buffer_load_dwordx2 v[12:13], v9, s[56:59], s36 offen offset:0
    buffer_load_dwordx2 v[14:15], v9, s[56:59], s36 offen offset:16
    buffer_load_dwordx2 v[16:17], v9, s[56:59], s36 offen offset:32
    buffer_load_dwordx2 v[18:19], v9, s[56:59], s36 offen offset:48
    s_lshl_b32 s36, s33, 8
    s_lshl_b32 s37, s35, 7
    s_add_u32 s36, s36, s37
    s_lshl_b32 s37, s43, 6
    s_add_u32 s36, s36, s37
    buffer_load_dwordx2 v[152:153], v9, s[56:59], s36 offen offset:0
    buffer_load_dwordx2 v[154:155], v9, s[56:59], s36 offen offset:16
    buffer_load_dwordx2 v[156:157], v9, s[56:59], s36 offen offset:32
    buffer_load_dwordx2 v[158:159], v9, s[56:59], s36 offen offset:48
    s_barrier
    v_mfma_f32_32x32x16_bf16 v[64:79], v[56:59], v[48:51], v[64:79]
    ds_read_b64_tr_b16 v[40:41], v164 offset:32768
    ds_read_b64_tr_b16 v[42:43], v164 offset:33792
    v_mfma_f32_32x32x16_bf16 v[80:95], v[56:59], v[52:55], v[80:95]
    ds_read_b128 v[32:35], v160 offset:32768
    ds_read_b128 v[36:39], v160 offset:36864
    v_mfma_f32_32x32x16_bf16 v[96:111], v[60:63], v[48:51], v[96:111]
    ds_read_b64_tr_b16 v[44:45], v165 offset:32768
    ds_read_b64_tr_b16 v[46:47], v165 offset:33792
    v_mfma_f32_16x16x32_bf16 v[28:31], v[24:27], v[56:59], v[28:31]
    v_mfma_f32_32x32x16_bf16 v[112:127], v[60:63], v[52:55], v[112:127]
    s_waitcnt lgkmcnt(0)
    v_mfma_f32_32x32x16_bf16 v[64:79], v[40:43], v[32:35], v[64:79]
    ds_read_b64_tr_b16 v[56:57], v164 offset:36864
    ds_read_b64_tr_b16 v[58:59], v164 offset:37888
    v_mfma_f32_32x32x16_bf16 v[80:95], v[40:43], v[36:39], v[80:95]
    ds_read_b128 v[48:51], v161 offset:32768
    ds_read_b128 v[52:55], v161 offset:36864
    v_mfma_f32_32x32x16_bf16 v[96:111], v[44:47], v[32:35], v[96:111]
    ds_read_b64_tr_b16 v[60:61], v165 offset:36864
    ds_read_b64_tr_b16 v[62:63], v165 offset:37888
    v_mfma_f32_16x16x32_bf16 v[28:31], v[24:27], v[40:43], v[28:31]
    v_mfma_f32_32x32x16_bf16 v[112:127], v[44:47], v[36:39], v[112:127]
    s_waitcnt lgkmcnt(0)
    v_mfma_f32_32x32x16_bf16 v[64:79], v[56:59], v[48:51], v[64:79]
    ds_read_b64_tr_b16 v[40:41], v164 offset:40960
    ds_read_b64_tr_b16 v[42:43], v164 offset:41984
    v_mfma_f32_32x32x16_bf16 v[80:95], v[56:59], v[52:55], v[80:95]
    ds_read_b128 v[32:35], v162 offset:32768
    ds_read_b128 v[36:39], v162 offset:36864
    v_mfma_f32_32x32x16_bf16 v[96:111], v[60:63], v[48:51], v[96:111]
    ds_read_b64_tr_b16 v[44:45], v165 offset:40960
    ds_read_b64_tr_b16 v[46:47], v165 offset:41984
    v_mfma_f32_16x16x32_bf16 v[28:31], v[24:27], v[56:59], v[28:31]
    v_mfma_f32_32x32x16_bf16 v[112:127], v[60:63], v[52:55], v[112:127]
    s_waitcnt lgkmcnt(0)
    v_mfma_f32_32x32x16_bf16 v[64:79], v[40:43], v[32:35], v[64:79]
    ds_read_b64_tr_b16 v[56:57], v164 offset:45056
    ds_read_b64_tr_b16 v[58:59], v164 offset:46080
    v_mfma_f32_32x32x16_bf16 v[80:95], v[40:43], v[36:39], v[80:95]
    ds_read_b128 v[48:51], v163 offset:32768
    ds_read_b128 v[52:55], v163 offset:36864
    v_mfma_f32_32x32x16_bf16 v[96:111], v[44:47], v[32:35], v[96:111]
    ds_read_b64_tr_b16 v[60:61], v165 offset:45056
    ds_read_b64_tr_b16 v[62:63], v165 offset:46080
    v_mfma_f32_16x16x32_bf16 v[28:31], v[24:27], v[40:43], v[28:31]
    v_mfma_f32_32x32x16_bf16 v[112:127], v[44:47], v[36:39], v[112:127]
    s_waitcnt lgkmcnt(0)
    s_barrier
    v_mfma_f32_32x32x16_bf16 v[64:79], v[56:59], v[48:51], v[64:79]
    ds_read_b64_tr_b16 v[40:41], v6 offset:0
    ds_read_b64_tr_b16 v[42:43], v6 offset:1024
    v_mfma_f32_32x32x16_bf16 v[80:95], v[56:59], v[52:55], v[80:95]
    ds_read_b128 v[32:35], v2 offset:0
    ds_read_b128 v[36:39], v2 offset:4096
    v_mfma_f32_32x32x16_bf16 v[96:111], v[60:63], v[48:51], v[96:111]
    ds_read_b64_tr_b16 v[44:45], v11 offset:0
    ds_read_b64_tr_b16 v[46:47], v11 offset:1024
    v_mfma_f32_16x16x32_bf16 v[28:31], v[24:27], v[56:59], v[28:31]
    v_mfma_f32_32x32x16_bf16 v[112:127], v[60:63], v[52:55], v[112:127]
    s_waitcnt lgkmcnt(0)
    v_mfma_f32_32x32x16_bf16 v[64:79], v[40:43], v[32:35], v[64:79]
    ds_read_b64_tr_b16 v[56:57], v6 offset:4096
    ds_read_b64_tr_b16 v[58:59], v6 offset:5120
    v_mfma_f32_32x32x16_bf16 v[80:95], v[40:43], v[36:39], v[80:95]
    ds_read_b128 v[48:51], v3 offset:0
    ds_read_b128 v[52:55], v3 offset:4096
    v_mfma_f32_32x32x16_bf16 v[96:111], v[44:47], v[32:35], v[96:111]
    ds_read_b64_tr_b16 v[60:61], v11 offset:4096
    ds_read_b64_tr_b16 v[62:63], v11 offset:5120
    v_mfma_f32_16x16x32_bf16 v[28:31], v[24:27], v[40:43], v[28:31]
    v_mfma_f32_32x32x16_bf16 v[112:127], v[44:47], v[36:39], v[112:127]
    s_waitcnt lgkmcnt(0)
    v_mfma_f32_32x32x16_bf16 v[64:79], v[56:59], v[48:51], v[64:79]
    ds_read_b64_tr_b16 v[40:41], v6 offset:8192
    ds_read_b64_tr_b16 v[42:43], v6 offset:9216
    v_mfma_f32_32x32x16_bf16 v[80:95], v[56:59], v[52:55], v[80:95]
    ds_read_b128 v[32:35], v4 offset:0
    ds_read_b128 v[36:39], v4 offset:4096
    v_mfma_f32_32x32x16_bf16 v[96:111], v[60:63], v[48:51], v[96:111]
    ds_read_b64_tr_b16 v[44:45], v11 offset:8192
    ds_read_b64_tr_b16 v[46:47], v11 offset:9216
    v_mfma_f32_16x16x32_bf16 v[28:31], v[24:27], v[56:59], v[28:31]
    v_mfma_f32_32x32x16_bf16 v[112:127], v[60:63], v[52:55], v[112:127]
    s_waitcnt lgkmcnt(0)
    v_mfma_f32_32x32x16_bf16 v[64:79], v[40:43], v[32:35], v[64:79]
    ds_read_b64_tr_b16 v[56:57], v6 offset:12288
    ds_read_b64_tr_b16 v[58:59], v6 offset:13312
    v_mfma_f32_32x32x16_bf16 v[80:95], v[40:43], v[36:39], v[80:95]
    ds_read_b128 v[48:51], v5 offset:0
    ds_read_b128 v[52:55], v5 offset:4096
    v_mfma_f32_32x32x16_bf16 v[96:111], v[44:47], v[32:35], v[96:111]
    ds_read_b64_tr_b16 v[60:61], v11 offset:12288
    ds_read_b64_tr_b16 v[62:63], v11 offset:13312
    v_mfma_f32_16x16x32_bf16 v[28:31], v[24:27], v[40:43], v[28:31]
    v_mfma_f32_32x32x16_bf16 v[112:127], v[44:47], v[36:39], v[112:127]
    s_waitcnt lgkmcnt(0)
    s_barrier
    v_mfma_f32_32x32x16_bf16 v[64:79], v[56:59], v[48:51], v[64:79]
    ds_read_b64_tr_b16 v[40:41], v6 offset:32768
    ds_read_b64_tr_b16 v[42:43], v6 offset:33792
    v_mfma_f32_32x32x16_bf16 v[80:95], v[56:59], v[52:55], v[80:95]
    ds_read_b128 v[32:35], v2 offset:32768
    ds_read_b128 v[36:39], v2 offset:36864
    v_mfma_f32_32x32x16_bf16 v[96:111], v[60:63], v[48:51], v[96:111]
    ds_read_b64_tr_b16 v[44:45], v11 offset:32768
    ds_read_b64_tr_b16 v[46:47], v11 offset:33792
    v_mfma_f32_16x16x32_bf16 v[28:31], v[24:27], v[56:59], v[28:31]
    v_mfma_f32_32x32x16_bf16 v[112:127], v[60:63], v[52:55], v[112:127]
    s_waitcnt lgkmcnt(0)
    v_mfma_f32_32x32x16_bf16 v[64:79], v[40:43], v[32:35], v[64:79]
    ds_read_b64_tr_b16 v[56:57], v6 offset:36864
    ds_read_b64_tr_b16 v[58:59], v6 offset:37888
    v_mfma_f32_32x32x16_bf16 v[80:95], v[40:43], v[36:39], v[80:95]
    ds_read_b128 v[48:51], v3 offset:32768
    ds_read_b128 v[52:55], v3 offset:36864
    v_mfma_f32_32x32x16_bf16 v[96:111], v[44:47], v[32:35], v[96:111]
    ds_read_b64_tr_b16 v[60:61], v11 offset:36864
    ds_read_b64_tr_b16 v[62:63], v11 offset:37888
    v_mfma_f32_16x16x32_bf16 v[28:31], v[24:27], v[40:43], v[28:31]
    v_mfma_f32_32x32x16_bf16 v[112:127], v[44:47], v[36:39], v[112:127]
    s_waitcnt lgkmcnt(0)
    v_mfma_f32_32x32x16_bf16 v[64:79], v[56:59], v[48:51], v[64:79]
    ds_read_b64_tr_b16 v[40:41], v6 offset:40960
    ds_read_b64_tr_b16 v[42:43], v6 offset:41984
    v_mfma_f32_32x32x16_bf16 v[80:95], v[56:59], v[52:55], v[80:95]
    ds_read_b128 v[32:35], v4 offset:32768
    ds_read_b128 v[36:39], v4 offset:36864
    v_mfma_f32_32x32x16_bf16 v[96:111], v[60:63], v[48:51], v[96:111]
    ds_read_b64_tr_b16 v[44:45], v11 offset:40960
    ds_read_b64_tr_b16 v[46:47], v11 offset:41984
    v_mfma_f32_16x16x32_bf16 v[28:31], v[24:27], v[56:59], v[28:31]
    v_mfma_f32_32x32x16_bf16 v[112:127], v[60:63], v[52:55], v[112:127]
    s_waitcnt lgkmcnt(0)
    v_mfma_f32_32x32x16_bf16 v[64:79], v[40:43], v[32:35], v[64:79]
    ds_read_b64_tr_b16 v[56:57], v6 offset:45056
    ds_read_b64_tr_b16 v[58:59], v6 offset:46080
    v_mfma_f32_32x32x16_bf16 v[80:95], v[40:43], v[36:39], v[80:95]
    ds_read_b128 v[48:51], v5 offset:32768
    ds_read_b128 v[52:55], v5 offset:36864
    v_mfma_f32_32x32x16_bf16 v[96:111], v[44:47], v[32:35], v[96:111]
    ds_read_b64_tr_b16 v[60:61], v11 offset:45056
    ds_read_b64_tr_b16 v[62:63], v11 offset:46080
    v_mfma_f32_16x16x32_bf16 v[28:31], v[24:27], v[40:43], v[28:31]
    v_mfma_f32_32x32x16_bf16 v[112:127], v[44:47], v[36:39], v[112:127]
    s_waitcnt lgkmcnt(0)
    s_barrier
    v_mfma_f32_32x32x16_bf16 v[64:79], v[56:59], v[48:51], v[64:79]
    ds_read_b64_tr_b16 v[40:41], v164 offset:0
    ds_read_b64_tr_b16 v[42:43], v164 offset:1024
    v_mfma_f32_32x32x16_bf16 v[80:95], v[56:59], v[52:55], v[80:95]
    ds_read_b128 v[32:35], v160 offset:0
    ds_read_b128 v[36:39], v160 offset:4096
    v_mfma_f32_32x32x16_bf16 v[96:111], v[60:63], v[48:51], v[96:111]
    ds_read_b64_tr_b16 v[44:45], v165 offset:0
    ds_read_b64_tr_b16 v[46:47], v165 offset:1024
    v_mfma_f32_16x16x32_bf16 v[28:31], v[24:27], v[56:59], v[28:31]
    v_mfma_f32_32x32x16_bf16 v[112:127], v[60:63], v[52:55], v[112:127]
    s_waitcnt lgkmcnt(0)
    v_mfma_f32_32x32x16_bf16 v[64:79], v[40:43], v[32:35], v[64:79]
    ds_read_b64_tr_b16 v[56:57], v164 offset:4096
    ds_read_b64_tr_b16 v[58:59], v164 offset:5120
    v_mfma_f32_32x32x16_bf16 v[80:95], v[40:43], v[36:39], v[80:95]
    ds_read_b128 v[48:51], v161 offset:0
    ds_read_b128 v[52:55], v161 offset:4096
    v_mfma_f32_32x32x16_bf16 v[96:111], v[44:47], v[32:35], v[96:111]
    ds_read_b64_tr_b16 v[60:61], v165 offset:4096
    ds_read_b64_tr_b16 v[62:63], v165 offset:5120
    v_mfma_f32_16x16x32_bf16 v[28:31], v[24:27], v[40:43], v[28:31]
    v_mfma_f32_32x32x16_bf16 v[112:127], v[44:47], v[36:39], v[112:127]
    s_waitcnt lgkmcnt(0)
    v_mfma_f32_32x32x16_bf16 v[64:79], v[56:59], v[48:51], v[64:79]
    ds_read_b64_tr_b16 v[40:41], v164 offset:8192
    ds_read_b64_tr_b16 v[42:43], v164 offset:9216
    v_mfma_f32_32x32x16_bf16 v[80:95], v[56:59], v[52:55], v[80:95]
    ds_read_b128 v[32:35], v162 offset:0
    ds_read_b128 v[36:39], v162 offset:4096
    v_mfma_f32_32x32x16_bf16 v[96:111], v[60:63], v[48:51], v[96:111]
    ds_read_b64_tr_b16 v[44:45], v165 offset:8192
    ds_read_b64_tr_b16 v[46:47], v165 offset:9216
    v_mfma_f32_16x16x32_bf16 v[28:31], v[24:27], v[56:59], v[28:31]
    v_mfma_f32_32x32x16_bf16 v[112:127], v[60:63], v[52:55], v[112:127]
    s_waitcnt lgkmcnt(0)
    v_mfma_f32_32x32x16_bf16 v[64:79], v[40:43], v[32:35], v[64:79]
    ds_read_b64_tr_b16 v[56:57], v164 offset:12288
    ds_read_b64_tr_b16 v[58:59], v164 offset:13312
    v_mfma_f32_32x32x16_bf16 v[80:95], v[40:43], v[36:39], v[80:95]
    ds_read_b128 v[48:51], v163 offset:0
    ds_read_b128 v[52:55], v163 offset:4096
    v_mfma_f32_32x32x16_bf16 v[96:111], v[44:47], v[32:35], v[96:111]
    ds_read_b64_tr_b16 v[60:61], v165 offset:12288
    ds_read_b64_tr_b16 v[62:63], v165 offset:13312
    v_mfma_f32_16x16x32_bf16 v[28:31], v[24:27], v[40:43], v[28:31]
    v_mfma_f32_32x32x16_bf16 v[112:127], v[44:47], v[36:39], v[112:127]
    s_waitcnt lgkmcnt(0)
    s_barrier
    v_mfma_f32_32x32x16_bf16 v[64:79], v[56:59], v[48:51], v[64:79]
    ds_read_b64_tr_b16 v[40:41], v164 offset:32768
    ds_read_b64_tr_b16 v[42:43], v164 offset:33792
    v_mfma_f32_32x32x16_bf16 v[80:95], v[56:59], v[52:55], v[80:95]
    ds_read_b128 v[32:35], v160 offset:32768
    ds_read_b128 v[36:39], v160 offset:36864
    v_mfma_f32_32x32x16_bf16 v[96:111], v[60:63], v[48:51], v[96:111]
    ds_read_b64_tr_b16 v[44:45], v165 offset:32768
    ds_read_b64_tr_b16 v[46:47], v165 offset:33792
    v_mfma_f32_16x16x32_bf16 v[28:31], v[24:27], v[56:59], v[28:31]
    v_mfma_f32_32x32x16_bf16 v[112:127], v[60:63], v[52:55], v[112:127]
    s_waitcnt lgkmcnt(0)
    v_mfma_f32_32x32x16_bf16 v[64:79], v[40:43], v[32:35], v[64:79]
    ds_read_b64_tr_b16 v[56:57], v164 offset:36864
    ds_read_b64_tr_b16 v[58:59], v164 offset:37888
    v_mfma_f32_32x32x16_bf16 v[80:95], v[40:43], v[36:39], v[80:95]
    ds_read_b128 v[48:51], v161 offset:32768
    ds_read_b128 v[52:55], v161 offset:36864
    v_mfma_f32_32x32x16_bf16 v[96:111], v[44:47], v[32:35], v[96:111]
    ds_read_b64_tr_b16 v[60:61], v165 offset:36864
    ds_read_b64_tr_b16 v[62:63], v165 offset:37888
    v_mfma_f32_16x16x32_bf16 v[28:31], v[24:27], v[40:43], v[28:31]
    v_mfma_f32_32x32x16_bf16 v[112:127], v[44:47], v[36:39], v[112:127]
    s_waitcnt lgkmcnt(0)
    v_mfma_f32_32x32x16_bf16 v[64:79], v[56:59], v[48:51], v[64:79]
    ds_read_b64_tr_b16 v[40:41], v164 offset:40960
    ds_read_b64_tr_b16 v[42:43], v164 offset:41984
    v_mfma_f32_32x32x16_bf16 v[80:95], v[56:59], v[52:55], v[80:95]
    ds_read_b128 v[32:35], v162 offset:32768
    ds_read_b128 v[36:39], v162 offset:36864
    v_mfma_f32_32x32x16_bf16 v[96:111], v[60:63], v[48:51], v[96:111]
    ds_read_b64_tr_b16 v[44:45], v165 offset:40960
    ds_read_b64_tr_b16 v[46:47], v165 offset:41984
    v_mfma_f32_16x16x32_bf16 v[28:31], v[24:27], v[56:59], v[28:31]
    v_mfma_f32_32x32x16_bf16 v[112:127], v[60:63], v[52:55], v[112:127]
    s_waitcnt lgkmcnt(0)
    v_mfma_f32_32x32x16_bf16 v[64:79], v[40:43], v[32:35], v[64:79]
    ds_read_b64_tr_b16 v[56:57], v164 offset:45056
    ds_read_b64_tr_b16 v[58:59], v164 offset:46080
    v_mfma_f32_32x32x16_bf16 v[80:95], v[40:43], v[36:39], v[80:95]
    ds_read_b128 v[48:51], v163 offset:32768
    ds_read_b128 v[52:55], v163 offset:36864
    v_mfma_f32_32x32x16_bf16 v[96:111], v[44:47], v[32:35], v[96:111]
    ds_read_b64_tr_b16 v[60:61], v165 offset:45056
    ds_read_b64_tr_b16 v[62:63], v165 offset:46080
    v_mfma_f32_16x16x32_bf16 v[28:31], v[24:27], v[40:43], v[28:31]
    v_mfma_f32_32x32x16_bf16 v[112:127], v[44:47], v[36:39], v[112:127]
    s_waitcnt lgkmcnt(0)
    s_barrier
    v_mfma_f32_32x32x16_bf16 v[64:79], v[56:59], v[48:51], v[64:79]
    ds_read_b64_tr_b16 v[40:41], v6 offset:0
    ds_read_b64_tr_b16 v[42:43], v6 offset:1024
    v_mfma_f32_32x32x16_bf16 v[80:95], v[56:59], v[52:55], v[80:95]
    ds_read_b128 v[32:35], v2 offset:0
    ds_read_b128 v[36:39], v2 offset:4096
    v_mfma_f32_32x32x16_bf16 v[96:111], v[60:63], v[48:51], v[96:111]
    ds_read_b64_tr_b16 v[44:45], v11 offset:0
    ds_read_b64_tr_b16 v[46:47], v11 offset:1024
    v_mfma_f32_16x16x32_bf16 v[28:31], v[24:27], v[56:59], v[28:31]
    v_mfma_f32_32x32x16_bf16 v[112:127], v[60:63], v[52:55], v[112:127]
    s_waitcnt lgkmcnt(0)
    v_mfma_f32_32x32x16_bf16 v[64:79], v[40:43], v[32:35], v[64:79]
    ds_read_b64_tr_b16 v[56:57], v6 offset:4096
    ds_read_b64_tr_b16 v[58:59], v6 offset:5120
    v_mfma_f32_32x32x16_bf16 v[80:95], v[40:43], v[36:39], v[80:95]
    ds_read_b128 v[48:51], v3 offset:0
    ds_read_b128 v[52:55], v3 offset:4096
    v_mfma_f32_32x32x16_bf16 v[96:111], v[44:47], v[32:35], v[96:111]
    ds_read_b64_tr_b16 v[60:61], v11 offset:4096
    ds_read_b64_tr_b16 v[62:63], v11 offset:5120
    v_mfma_f32_16x16x32_bf16 v[28:31], v[24:27], v[40:43], v[28:31]
    v_mfma_f32_32x32x16_bf16 v[112:127], v[44:47], v[36:39], v[112:127]
    s_waitcnt lgkmcnt(0)
    v_mfma_f32_32x32x16_bf16 v[64:79], v[56:59], v[48:51], v[64:79]
    ds_read_b64_tr_b16 v[40:41], v6 offset:8192
    ds_read_b64_tr_b16 v[42:43], v6 offset:9216
    v_mfma_f32_32x32x16_bf16 v[80:95], v[56:59], v[52:55], v[80:95]
    ds_read_b128 v[32:35], v4 offset:0
    ds_read_b128 v[36:39], v4 offset:4096
    v_mfma_f32_32x32x16_bf16 v[96:111], v[60:63], v[48:51], v[96:111]
    ds_read_b64_tr_b16 v[44:45], v11 offset:8192
    ds_read_b64_tr_b16 v[46:47], v11 offset:9216
    v_mfma_f32_16x16x32_bf16 v[28:31], v[24:27], v[56:59], v[28:31]
    v_mfma_f32_32x32x16_bf16 v[112:127], v[60:63], v[52:55], v[112:127]
    s_waitcnt lgkmcnt(0)
    v_mfma_f32_32x32x16_bf16 v[64:79], v[40:43], v[32:35], v[64:79]
    ds_read_b64_tr_b16 v[56:57], v6 offset:12288
    ds_read_b64_tr_b16 v[58:59], v6 offset:13312
    v_mfma_f32_32x32x16_bf16 v[80:95], v[40:43], v[36:39], v[80:95]
    ds_read_b128 v[48:51], v5 offset:0
    ds_read_b128 v[52:55], v5 offset:4096
    v_mfma_f32_32x32x16_bf16 v[96:111], v[44:47], v[32:35], v[96:111]
    ds_read_b64_tr_b16 v[60:61], v11 offset:12288
    ds_read_b64_tr_b16 v[62:63], v11 offset:13312
    v_mfma_f32_16x16x32_bf16 v[28:31], v[24:27], v[40:43], v[28:31]
    v_mfma_f32_32x32x16_bf16 v[112:127], v[44:47], v[36:39], v[112:127]
    s_waitcnt lgkmcnt(0)
    s_barrier
    v_mfma_f32_32x32x16_bf16 v[64:79], v[56:59], v[48:51], v[64:79]
    ds_read_b64_tr_b16 v[40:41], v6 offset:32768
    ds_read_b64_tr_b16 v[42:43], v6 offset:33792
    v_mfma_f32_32x32x16_bf16 v[80:95], v[56:59], v[52:55], v[80:95]
    ds_read_b128 v[32:35], v2 offset:32768
    ds_read_b128 v[36:39], v2 offset:36864
    v_mfma_f32_32x32x16_bf16 v[96:111], v[60:63], v[48:51], v[96:111]
    ds_read_b64_tr_b16 v[44:45], v11 offset:32768
    ds_read_b64_tr_b16 v[46:47], v11 offset:33792
    v_mfma_f32_16x16x32_bf16 v[28:31], v[24:27], v[56:59], v[28:31]
    v_mfma_f32_32x32x16_bf16 v[112:127], v[60:63], v[52:55], v[112:127]
    s_waitcnt lgkmcnt(0)
    v_mfma_f32_32x32x16_bf16 v[64:79], v[40:43], v[32:35], v[64:79]
    ds_read_b64_tr_b16 v[56:57], v6 offset:36864
    ds_read_b64_tr_b16 v[58:59], v6 offset:37888
    v_mfma_f32_32x32x16_bf16 v[80:95], v[40:43], v[36:39], v[80:95]
    ds_read_b128 v[48:51], v3 offset:32768
    ds_read_b128 v[52:55], v3 offset:36864
    v_mfma_f32_32x32x16_bf16 v[96:111], v[44:47], v[32:35], v[96:111]
    ds_read_b64_tr_b16 v[60:61], v11 offset:36864
    ds_read_b64_tr_b16 v[62:63], v11 offset:37888
    v_mfma_f32_16x16x32_bf16 v[28:31], v[24:27], v[40:43], v[28:31]
    v_mfma_f32_32x32x16_bf16 v[112:127], v[44:47], v[36:39], v[112:127]
    s_waitcnt lgkmcnt(0)
    v_and_b32 v132, 15, v1
    v_lshlrev_b32 v132, 8, v132
    v_add_u32 v132, 20893696, v132
    v_mov_b32 v133, 15
    s_cmp_lg_u32 s3, 2
    s_cbranch_scc1 CQI16
    buffer_load_dword v134, v132, s[16:19], 0 offen sc1
CQI16:
    v_mfma_f32_32x32x16_bf16 v[64:79], v[56:59], v[48:51], v[64:79]
    ds_read_b64_tr_b16 v[40:41], v6 offset:40960
    ds_read_b64_tr_b16 v[42:43], v6 offset:41984
    v_mfma_f32_32x32x16_bf16 v[80:95], v[56:59], v[52:55], v[80:95]
    ds_read_b128 v[32:35], v4 offset:32768
    ds_read_b128 v[36:39], v4 offset:36864
    v_mfma_f32_32x32x16_bf16 v[96:111], v[60:63], v[48:51], v[96:111]
    ds_read_b64_tr_b16 v[44:45], v11 offset:40960
    ds_read_b64_tr_b16 v[46:47], v11 offset:41984
    v_mfma_f32_16x16x32_bf16 v[28:31], v[24:27], v[56:59], v[28:31]
    v_mfma_f32_32x32x16_bf16 v[112:127], v[60:63], v[52:55], v[112:127]
    s_waitcnt lgkmcnt(0)
    v_mfma_f32_32x32x16_bf16 v[64:79], v[40:43], v[32:35], v[64:79]
    ds_read_b64_tr_b16 v[56:57], v6 offset:45056
    ds_read_b64_tr_b16 v[58:59], v6 offset:46080
    v_mfma_f32_32x32x16_bf16 v[80:95], v[40:43], v[36:39], v[80:95]
    ds_read_b128 v[48:51], v5 offset:32768
    ds_read_b128 v[52:55], v5 offset:36864
    v_mfma_f32_32x32x16_bf16 v[96:111], v[44:47], v[32:35], v[96:111]
    ds_read_b64_tr_b16 v[60:61], v11 offset:45056
    ds_read_b64_tr_b16 v[62:63], v11 offset:46080
    v_mfma_f32_16x16x32_bf16 v[28:31], v[24:27], v[40:43], v[28:31]
    v_mfma_f32_32x32x16_bf16 v[112:127], v[44:47], v[36:39], v[112:127]
    s_waitcnt lgkmcnt(0)
    s_barrier
    v_mfma_f32_32x32x16_bf16 v[64:79], v[56:59], v[48:51], v[64:79]
    ds_read_b64_tr_b16 v[40:41], v164 offset:0
    ds_read_b64_tr_b16 v[42:43], v164 offset:1024
    v_mfma_f32_32x32x16_bf16 v[80:95], v[56:59], v[52:55], v[80:95]
    ds_read_b128 v[32:35], v160 offset:0
    ds_read_b128 v[36:39], v160 offset:4096
    v_mfma_f32_32x32x16_bf16 v[96:111], v[60:63], v[48:51], v[96:111]
    ds_read_b64_tr_b16 v[44:45], v165 offset:0
    ds_read_b64_tr_b16 v[46:47], v165 offset:1024
    v_mfma_f32_16x16x32_bf16 v[28:31], v[24:27], v[56:59], v[28:31]
    v_mfma_f32_32x32x16_bf16 v[112:127], v[60:63], v[52:55], v[112:127]
    s_waitcnt lgkmcnt(0)
    v_mfma_f32_32x32x16_bf16 v[64:79], v[40:43], v[32:35], v[64:79]
    ds_read_b64_tr_b16 v[56:57], v164 offset:4096
    ds_read_b64_tr_b16 v[58:59], v164 offset:5120
    v_mfma_f32_32x32x16_bf16 v[80:95], v[40:43], v[36:39], v[80:95]
    ds_read_b128 v[48:51], v161 offset:0
    ds_read_b128 v[52:55], v161 offset:4096
    v_mfma_f32_32x32x16_bf16 v[96:111], v[44:47], v[32:35], v[96:111]
    ds_read_b64_tr_b16 v[60:61], v165 offset:4096
    ds_read_b64_tr_b16 v[62:63], v165 offset:5120
    v_mfma_f32_16x16x32_bf16 v[28:31], v[24:27], v[40:43], v[28:31]
    v_mfma_f32_32x32x16_bf16 v[112:127], v[44:47], v[36:39], v[112:127]
    s_waitcnt lgkmcnt(0)
    v_mfma_f32_32x32x16_bf16 v[64:79], v[56:59], v[48:51], v[64:79]
    ds_read_b64_tr_b16 v[40:41], v164 offset:8192
    ds_read_b64_tr_b16 v[42:43], v164 offset:9216
    v_mfma_f32_32x32x16_bf16 v[80:95], v[56:59], v[52:55], v[80:95]
    ds_read_b128 v[32:35], v162 offset:0
    ds_read_b128 v[36:39], v162 offset:4096
    v_mfma_f32_32x32x16_bf16 v[96:111], v[60:63], v[48:51], v[96:111]
    ds_read_b64_tr_b16 v[44:45], v165 offset:8192
    ds_read_b64_tr_b16 v[46:47], v165 offset:9216
    v_mfma_f32_16x16x32_bf16 v[28:31], v[24:27], v[56:59], v[28:31]
    v_mfma_f32_32x32x16_bf16 v[112:127], v[60:63], v[52:55], v[112:127]
    s_waitcnt lgkmcnt(0)
    v_mfma_f32_32x32x16_bf16 v[64:79], v[40:43], v[32:35], v[64:79]
    ds_read_b64_tr_b16 v[56:57], v164 offset:12288
    ds_read_b64_tr_b16 v[58:59], v164 offset:13312
    v_mfma_f32_32x32x16_bf16 v[80:95], v[40:43], v[36:39], v[80:95]
    ds_read_b128 v[48:51], v163 offset:0
    ds_read_b128 v[52:55], v163 offset:4096
    v_mfma_f32_32x32x16_bf16 v[96:111], v[44:47], v[32:35], v[96:111]
    ds_read_b64_tr_b16 v[60:61], v165 offset:12288
    ds_read_b64_tr_b16 v[62:63], v165 offset:13312
    v_mfma_f32_16x16x32_bf16 v[28:31], v[24:27], v[40:43], v[28:31]
    v_mfma_f32_32x32x16_bf16 v[112:127], v[44:47], v[36:39], v[112:127]
    s_waitcnt lgkmcnt(0)
    s_cmp_lg_u32 s3, 2
    s_cbranch_scc1 CQC17
    s_waitcnt vmcnt(0)
    v_cmp_gt_u32 vcc, v133, v134
    s_nop 1
    s_cbranch_vccnz CQC17
    v_mov_b32 v136, 159336
    v_mov_b32 v137, 1
    s_mov_b64 exec, 1
    ds_add_u32 v136, v137
    s_mov_b64 exec, -1
    s_waitcnt lgkmcnt(0)
CQC17:
    s_barrier
    v_mfma_f32_32x32x16_bf16 v[64:79], v[56:59], v[48:51], v[64:79]
    ds_read_b64_tr_b16 v[40:41], v164 offset:32768
    ds_read_b64_tr_b16 v[42:43], v164 offset:33792
    v_mfma_f32_32x32x16_bf16 v[80:95], v[56:59], v[52:55], v[80:95]
    ds_read_b128 v[32:35], v160 offset:32768
    ds_read_b128 v[36:39], v160 offset:36864
    v_mfma_f32_32x32x16_bf16 v[96:111], v[60:63], v[48:51], v[96:111]
    ds_read_b64_tr_b16 v[44:45], v165 offset:32768
    ds_read_b64_tr_b16 v[46:47], v165 offset:33792
    v_mfma_f32_16x16x32_bf16 v[28:31], v[24:27], v[56:59], v[28:31]
    v_mfma_f32_32x32x16_bf16 v[112:127], v[60:63], v[52:55], v[112:127]
    s_waitcnt lgkmcnt(0)
    v_mfma_f32_32x32x16_bf16 v[64:79], v[40:43], v[32:35], v[64:79]
    ds_read_b64_tr_b16 v[56:57], v164 offset:36864
    ds_read_b64_tr_b16 v[58:59], v164 offset:37888
    v_mfma_f32_32x32x16_bf16 v[80:95], v[40:43], v[36:39], v[80:95]
    ds_read_b128 v[48:51], v161 offset:32768
    ds_read_b128 v[52:55], v161 offset:36864
    v_mfma_f32_32x32x16_bf16 v[96:111], v[44:47], v[32:35], v[96:111]
    ds_read_b64_tr_b16 v[60:61], v165 offset:36864
    ds_read_b64_tr_b16 v[62:63], v165 offset:37888
    v_mfma_f32_16x16x32_bf16 v[28:31], v[24:27], v[40:43], v[28:31]
    v_mfma_f32_32x32x16_bf16 v[112:127], v[44:47], v[36:39], v[112:127]
    s_waitcnt lgkmcnt(0)
    v_mfma_f32_32x32x16_bf16 v[64:79], v[56:59], v[48:51], v[64:79]
    ds_read_b64_tr_b16 v[40:41], v164 offset:40960
    ds_read_b64_tr_b16 v[42:43], v164 offset:41984
    v_mfma_f32_32x32x16_bf16 v[80:95], v[56:59], v[52:55], v[80:95]
    ds_read_b128 v[32:35], v162 offset:32768
    ds_read_b128 v[36:39], v162 offset:36864
    v_mfma_f32_32x32x16_bf16 v[96:111], v[60:63], v[48:51], v[96:111]
    ds_read_b64_tr_b16 v[44:45], v165 offset:40960
    ds_read_b64_tr_b16 v[46:47], v165 offset:41984
    v_mfma_f32_16x16x32_bf16 v[28:31], v[24:27], v[56:59], v[28:31]
    v_mfma_f32_32x32x16_bf16 v[112:127], v[60:63], v[52:55], v[112:127]
    s_waitcnt lgkmcnt(0)
    v_mfma_f32_32x32x16_bf16 v[64:79], v[40:43], v[32:35], v[64:79]
    ds_read_b64_tr_b16 v[56:57], v164 offset:45056
    ds_read_b64_tr_b16 v[58:59], v164 offset:46080
    v_mfma_f32_32x32x16_bf16 v[80:95], v[40:43], v[36:39], v[80:95]
    ds_read_b128 v[48:51], v163 offset:32768
    ds_read_b128 v[52:55], v163 offset:36864
    v_mfma_f32_32x32x16_bf16 v[96:111], v[44:47], v[32:35], v[96:111]
    ds_read_b64_tr_b16 v[60:61], v165 offset:45056
    ds_read_b64_tr_b16 v[62:63], v165 offset:46080
    v_mfma_f32_16x16x32_bf16 v[28:31], v[24:27], v[40:43], v[28:31]
    v_mfma_f32_32x32x16_bf16 v[112:127], v[44:47], v[36:39], v[112:127]
    s_waitcnt lgkmcnt(0)
    v_mfma_f32_32x32x16_bf16 v[64:79], v[56:59], v[48:51], v[64:79]
    v_mfma_f32_32x32x16_bf16 v[80:95], v[56:59], v[52:55], v[80:95]
    v_mfma_f32_32x32x16_bf16 v[96:111], v[60:63], v[48:51], v[96:111]
    v_mfma_f32_16x16x32_bf16 v[28:31], v[24:27], v[56:59], v[28:31]
    v_mfma_f32_32x32x16_bf16 v[112:127], v[60:63], v[52:55], v[112:127]
    s_lshl_b32 s36, s35, 8
    s_lshl_b32 s37, s34, 7
    s_add_u32 s36, s36, s37
    s_add_u32 s36, s36, 132608
    v_lshl_add_u32 v9, v1, 2, s36
    s_mov_b64 exec, 0xffff
    s_nop 3
    ds_write_b32 v9, v28
    ds_write_b32 v9, v29 offset:64
    s_mov_b64 exec, -1
    s_waitcnt vmcnt(0) lgkmcnt(0)
    v_mov_b32 v20, 159332
    v_mov_b32 v21, 1
    s_mov_b64 exec, 1
    ds_add_u32 v20, v21
    s_mov_b64 exec, -1
    v_mov_b32 v20, 159332
LW18:
    ds_read_b32 v21, v20
    s_waitcnt lgkmcnt(0)
    v_cmp_gt_u32 vcc, 4, v21
    s_nop 1
    s_cbranch_vccz LW18_OK
    s_add_u32 s101, s101, 1
    s_cmp_gt_u32 s101, 0x40000
    s_cbranch_scc1 K_END
    s_sleep 1
    s_branch LW18
LW18_OK:
    s_waitcnt vmcnt(0)
    v_mov_b32 v32, v152
    v_mov_b32 v33, v153
    v_mov_b32 v34, v154
    v_mov_b32 v35, v155
    v_mov_b32 v36, v156
    v_mov_b32 v37, v157
    v_mov_b32 v38, v158
    v_mov_b32 v39, v159
    s_lshl_b32 s36, s34, 8
    s_add_u32 s36, s36, 131072
    v_lshl_add_u32 v9, v7, 2, s36
    s_lshl_b32 s36, s35, 8
    s_lshl_b32 s37, s34, 7
    s_add_u32 s36, s36, s37
    s_add_u32 s36, s36, 132608
    v_lshl_add_u32 v10, v8, 4, s36
    v_xor_b32 v28, 0x80, v10
    ds_read_b32 v20, v9
    ds_read_b32 v21, v9 offset:128
    ds_read_b32 v22, v9 offset:512
    ds_read_b32 v23, v9 offset:640
    ds_read_b128 v[128:131], v10 offset:0
    ds_read_b128 v[132:135], v10 offset:32
    ds_read_b128 v[136:139], v10 offset:64
    ds_read_b128 v[140:143], v10 offset:96
    ds_read_b128 v[144:147], v28 offset:0
    ds_read_b128 v[148:151], v28 offset:32
    ds_read_b128 v[152:155], v28 offset:64
    ds_read_b128 v[156:159], v28 offset:96
    s_lshl_b32 s36, s33, 2
    s_lshl_b32 s37, s35, 1
    s_add_u32 s36, s36, s37
    s_lshl_b32 s37, s32, 2
    s_lshl_b32 s38, s34, 1
    s_add_u32 s37, s37, s38
    s_lshl_b32 s37, s37, 10
    s_add_u32 s37, s37, 10899456
    s_add_u32 s44, s36, s34
    s_lshl_b32 s44, s44, 17
    s_add_u32 s44, s44, s37
    s_add_u32 s45, s36, s43
    s_lshl_b32 s45, s45, 17
    s_add_u32 s45, s45, s37
    s_mov_b32 s39, 0xbdd2d3e8
    v_mov_b32 v9, 0xc0135761
    v_lshlrev_b32 v10, 4, v1
    s_waitcnt lgkmcnt(0)
    v_lshlrev_b32 v48, 16, v12
    v_and_b32 v49, 0xffff0000, v12
    v_lshlrev_b32 v50, 16, v13
    v_and_b32 v51, 0xffff0000, v13
    v_lshlrev_b32 v52, 16, v14
    v_and_b32 v53, 0xffff0000, v14
    v_lshlrev_b32 v54, 16, v15
    v_and_b32 v55, 0xffff0000, v15
    v_fma_f32 v64, -v20, v128, v64
    v_fma_f32 v65, -v20, v129, v65
    v_fma_f32 v66, -v20, v130, v66
    v_fma_f32 v67, -v20, v131, v67
    v_fma_f32 v68, -v20, v132, v68
    v_fma_f32 v69, -v20, v133, v69
    v_fma_f32 v70, -v20, v134, v70
    v_fma_f32 v71, -v20, v135, v71
    v_fma_f32 v64, v64, v22, v48
    v_fma_f32 v65, v65, v22, v49
    v_fma_f32 v66, v66, v22, v50
    v_fma_f32 v67, v67, v22, v51
    v_fma_f32 v68, v68, v22, v52
    v_fma_f32 v69, v69, v22, v53
    v_fma_f32 v70, v70, v22, v54
    v_fma_f32 v71, v71, v22, v55
    v_mul_f32 v40, v64, v64
    v_mul_f32 v41, v65, v65
    v_mul_f32 v42, v66, v66
    v_mul_f32 v43, v67, v67
    v_mul_f32 v44, v68, v68
    v_mul_f32 v45, v69, v69
    v_mul_f32 v46, v70, v70
    v_mul_f32 v47, v71, v71
    v_fma_f32 v40, v40, s39, v9
    v_fma_f32 v41, v41, s39, v9
    v_fma_f32 v42, v42, s39, v9
    v_fma_f32 v43, v43, s39, v9
    v_fma_f32 v44, v44, s39, v9
    v_fma_f32 v45, v45, s39, v9
    v_fma_f32 v46, v46, s39, v9
    v_fma_f32 v47, v47, s39, v9
    v_mul_f32 v40, v40, v64
    v_mul_f32 v41, v41, v65
    v_mul_f32 v42, v42, v66
    v_mul_f32 v43, v43, v67
    v_mul_f32 v44, v44, v68
    v_mul_f32 v45, v45, v69
    v_mul_f32 v46, v46, v70
    v_mul_f32 v47, v47, v71
    v_exp_f32 v40, v40
    v_exp_f32 v41, v41
    v_exp_f32 v42, v42
    v_exp_f32 v43, v43
    v_exp_f32 v44, v44
    v_exp_f32 v45, v45
    v_exp_f32 v46, v46
    v_exp_f32 v47, v47
    v_add_f32 v40, 1.0, v40
    v_add_f32 v41, 1.0, v41
    v_add_f32 v42, 1.0, v42
    v_add_f32 v43, 1.0, v43
    v_add_f32 v44, 1.0, v44
    v_add_f32 v45, 1.0, v45
    v_add_f32 v46, 1.0, v46
    v_add_f32 v47, 1.0, v47
    v_rcp_f32 v40, v40
    v_rcp_f32 v41, v41
    v_rcp_f32 v42, v42
    v_rcp_f32 v43, v43
    v_rcp_f32 v44, v44
    v_rcp_f32 v45, v45
    v_rcp_f32 v46, v46
    v_rcp_f32 v47, v47
    v_mul_f32 v64, v64, v40
    v_mul_f32 v65, v65, v41
    v_mul_f32 v66, v66, v42
    v_mul_f32 v67, v67, v43
    v_mul_f32 v68, v68, v44
    v_mul_f32 v69, v69, v45
    v_mul_f32 v70, v70, v46
    v_mul_f32 v71, v71, v47
    v_cvt_pk_bf16_f32 v64, v64, v65
    v_cvt_pk_bf16_f32 v65, v66, v67
    v_cvt_pk_bf16_f32 v66, v68, v69
    v_cvt_pk_bf16_f32 v67, v70, v71
    buffer_store_dwordx4 v[64:67], v10, s[16:19], s44 offen offset:0 sc1
    v_fma_f32 v80, -v21, v128, v80
    v_fma_f32 v81, -v21, v129, v81
    v_fma_f32 v82, -v21, v130, v82
    v_fma_f32 v83, -v21, v131, v83
    v_fma_f32 v84, -v21, v132, v84
    v_fma_f32 v85, -v21, v133, v85
    v_fma_f32 v86, -v21, v134, v86
    v_fma_f32 v87, -v21, v135, v87
    v_fma_f32 v80, v80, v23, v48
    v_fma_f32 v81, v81, v23, v49
    v_fma_f32 v82, v82, v23, v50
    v_fma_f32 v83, v83, v23, v51
    v_fma_f32 v84, v84, v23, v52
    v_fma_f32 v85, v85, v23, v53
    v_fma_f32 v86, v86, v23, v54
    v_fma_f32 v87, v87, v23, v55
    v_mul_f32 v40, v80, v80
    v_mul_f32 v41, v81, v81
    v_mul_f32 v42, v82, v82
    v_mul_f32 v43, v83, v83
    v_mul_f32 v44, v84, v84
    v_mul_f32 v45, v85, v85
    v_mul_f32 v46, v86, v86
    v_mul_f32 v47, v87, v87
    v_fma_f32 v40, v40, s39, v9
    v_fma_f32 v41, v41, s39, v9
    v_fma_f32 v42, v42, s39, v9
    v_fma_f32 v43, v43, s39, v9
    v_fma_f32 v44, v44, s39, v9
    v_fma_f32 v45, v45, s39, v9
    v_fma_f32 v46, v46, s39, v9
    v_fma_f32 v47, v47, s39, v9
    v_mul_f32 v40, v40, v80
    v_mul_f32 v41, v41, v81
    v_mul_f32 v42, v42, v82
    v_mul_f32 v43, v43, v83
    v_mul_f32 v44, v44, v84
    v_mul_f32 v45, v45, v85
    v_mul_f32 v46, v46, v86
    v_mul_f32 v47, v47, v87
    v_exp_f32 v40, v40
    v_exp_f32 v41, v41
    v_exp_f32 v42, v42
    v_exp_f32 v43, v43
    v_exp_f32 v44, v44
    v_exp_f32 v45, v45
    v_exp_f32 v46, v46
    v_exp_f32 v47, v47
    v_add_f32 v40, 1.0, v40
    v_add_f32 v41, 1.0, v41
    v_add_f32 v42, 1.0, v42
    v_add_f32 v43, 1.0, v43
    v_add_f32 v44, 1.0, v44
    v_add_f32 v45, 1.0, v45
    v_add_f32 v46, 1.0, v46
    v_add_f32 v47, 1.0, v47
    v_rcp_f32 v40, v40
    v_rcp_f32 v41, v41
    v_rcp_f32 v42, v42
    v_rcp_f32 v43, v43
    v_rcp_f32 v44, v44
    v_rcp_f32 v45, v45
    v_rcp_f32 v46, v46
    v_rcp_f32 v47, v47
    v_mul_f32 v80, v80, v40
    v_mul_f32 v81, v81, v41
    v_mul_f32 v82, v82, v42
    v_mul_f32 v83, v83, v43
    v_mul_f32 v84, v84, v44
    v_mul_f32 v85, v85, v45
    v_mul_f32 v86, v86, v46
    v_mul_f32 v87, v87, v47
    v_cvt_pk_bf16_f32 v80, v80, v81
    v_cvt_pk_bf16_f32 v81, v82, v83
    v_cvt_pk_bf16_f32 v82, v84, v85
    v_cvt_pk_bf16_f32 v83, v86, v87
    buffer_store_dwordx4 v[80:83], v10, s[16:19], s44 offen offset:1024 sc1
    s_add_u32 s44, s44, 65536
    v_lshlrev_b32 v48, 16, v16
    v_and_b32 v49, 0xffff0000, v16
    v_lshlrev_b32 v50, 16, v17
    v_and_b32 v51, 0xffff0000, v17
    v_lshlrev_b32 v52, 16, v18
    v_and_b32 v53, 0xffff0000, v18
    v_lshlrev_b32 v54, 16, v19
    v_and_b32 v55, 0xffff0000, v19
    v_fma_f32 v72, -v20, v136, v72
    v_fma_f32 v73, -v20, v137, v73
    v_fma_f32 v74, -v20, v138, v74
    v_fma_f32 v75, -v20, v139, v75
    v_fma_f32 v76, -v20, v140, v76
    v_fma_f32 v77, -v20, v141, v77
    v_fma_f32 v78, -v20, v142, v78
    v_fma_f32 v79, -v20, v143, v79
    v_fma_f32 v72, v72, v22, v48
    v_fma_f32 v73, v73, v22, v49
    v_fma_f32 v74, v74, v22, v50
    v_fma_f32 v75, v75, v22, v51
    v_fma_f32 v76, v76, v22, v52
    v_fma_f32 v77, v77, v22, v53
    v_fma_f32 v78, v78, v22, v54
    v_fma_f32 v79, v79, v22, v55
    v_mul_f32 v40, v72, v72
    v_mul_f32 v41, v73, v73
    v_mul_f32 v42, v74, v74
    v_mul_f32 v43, v75, v75
    v_mul_f32 v44, v76, v76
    v_mul_f32 v45, v77, v77
    v_mul_f32 v46, v78, v78
    v_mul_f32 v47, v79, v79
    v_fma_f32 v40, v40, s39, v9
    v_fma_f32 v41, v41, s39, v9
    v_fma_f32 v42, v42, s39, v9
    v_fma_f32 v43, v43, s39, v9
    v_fma_f32 v44, v44, s39, v9
    v_fma_f32 v45, v45, s39, v9
    v_fma_f32 v46, v46, s39, v9
    v_fma_f32 v47, v47, s39, v9
    v_mul_f32 v40, v40, v72
    v_mul_f32 v41, v41, v73
    v_mul_f32 v42, v42, v74
    v_mul_f32 v43, v43, v75
    v_mul_f32 v44, v44, v76
    v_mul_f32 v45, v45, v77
    v_mul_f32 v46, v46, v78
    v_mul_f32 v47, v47, v79
    v_exp_f32 v40, v40
    v_exp_f32 v41, v41
    v_exp_f32 v42, v42
    v_exp_f32 v43, v43
    v_exp_f32 v44, v44
    v_exp_f32 v45, v45
    v_exp_f32 v46, v46
    v_exp_f32 v47, v47
    v_add_f32 v40, 1.0, v40
    v_add_f32 v41, 1.0, v41
    v_add_f32 v42, 1.0, v42
    v_add_f32 v43, 1.0, v43
    v_add_f32 v44, 1.0, v44
    v_add_f32 v45, 1.0, v45
    v_add_f32 v46, 1.0, v46
    v_add_f32 v47, 1.0, v47
    v_rcp_f32 v40, v40
    v_rcp_f32 v41, v41
    v_rcp_f32 v42, v42
    v_rcp_f32 v43, v43
    v_rcp_f32 v44, v44
    v_rcp_f32 v45, v45
    v_rcp_f32 v46, v46
    v_rcp_f32 v47, v47
    v_mul_f32 v72, v72, v40
    v_mul_f32 v73, v73, v41
    v_mul_f32 v74, v74, v42
    v_mul_f32 v75, v75, v43
    v_mul_f32 v76, v76, v44
    v_mul_f32 v77, v77, v45
    v_mul_f32 v78, v78, v46
    v_mul_f32 v79, v79, v47
    v_cvt_pk_bf16_f32 v72, v72, v73
    v_cvt_pk_bf16_f32 v73, v74, v75
    v_cvt_pk_bf16_f32 v74, v76, v77
    v_cvt_pk_bf16_f32 v75, v78, v79
    buffer_store_dwordx4 v[72:75], v10, s[16:19], s44 offen offset:0 sc1
    v_fma_f32 v88, -v21, v136, v88
    v_fma_f32 v89, -v21, v137, v89
    v_fma_f32 v90, -v21, v138, v90
    v_fma_f32 v91, -v21, v139, v91
    v_fma_f32 v92, -v21, v140, v92
    v_fma_f32 v93, -v21, v141, v93
    v_fma_f32 v94, -v21, v142, v94
    v_fma_f32 v95, -v21, v143, v95
    v_fma_f32 v88, v88, v23, v48
    v_fma_f32 v89, v89, v23, v49
    v_fma_f32 v90, v90, v23, v50
    v_fma_f32 v91, v91, v23, v51
    v_fma_f32 v92, v92, v23, v52
    v_fma_f32 v93, v93, v23, v53
    v_fma_f32 v94, v94, v23, v54
    v_fma_f32 v95, v95, v23, v55
    v_mul_f32 v40, v88, v88
    v_mul_f32 v41, v89, v89
    v_mul_f32 v42, v90, v90
    v_mul_f32 v43, v91, v91
    v_mul_f32 v44, v92, v92
    v_mul_f32 v45, v93, v93
    v_mul_f32 v46, v94, v94
    v_mul_f32 v47, v95, v95
    v_fma_f32 v40, v40, s39, v9
    v_fma_f32 v41, v41, s39, v9
    v_fma_f32 v42, v42, s39, v9
    v_fma_f32 v43, v43, s39, v9
    v_fma_f32 v44, v44, s39, v9
    v_fma_f32 v45, v45, s39, v9
    v_fma_f32 v46, v46, s39, v9
    v_fma_f32 v47, v47, s39, v9
    v_mul_f32 v40, v40, v88
    v_mul_f32 v41, v41, v89
    v_mul_f32 v42, v42, v90
    v_mul_f32 v43, v43, v91
    v_mul_f32 v44, v44, v92
    v_mul_f32 v45, v45, v93
    v_mul_f32 v46, v46, v94
    v_mul_f32 v47, v47, v95
    v_exp_f32 v40, v40
    v_exp_f32 v41, v41
    v_exp_f32 v42, v42
    v_exp_f32 v43, v43
    v_exp_f32 v44, v44
    v_exp_f32 v45, v45
    v_exp_f32 v46, v46
    v_exp_f32 v47, v47
    v_add_f32 v40, 1.0, v40
    v_add_f32 v41, 1.0, v41
    v_add_f32 v42, 1.0, v42
    v_add_f32 v43, 1.0, v43
    v_add_f32 v44, 1.0, v44
    v_add_f32 v45, 1.0, v45
    v_add_f32 v46, 1.0, v46
    v_add_f32 v47, 1.0, v47
    v_rcp_f32 v40, v40
    v_rcp_f32 v41, v41
    v_rcp_f32 v42, v42
    v_rcp_f32 v43, v43
    v_rcp_f32 v44, v44
    v_rcp_f32 v45, v45
    v_rcp_f32 v46, v46
    v_rcp_f32 v47, v47
    v_mul_f32 v88, v88, v40
    v_mul_f32 v89, v89, v41
    v_mul_f32 v90, v90, v42
    v_mul_f32 v91, v91, v43
    v_mul_f32 v92, v92, v44
    v_mul_f32 v93, v93, v45
    v_mul_f32 v94, v94, v46
    v_mul_f32 v95, v95, v47
    v_cvt_pk_bf16_f32 v88, v88, v89
    v_cvt_pk_bf16_f32 v89, v90, v91
    v_cvt_pk_bf16_f32 v90, v92, v93
    v_cvt_pk_bf16_f32 v91, v94, v95
    buffer_store_dwordx4 v[88:91], v10, s[16:19], s44 offen offset:1024 sc1
    s_add_u32 s44, s44, 65536
    v_lshlrev_b32 v48, 16, v32
    v_and_b32 v49, 0xffff0000, v32
    v_lshlrev_b32 v50, 16, v33
    v_and_b32 v51, 0xffff0000, v33
    v_lshlrev_b32 v52, 16, v34
    v_and_b32 v53, 0xffff0000, v34
    v_lshlrev_b32 v54, 16, v35
    v_and_b32 v55, 0xffff0000, v35
    v_fma_f32 v96, -v20, v144, v96
    v_fma_f32 v97, -v20, v145, v97
    v_fma_f32 v98, -v20, v146, v98
    v_fma_f32 v99, -v20, v147, v99
    v_fma_f32 v100, -v20, v148, v100
    v_fma_f32 v101, -v20, v149, v101
    v_fma_f32 v102, -v20, v150, v102
    v_fma_f32 v103, -v20, v151, v103
    v_fma_f32 v96, v96, v22, v48
    v_fma_f32 v97, v97, v22, v49
    v_fma_f32 v98, v98, v22, v50
    v_fma_f32 v99, v99, v22, v51
    v_fma_f32 v100, v100, v22, v52
    v_fma_f32 v101, v101, v22, v53
    v_fma_f32 v102, v102, v22, v54
    v_fma_f32 v103, v103, v22, v55
    v_mul_f32 v40, v96, v96
    v_mul_f32 v41, v97, v97
    v_mul_f32 v42, v98, v98
    v_mul_f32 v43, v99, v99
    v_mul_f32 v44, v100, v100
    v_mul_f32 v45, v101, v101
    v_mul_f32 v46, v102, v102
    v_mul_f32 v47, v103, v103
    v_fma_f32 v40, v40, s39, v9
    v_fma_f32 v41, v41, s39, v9
    v_fma_f32 v42, v42, s39, v9
    v_fma_f32 v43, v43, s39, v9
    v_fma_f32 v44, v44, s39, v9
    v_fma_f32 v45, v45, s39, v9
    v_fma_f32 v46, v46, s39, v9
    v_fma_f32 v47, v47, s39, v9
    v_mul_f32 v40, v40, v96
    v_mul_f32 v41, v41, v97
    v_mul_f32 v42, v42, v98
    v_mul_f32 v43, v43, v99
    v_mul_f32 v44, v44, v100
    v_mul_f32 v45, v45, v101
    v_mul_f32 v46, v46, v102
    v_mul_f32 v47, v47, v103
    v_exp_f32 v40, v40
    v_exp_f32 v41, v41
    v_exp_f32 v42, v42
    v_exp_f32 v43, v43
    v_exp_f32 v44, v44
    v_exp_f32 v45, v45
    v_exp_f32 v46, v46
    v_exp_f32 v47, v47
    v_add_f32 v40, 1.0, v40
    v_add_f32 v41, 1.0, v41
    v_add_f32 v42, 1.0, v42
    v_add_f32 v43, 1.0, v43
    v_add_f32 v44, 1.0, v44
    v_add_f32 v45, 1.0, v45
    v_add_f32 v46, 1.0, v46
    v_add_f32 v47, 1.0, v47
    v_rcp_f32 v40, v40
    v_rcp_f32 v41, v41
    v_rcp_f32 v42, v42
    v_rcp_f32 v43, v43
    v_rcp_f32 v44, v44
    v_rcp_f32 v45, v45
    v_rcp_f32 v46, v46
    v_rcp_f32 v47, v47
    v_mul_f32 v96, v96, v40
    v_mul_f32 v97, v97, v41
    v_mul_f32 v98, v98, v42
    v_mul_f32 v99, v99, v43
    v_mul_f32 v100, v100, v44
    v_mul_f32 v101, v101, v45
    v_mul_f32 v102, v102, v46
    v_mul_f32 v103, v103, v47
    v_cvt_pk_bf16_f32 v96, v96, v97
    v_cvt_pk_bf16_f32 v97, v98, v99
    v_cvt_pk_bf16_f32 v98, v100, v101
    v_cvt_pk_bf16_f32 v99, v102, v103
    buffer_store_dwordx4 v[96:99], v10, s[16:19], s45 offen offset:0 sc1
    v_fma_f32 v112, -v21, v144, v112
    v_fma_f32 v113, -v21, v145, v113
    v_fma_f32 v114, -v21, v146, v114
    v_fma_f32 v115, -v21, v147, v115
    v_fma_f32 v116, -v21, v148, v116
    v_fma_f32 v117, -v21, v149, v117
    v_fma_f32 v118, -v21, v150, v118
    v_fma_f32 v119, -v21, v151, v119
    v_fma_f32 v112, v112, v23, v48
    v_fma_f32 v113, v113, v23, v49
    v_fma_f32 v114, v114, v23, v50
    v_fma_f32 v115, v115, v23, v51
    v_fma_f32 v116, v116, v23, v52
    v_fma_f32 v117, v117, v23, v53
    v_fma_f32 v118, v118, v23, v54
    v_fma_f32 v119, v119, v23, v55
    v_mul_f32 v40, v112, v112
    v_mul_f32 v41, v113, v113
    v_mul_f32 v42, v114, v114
    v_mul_f32 v43, v115, v115
    v_mul_f32 v44, v116, v116
    v_mul_f32 v45, v117, v117
    v_mul_f32 v46, v118, v118
    v_mul_f32 v47, v119, v119
    v_fma_f32 v40, v40, s39, v9
    v_fma_f32 v41, v41, s39, v9
    v_fma_f32 v42, v42, s39, v9
    v_fma_f32 v43, v43, s39, v9
    v_fma_f32 v44, v44, s39, v9
    v_fma_f32 v45, v45, s39, v9
    v_fma_f32 v46, v46, s39, v9
    v_fma_f32 v47, v47, s39, v9
    v_mul_f32 v40, v40, v112
    v_mul_f32 v41, v41, v113
    v_mul_f32 v42, v42, v114
    v_mul_f32 v43, v43, v115
    v_mul_f32 v44, v44, v116
    v_mul_f32 v45, v45, v117
    v_mul_f32 v46, v46, v118
    v_mul_f32 v47, v47, v119
    v_exp_f32 v40, v40
    v_exp_f32 v41, v41
    v_exp_f32 v42, v42
    v_exp_f32 v43, v43
    v_exp_f32 v44, v44
    v_exp_f32 v45, v45
    v_exp_f32 v46, v46
    v_exp_f32 v47, v47
    v_add_f32 v40, 1.0, v40
    v_add_f32 v41, 1.0, v41
    v_add_f32 v42, 1.0, v42
    v_add_f32 v43, 1.0, v43
    v_add_f32 v44, 1.0, v44
    v_add_f32 v45, 1.0, v45
    v_add_f32 v46, 1.0, v46
    v_add_f32 v47, 1.0, v47
    v_rcp_f32 v40, v40
    v_rcp_f32 v41, v41
    v_rcp_f32 v42, v42
    v_rcp_f32 v43, v43
    v_rcp_f32 v44, v44
    v_rcp_f32 v45, v45
    v_rcp_f32 v46, v46
    v_rcp_f32 v47, v47
    v_mul_f32 v112, v112, v40
    v_mul_f32 v113, v113, v41
    v_mul_f32 v114, v114, v42
    v_mul_f32 v115, v115, v43
    v_mul_f32 v116, v116, v44
    v_mul_f32 v117, v117, v45
    v_mul_f32 v118, v118, v46
    v_mul_f32 v119, v119, v47
    v_cvt_pk_bf16_f32 v112, v112, v113
    v_cvt_pk_bf16_f32 v113, v114, v115
    v_cvt_pk_bf16_f32 v114, v116, v117
    v_cvt_pk_bf16_f32 v115, v118, v119
    buffer_store_dwordx4 v[112:115], v10, s[16:19], s45 offen offset:1024 sc1
    s_add_u32 s45, s45, 65536
    v_lshlrev_b32 v48, 16, v36
    v_and_b32 v49, 0xffff0000, v36
    v_lshlrev_b32 v50, 16, v37
    v_and_b32 v51, 0xffff0000, v37
    v_lshlrev_b32 v52, 16, v38
    v_and_b32 v53, 0xffff0000, v38
    v_lshlrev_b32 v54, 16, v39
    v_and_b32 v55, 0xffff0000, v39
    v_fma_f32 v104, -v20, v152, v104
    v_fma_f32 v105, -v20, v153, v105
    v_fma_f32 v106, -v20, v154, v106
    v_fma_f32 v107, -v20, v155, v107
    v_fma_f32 v108, -v20, v156, v108
    v_fma_f32 v109, -v20, v157, v109
    v_fma_f32 v110, -v20, v158, v110
    v_fma_f32 v111, -v20, v159, v111
    v_fma_f32 v104, v104, v22, v48
    v_fma_f32 v105, v105, v22, v49
    v_fma_f32 v106, v106, v22, v50
    v_fma_f32 v107, v107, v22, v51
    v_fma_f32 v108, v108, v22, v52
    v_fma_f32 v109, v109, v22, v53
    v_fma_f32 v110, v110, v22, v54
    v_fma_f32 v111, v111, v22, v55
    v_mul_f32 v40, v104, v104
    v_mul_f32 v41, v105, v105
    v_mul_f32 v42, v106, v106
    v_mul_f32 v43, v107, v107
    v_mul_f32 v44, v108, v108
    v_mul_f32 v45, v109, v109
    v_mul_f32 v46, v110, v110
    v_mul_f32 v47, v111, v111
    v_fma_f32 v40, v40, s39, v9
    v_fma_f32 v41, v41, s39, v9
    v_fma_f32 v42, v42, s39, v9
    v_fma_f32 v43, v43, s39, v9
    v_fma_f32 v44, v44, s39, v9
    v_fma_f32 v45, v45, s39, v9
    v_fma_f32 v46, v46, s39, v9
    v_fma_f32 v47, v47, s39, v9
    v_mul_f32 v40, v40, v104
    v_mul_f32 v41, v41, v105
    v_mul_f32 v42, v42, v106
    v_mul_f32 v43, v43, v107
    v_mul_f32 v44, v44, v108
    v_mul_f32 v45, v45, v109
    v_mul_f32 v46, v46, v110
    v_mul_f32 v47, v47, v111
    v_exp_f32 v40, v40
    v_exp_f32 v41, v41
    v_exp_f32 v42, v42
    v_exp_f32 v43, v43
    v_exp_f32 v44, v44
    v_exp_f32 v45, v45
    v_exp_f32 v46, v46
    v_exp_f32 v47, v47
    v_add_f32 v40, 1.0, v40
    v_add_f32 v41, 1.0, v41
    v_add_f32 v42, 1.0, v42
    v_add_f32 v43, 1.0, v43
    v_add_f32 v44, 1.0, v44
    v_add_f32 v45, 1.0, v45
    v_add_f32 v46, 1.0, v46
    v_add_f32 v47, 1.0, v47
    v_rcp_f32 v40, v40
    v_rcp_f32 v41, v41
    v_rcp_f32 v42, v42
    v_rcp_f32 v43, v43
    v_rcp_f32 v44, v44
    v_rcp_f32 v45, v45
    v_rcp_f32 v46, v46
    v_rcp_f32 v47, v47
    v_mul_f32 v104, v104, v40
    v_mul_f32 v105, v105, v41
    v_mul_f32 v106, v106, v42
    v_mul_f32 v107, v107, v43
    v_mul_f32 v108, v108, v44
    v_mul_f32 v109, v109, v45
    v_mul_f32 v110, v110, v46
    v_mul_f32 v111, v111, v47
    v_cvt_pk_bf16_f32 v104, v104, v105
    v_cvt_pk_bf16_f32 v105, v106, v107
    v_cvt_pk_bf16_f32 v106, v108, v109
    v_cvt_pk_bf16_f32 v107, v110, v111
    buffer_store_dwordx4 v[104:107], v10, s[16:19], s45 offen offset:0 sc1
    v_fma_f32 v120, -v21, v152, v120
    v_fma_f32 v121, -v21, v153, v121
    v_fma_f32 v122, -v21, v154, v122
    v_fma_f32 v123, -v21, v155, v123
    v_fma_f32 v124, -v21, v156, v124
    v_fma_f32 v125, -v21, v157, v125
    v_fma_f32 v126, -v21, v158, v126
    v_fma_f32 v127, -v21, v159, v127
    v_fma_f32 v120, v120, v23, v48
    v_fma_f32 v121, v121, v23, v49
    v_fma_f32 v122, v122, v23, v50
    v_fma_f32 v123, v123, v23, v51
    v_fma_f32 v124, v124, v23, v52
    v_fma_f32 v125, v125, v23, v53
    v_fma_f32 v126, v126, v23, v54
    v_fma_f32 v127, v127, v23, v55
    v_mul_f32 v40, v120, v120
    v_mul_f32 v41, v121, v121
    v_mul_f32 v42, v122, v122
    v_mul_f32 v43, v123, v123
    v_mul_f32 v44, v124, v124
    v_mul_f32 v45, v125, v125
    v_mul_f32 v46, v126, v126
    v_mul_f32 v47, v127, v127
    v_fma_f32 v40, v40, s39, v9
    v_fma_f32 v41, v41, s39, v9
    v_fma_f32 v42, v42, s39, v9
    v_fma_f32 v43, v43, s39, v9
    v_fma_f32 v44, v44, s39, v9
    v_fma_f32 v45, v45, s39, v9
    v_fma_f32 v46, v46, s39, v9
    v_fma_f32 v47, v47, s39, v9
    v_mul_f32 v40, v40, v120
    v_mul_f32 v41, v41, v121
    v_mul_f32 v42, v42, v122
    v_mul_f32 v43, v43, v123
    v_mul_f32 v44, v44, v124
    v_mul_f32 v45, v45, v125
    v_mul_f32 v46, v46, v126
    v_mul_f32 v47, v47, v127
    v_exp_f32 v40, v40
    v_exp_f32 v41, v41
    v_exp_f32 v42, v42
    v_exp_f32 v43, v43
    v_exp_f32 v44, v44
    v_exp_f32 v45, v45
    v_exp_f32 v46, v46
    v_exp_f32 v47, v47
    v_add_f32 v40, 1.0, v40
    v_add_f32 v41, 1.0, v41
    v_add_f32 v42, 1.0, v42
    v_add_f32 v43, 1.0, v43
    v_add_f32 v44, 1.0, v44
    v_add_f32 v45, 1.0, v45
    v_add_f32 v46, 1.0, v46
    v_add_f32 v47, 1.0, v47
    v_rcp_f32 v40, v40
    v_rcp_f32 v41, v41
    v_rcp_f32 v42, v42
    v_rcp_f32 v43, v43
    v_rcp_f32 v44, v44
    v_rcp_f32 v45, v45
    v_rcp_f32 v46, v46
    v_rcp_f32 v47, v47
    v_mul_f32 v120, v120, v40
    v_mul_f32 v121, v121, v41
    v_mul_f32 v122, v122, v42
    v_mul_f32 v123, v123, v43
    v_mul_f32 v124, v124, v44
    v_mul_f32 v125, v125, v45
    v_mul_f32 v126, v126, v46
    v_mul_f32 v127, v127, v47
    v_cvt_pk_bf16_f32 v120, v120, v121
    v_cvt_pk_bf16_f32 v121, v122, v123
    v_cvt_pk_bf16_f32 v122, v124, v125
    v_cvt_pk_bf16_f32 v123, v126, v127
    buffer_store_dwordx4 v[120:123], v10, s[16:19], s45 offen offset:1024 sc1
    s_add_u32 s45, s45, 65536
    s_lshl_b32 s37, s32, 8
    s_add_u32 s37, s37, 20897792
    v_mov_b32 v12, 159316
    v_mov_b32 v13, 1
    v_mov_b32 v15, s37
    s_waitcnt vmcnt(0)
    s_mov_b64 exec, 1
    ds_add_rtn_u32 v14, v12, v13
    s_waitcnt lgkmcnt(0)
    v_readfirstlane_b32 s36, v14
    s_cmp_lg_u32 s36, 3
    s_cbranch_scc1 PUB19
    buffer_atomic_add v13, v15, s[16:19], 0 offen sc1
PUB19:
    s_mov_b64 exec, -1
M_FFN2:
    s_setprio 0
    s_mov_b32 s50, s3
    v_lshlrev_b32 v5, 4, v1
    s_lshr_b32 s36, s50, 1
    s_lshl_b32 s36, s36, 10
    v_add_u32 v2, s36, v5
    v_xor_b32 v3, 0x400, v2
    s_and_b32 s36, s50, 1
    s_lshl_b32 s36, s36, 8
    v_xor_b32 v4, s36, v5
    s_lshl_b32 s36, s50, 2
    s_add_u32 s36, s36, 159296
    v_mov_b32 v6, s36
    v_and_b32 v7, 3, v1
    v_lshlrev_b32 v7, 2, v7
    v_add_u32 v7, 159296, v7
    v_mov_b32 v8, 0
    s_mul_i32 s36, s50, 18432
    s_add_u32 s36, s36, 85504
    v_add_u32 v11, s36, v5
    s_mov_b32 s60, s30
    s_mov_b32 s61, s31
    s_mov_b32 s62, 1280
    s_mov_b32 s63, 0x00020000
    s_mov_b32 s64, s72
    s_mov_b32 s65, s73
    s_mov_b32 s66, 2621440
    s_mov_b32 s67, 0x00020000
    s_lshl_b32 s53, s80, 11
    s_mul_i32 s54, s81, 3
    s_lshl_b32 s36, s81, 1
    s_add_u32 s36, s36, 4
    s_cmp_lt_u32 s81, 4
    s_cselect_b32 s54, s54, s36
    s_mul_i32 s70, s50, 1769472
    s_add_u32 s70, s70, s53
    s_add_u32 s70, s70, 10899456
    s_mul_i32 s71, s50, 540
    s_add_u32 s71, s71, s54
    s_lshl_b32 s71, s71, 10
    s_add_u32 s71, s71, 7864320
    s_cmp_lg_u32 s3, 0
    s_cbranch_scc1 GATE20_W
    v_and_b32 v12, 15, v1
    v_lshlrev_b32 v12, 8, v12
    v_add_u32 v12, 20901888, v12
    v_mov_b32 v13, 2
    s_lshr_b32 s36, s80, 1
    s_lshl_b32 s36, s36, 8
    s_add_u32 s36, s36, 20897792
    s_mov_b32 exec_lo, 0
    v_mov_b32 v12, s36
    v_mov_b32 v13, 14
    s_mov_b64 exec, -1
POLL21:
    buffer_load_dword v14, v12, s[16:19], 0 offen sc1
    s_waitcnt vmcnt(0)
    v_cmp_gt_u32 vcc, v13, v14
    s_nop 1
    s_cbranch_vccz POLL21_OK
    s_add_u32 s101, s101, 1
    s_cmp_gt_u32 s101, 0x40000
    s_cbranch_scc1 K_END
    s_sleep 24
    s_branch POLL21
POLL21_OK:
    s_cmp_ge_u32 s33, 14
    s_cbranch_scc1 GATE20_N
    v_mov_b32 v12, 159316
LW22:
    ds_read_b32 v13, v12
    s_waitcnt lgkmcnt(0)
    v_cmp_gt_u32 vcc, 4, v13
    s_nop 1
    s_cbranch_vccz LW22_OK
    s_add_u32 s101, s101, 1
    s_cmp_gt_u32 s101, 0x40000
    s_cbranch_scc1 K_END
    s_sleep 2
    s_branch LW22
LW22_OK:
GATE20_N:
    v_mov_b32 v12, 159328
    v_mov_b32 v13, 1
    s_mov_b64 exec, 1
    ds_add_u32 v12, v13
    s_mov_b64 exec, -1
    s_branch GATE20_G
GATE20_W:
    v_mov_b32 v12, 159328
LW23:
    ds_read_b32 v13, v12
    s_waitcnt lgkmcnt(0)
    v_cmp_gt_u32 vcc, 1, v13
    s_nop 1
    s_cbranch_vccz LW23_OK
    s_add_u32 s101, s101, 1
    s_cmp_gt_u32 s101, 0x40000
    s_cbranch_scc1 K_END
    s_sleep 2
    s_branch LW23
LW23_OK:
GATE20_G:
    s_cmp_lt_u32 s81, 4
    s_cbranch_scc0 FF2_NB2
    s_mul_i32 s74, s50, 200
    s_add_u32 s74, s74, s54
    s_lshl_b32 s74, s74, 10
    s_add_u32 s74, s74, 10076160
    s_add_u32 s75, s74, 81920
    s_mul_i32 s57, s50, 18432
    s_add_u32 s57, s57, 85504
    s_add_u32 m0, s57, 0
    s_nop 0
    buffer_load_dwordx4 v4, s[16:19], s75 offen offset:0 sc1 lds
    buffer_load_dwordx4 v4, s[16:19], s75 offen offset:1024 sc1 lds
    buffer_load_dwordx4 v4, s[16:19], s75 offen offset:2048 sc1 lds
    s_add_u32 s75, s75, 20480
    s_add_u32 m0, s57, 3072
    s_nop 0
    buffer_load_dwordx4 v4, s[16:19], s75 offen offset:0 sc1 lds
    buffer_load_dwordx4 v4, s[16:19], s75 offen offset:1024 sc1 lds
    buffer_load_dwordx4 v4, s[16:19], s75 offen offset:2048 sc1 lds
    s_add_u32 s75, s75, 20480
    s_add_u32 m0, s57, 6144
    s_nop 0
    buffer_load_dwordx4 v4, s[16:19], s75 offen offset:0 sc1 lds
    buffer_load_dwordx4 v4, s[16:19], s75 offen offset:1024 sc1 lds
    buffer_load_dwordx4 v4, s[16:19], s75 offen offset:2048 sc1 lds
    s_add_u32 s75, s75, 20480
    s_add_u32 m0, s57, 9216
    s_nop 0
    buffer_load_dwordx4 v4, s[16:19], s75 offen offset:0 sc1 lds
    buffer_load_dwordx4 v4, s[16:19], s75 offen offset:1024 sc1 lds
    buffer_load_dwordx4 v4, s[16:19], s75 offen offset:2048 sc1 lds
    s_add_u32 s75, s75, 20480
    s_add_u32 m0, s57, 12288
    s_nop 0
    buffer_load_dwordx4 v4, s[16:19], s75 offen offset:0 sc1 lds
    buffer_load_dwordx4 v4, s[16:19], s75 offen offset:1024 sc1 lds
    buffer_load_dwordx4 v4, s[16:19], s75 offen offset:2048 sc1 lds
    s_add_u32 s75, s75, 20480
    s_add_u32 m0, s57, 15360
    s_nop 0
    buffer_load_dwordx4 v4, s[16:19], s75 offen offset:0 sc1 lds
    buffer_load_dwordx4 v4, s[16:19], s75 offen offset:1024 sc1 lds
    buffer_load_dwordx4 v4, s[16:19], s75 offen offset:2048 sc1 lds
    s_add_u32 s75, s75, 20480
    buffer_load_dwordx4 v[12:15], v2, s[16:19], s70 offen sc1
    buffer_load_dwordx4 v[20:23], v4, s[16:19], s71 offen offset:0 sc1
    buffer_load_dwordx4 v[24:27], v4, s[16:19], s71 offen offset:1024 sc1
    buffer_load_dwordx4 v[28:31], v4, s[16:19], s71 offen offset:2048 sc1
    buffer_load_dwordx4 v[16:19], v3, s[16:19], s70 offen sc1
    s_add_u32 s70, s70, 65536
    s_add_u32 s71, s71, 20480
    buffer_load_dwordx4 v[32:35], v2, s[16:19], s70 offen sc1
    buffer_load_dwordx4 v[40:43], v4, s[16:19], s71 offen offset:0 sc1
    buffer_load_dwordx4 v[44:47], v4, s[16:19], s71 offen offset:1024 sc1
    buffer_load_dwordx4 v[48:51], v4, s[16:19], s71 offen offset:2048 sc1
    buffer_load_dwordx4 v[36:39], v3, s[16:19], s70 offen sc1
    s_add_u32 s70, s70, 65536
    s_add_u32 s71, s71, 20480
    s_waitcnt vmcnt(6)
    v_mfma_f32_32x32x16_bf16 v[72:87], v[20:23], v[12:15], 0
    buffer_load_dwordx4 v[52:55], v2, s[16:19], s70 offen sc1
    buffer_load_dwordx4 v[60:63], v4, s[16:19], s71 offen offset:0 sc1
    buffer_load_dwordx4 v[64:67], v4, s[16:19], s71 offen offset:1024 sc1
    buffer_load_dwordx4 v[68:71], v4, s[16:19], s71 offen offset:2048 sc1
    buffer_load_dwordx4 v[56:59], v3, s[16:19], s70 offen sc1
    s_add_u32 s70, s70, 65536
    s_add_u32 s71, s71, 20480
    v_mfma_f32_32x32x16_bf16 v[104:119], v[24:27], v[12:15], 0
    v_mfma_f32_32x32x16_bf16 v[136:151], v[28:31], v[12:15], 0
    s_waitcnt vmcnt(10)
    v_mfma_f32_32x32x16_bf16 v[88:103], v[20:23], v[16:19], 0
    v_mfma_f32_32x32x16_bf16 v[120:135], v[24:27], v[16:19], 0
    v_mfma_f32_32x32x16_bf16 v[152:167], v[28:31], v[16:19], 0
    s_waitcnt vmcnt(6)
    v_mfma_f32_32x32x16_bf16 v[72:87], v[40:43], v[32:35], v[72:87]
    buffer_load_dwordx4 v[12:15], v2, s[16:19], s70 offen sc1
    buffer_load_dwordx4 v[20:23], v4, s[16:19], s71 offen offset:0 sc1
    buffer_load_dwordx4 v[24:27], v4, s[16:19], s71 offen offset:1024 sc1
    buffer_load_dwordx4 v[28:31], v4, s[16:19], s71 offen offset:2048 sc1
    buffer_load_dwordx4 v[16:19], v3, s[16:19], s70 offen sc1
    s_add_u32 s70, s70, 65536
    s_add_u32 s71, s71, 20480
    v_mfma_f32_32x32x16_bf16 v[104:119], v[44:47], v[32:35], v[104:119]
    v_mfma_f32_32x32x16_bf16 v[136:151], v[48:51], v[32:35], v[136:151]
    s_waitcnt vmcnt(10)
    v_mfma_f32_32x32x16_bf16 v[88:103], v[40:43], v[36:39], v[88:103]
    v_mfma_f32_32x32x16_bf16 v[120:135], v[44:47], v[36:39], v[120:135]
    v_mfma_f32_32x32x16_bf16 v[152:167], v[48:51], v[36:39], v[152:167]
    s_waitcnt vmcnt(6)
    v_mfma_f32_32x32x16_bf16 v[72:87], v[60:63], v[52:55], v[72:87]
    buffer_load_dwordx4 v[32:35], v2, s[16:19], s70 offen sc1
    buffer_load_dwordx4 v[40:43], v4, s[16:19], s71 offen offset:0 sc1
    buffer_load_dwordx4 v[44:47], v4, s[16:19], s71 offen offset:1024 sc1
    buffer_load_dwordx4 v[48:51], v4, s[16:19], s71 offen offset:2048 sc1
    buffer_load_dwordx4 v[36:39], v3, s[16:19], s70 offen sc1
    s_add_u32 s70, s70, 65536
    s_add_u32 s71, s71, 20480
    v_mfma_f32_32x32x16_bf16 v[104:119], v[64:67], v[52:55], v[104:119]
    v_mfma_f32_32x32x16_bf16 v[136:151], v[68:71], v[52:55], v[136:151]
    s_waitcnt vmcnt(10)
    v_mfma_f32_32x32x16_bf16 v[88:103], v[60:63], v[56:59], v[88:103]
    v_mfma_f32_32x32x16_bf16 v[120:135], v[64:67], v[56:59], v[120:135]
    v_mfma_f32_32x32x16_bf16 v[152:167], v[68:71], v[56:59], v[152:167]
    s_waitcnt vmcnt(6)
    v_mfma_f32_32x32x16_bf16 v[72:87], v[20:23], v[12:15], v[72:87]
    buffer_load_dwordx4 v[52:55], v2, s[16:19], s70 offen sc1
    buffer_load_dwordx4 v[60:63], v4, s[16:19], s71 offen offset:0 sc1
    buffer_load_dwordx4 v[64:67], v4, s[16:19], s71 offen offset:1024 sc1
    buffer_load_dwordx4 v[68:71], v4, s[16:19], s71 offen offset:2048 sc1
    buffer_load_dwordx4 v[56:59], v3, s[16:19], s70 offen sc1
    s_add_u32 s70, s70, 65536
    s_add_u32 s71, s71, 20480
    v_mfma_f32_32x32x16_bf16 v[104:119], v[24:27], v[12:15], v[104:119]
    v_mfma_f32_32x32x16_bf16 v[136:151], v[28:31], v[12:15], v[136:151]
    s_waitcnt vmcnt(10)
    v_mfma_f32_32x32x16_bf16 v[88:103], v[20:23], v[16:19], v[88:103]
    v_mfma_f32_32x32x16_bf16 v[120:135], v[24:27], v[16:19], v[120:135]
    v_mfma_f32_32x32x16_bf16 v[152:167], v[28:31], v[16:19], v[152:167]
    s_waitcnt vmcnt(6)
    v_mfma_f32_32x32x16_bf16 v[72:87], v[40:43], v[32:35], v[72:87]
    buffer_load_dwordx4 v[12:15], v2, s[16:19], s70 offen sc1
    buffer_load_dwordx4 v[20:23], v4, s[16:19], s71 offen offset:0 sc1
    buffer_load_dwordx4 v[24:27], v4, s[16:19], s71 offen offset:1024 sc1
    buffer_load_dwordx4 v[28:31], v4, s[16:19], s71 offen offset:2048 sc1
    buffer_load_dwordx4 v[16:19], v3, s[16:19], s70 offen sc1
    s_add_u32 s70, s70, 65536
    s_add_u32 s71, s71, 20480
    v_mfma_f32_32x32x16_bf16 v[104:119], v[44:47], v[32:35], v[104:119]
    v_mfma_f32_32x32x16_bf16 v[136:151], v[48:51], v[32:35], v[136:151]
    s_waitcnt vmcnt(10)
    v_mfma_f32_32x32x16_bf16 v[88:103], v[40:43], v[36:39], v[88:103]
    v_mfma_f32_32x32x16_bf16 v[120:135], v[44:47], v[36:39], v[120:135]
    v_mfma_f32_32x32x16_bf16 v[152:167], v[48:51], v[36:39], v[152:167]
    s_waitcnt vmcnt(6)
    v_mfma_f32_32x32x16_bf16 v[72:87], v[60:63], v[52:55], v[72:87]
    buffer_load_dwordx4 v[32:35], v2, s[16:19], s70 offen sc1
    buffer_load_dwordx4 v[40:43], v4, s[16:19], s71 offen offset:0 sc1
    buffer_load_dwordx4 v[44:47], v4, s[16:19], s71 offen offset:1024 sc1
    buffer_load_dwordx4 v[48:51], v4, s[16:19], s71 offen offset:2048 sc1
    buffer_load_dwordx4 v[36:39], v3, s[16:19], s70 offen sc1
    s_add_u32 s70, s70, 65536
    s_add_u32 s71, s71, 20480
    v_mfma_f32_32x32x16_bf16 v[104:119], v[64:67], v[52:55], v[104:119]
    v_mfma_f32_32x32x16_bf16 v[136:151], v[68:71], v[52:55], v[136:151]
    s_waitcnt vmcnt(10)
    v_mfma_f32_32x32x16_bf16 v[88:103], v[60:63], v[56:59], v[88:103]
    v_mfma_f32_32x32x16_bf16 v[120:135], v[64:67], v[56:59], v[120:135]
    v_mfma_f32_32x32x16_bf16 v[152:167], v[68:71], v[56:59], v[152:167]
    s_waitcnt vmcnt(6)
    v_mfma_f32_32x32x16_bf16 v[72:87], v[20:23], v[12:15], v[72:87]
    buffer_load_dwordx4 v[52:55], v2, s[16:19], s70 offen sc1
    buffer_load_dwordx4 v[60:63], v4, s[16:19], s71 offen offset:0 sc1
    buffer_load_dwordx4 v[64:67], v4, s[16:19], s71 offen offset:1024 sc1
    buffer_load_dwordx4 v[68:71], v4, s[16:19], s71 offen offset:2048 sc1
    buffer_load_dwordx4 v[56:59], v3, s[16:19], s70 offen sc1
    s_add_u32 s70, s70, 65536
    s_add_u32 s71, s71, 20480
    v_mfma_f32_32x32x16_bf16 v[104:119], v[24:27], v[12:15], v[104:119]
    v_mfma_f32_32x32x16_bf16 v[136:151], v[28:31], v[12:15], v[136:151]
    s_waitcnt vmcnt(10)
    v_mfma_f32_32x32x16_bf16 v[88:103], v[20:23], v[16:19], v[88:103]
    v_mfma_f32_32x32x16_bf16 v[120:135], v[24:27], v[16:19], v[120:135]
    v_mfma_f32_32x32x16_bf16 v[152:167], v[28:31], v[16:19], v[152:167]
    s_waitcnt vmcnt(6)
    v_mfma_f32_32x32x16_bf16 v[72:87], v[40:43], v[32:35], v[72:87]
    buffer_load_dwordx4 v[12:15], v2, s[16:19], s70 offen sc1
    buffer_load_dwordx4 v[20:23], v4, s[16:19], s71 offen offset:0 sc1
    buffer_load_dwordx4 v[24:27], v4, s[16:19], s71 offen offset:1024 sc1
    buffer_load_dwordx4 v[28:31], v4, s[16:19], s71 offen offset:2048 sc1
    buffer_load_dwordx4 v[16:19], v3, s[16:19], s70 offen sc1
    s_add_u32 s70, s70, 65536
    s_add_u32 s71, s71, 20480
    v_mfma_f32_32x32x16_bf16 v[104:119], v[44:47], v[32:35], v[104:119]
    v_mfma_f32_32x32x16_bf16 v[136:151], v[48:51], v[32:35], v[136:151]
    s_waitcnt vmcnt(10)
    v_mfma_f32_32x32x16_bf16 v[88:103], v[40:43], v[36:39], v[88:103]
    v_mfma_f32_32x32x16_bf16 v[120:135], v[44:47], v[36:39], v[120:135]
    v_mfma_f32_32x32x16_bf16 v[152:167], v[48:51], v[36:39], v[152:167]
    s_waitcnt vmcnt(6)
    v_mfma_f32_32x32x16_bf16 v[72:87], v[60:63], v[52:55], v[72:87]
    buffer_load_dwordx4 v[32:35], v2, s[16:19], s70 offen sc1
    buffer_load_dwordx4 v[40:43], v4, s[16:19], s71 offen offset:0 sc1
    buffer_load_dwordx4 v[44:47], v4, s[16:19], s71 offen offset:1024 sc1
    buffer_load_dwordx4 v[48:51], v4, s[16:19], s71 offen offset:2048 sc1
    buffer_load_dwordx4 v[36:39], v3, s[16:19], s70 offen sc1
    s_add_u32 s70, s70, 65536
    s_add_u32 s71, s71, 20480
    v_mfma_f32_32x32x16_bf16 v[104:119], v[64:67], v[52:55], v[104:119]
    v_mfma_f32_32x32x16_bf16 v[136:151], v[68:71], v[52:55], v[136:151]
    s_waitcnt vmcnt(10)
    v_mfma_f32_32x32x16_bf16 v[88:103], v[60:63], v[56:59], v[88:103]
    v_mfma_f32_32x32x16_bf16 v[120:135], v[64:67], v[56:59], v[120:135]
    v_mfma_f32_32x32x16_bf16 v[152:167], v[68:71], v[56:59], v[152:167]
    s_waitcnt vmcnt(6)
    v_mfma_f32_32x32x16_bf16 v[72:87], v[20:23], v[12:15], v[72:87]
    buffer_load_dwordx4 v[52:55], v2, s[16:19], s70 offen sc1
    buffer_load_dwordx4 v[60:63], v4, s[16:19], s71 offen offset:0 sc1
    buffer_load_dwordx4 v[64:67], v4, s[16:19], s71 offen offset:1024 sc1
    buffer_load_dwordx4 v[68:71], v4, s[16:19], s71 offen offset:2048 sc1
    buffer_load_dwordx4 v[56:59], v3, s[16:19], s70 offen sc1
    s_add_u32 s70, s70, 65536
    s_add_u32 s71, s71, 20480
    v_mfma_f32_32x32x16_bf16 v[104:119], v[24:27], v[12:15], v[104:119]
    v_mfma_f32_32x32x16_bf16 v[136:151], v[28:31], v[12:15], v[136:151]
    s_waitcnt vmcnt(10)
    v_mfma_f32_32x32x16_bf16 v[88:103], v[20:23], v[16:19], v[88:103]
    v_mfma_f32_32x32x16_bf16 v[120:135], v[24:27], v[16:19], v[120:135]
    v_mfma_f32_32x32x16_bf16 v[152:167], v[28:31], v[16:19], v[152:167]
    s_waitcnt vmcnt(6)
    v_mfma_f32_32x32x16_bf16 v[72:87], v[40:43], v[32:35], v[72:87]
    buffer_load_dwordx4 v[12:15], v2, s[16:19], s70 offen sc1
    buffer_load_dwordx4 v[20:23], v4, s[16:19], s71 offen offset:0 sc1
    buffer_load_dwordx4 v[24:27], v4, s[16:19], s71 offen offset:1024 sc1
    buffer_load_dwordx4 v[28:31], v4, s[16:19], s71 offen offset:2048 sc1
    buffer_load_dwordx4 v[16:19], v3, s[16:19], s70 offen sc1
    s_add_u32 s70, s70, 65536
    s_add_u32 s71, s71, 20480
    v_mfma_f32_32x32x16_bf16 v[104:119], v[44:47], v[32:35], v[104:119]
    v_mfma_f32_32x32x16_bf16 v[136:151], v[48:51], v[32:35], v[136:151]
    s_waitcnt vmcnt(10)
    v_mfma_f32_32x32x16_bf16 v[88:103], v[40:43], v[36:39], v[88:103]
    v_mfma_f32_32x32x16_bf16 v[120:135], v[44:47], v[36:39], v[120:135]
    v_mfma_f32_32x32x16_bf16 v[152:167], v[48:51], v[36:39], v[152:167]
    s_waitcnt vmcnt(6)
    v_mfma_f32_32x32x16_bf16 v[72:87], v[60:63], v[52:55], v[72:87]
    buffer_load_dwordx4 v[32:35], v2, s[16:19], s70 offen sc1
    buffer_load_dwordx4 v[40:43], v4, s[16:19], s71 offen offset:0 sc1
    buffer_load_dwordx4 v[44:47], v4, s[16:19], s71 offen offset:1024 sc1
    buffer_load_dwordx4 v[48:51], v4, s[16:19], s71 offen offset:2048 sc1
    buffer_load_dwordx4 v[36:39], v3, s[16:19], s70 offen sc1
    s_add_u32 s70, s70, 65536
    s_add_u32 s71, s71, 20480
    v_mfma_f32_32x32x16_bf16 v[104:119], v[64:67], v[52:55], v[104:119]
    v_mfma_f32_32x32x16_bf16 v[136:151], v[68:71], v[52:55], v[136:151]
    s_waitcnt vmcnt(10)
    v_mfma_f32_32x32x16_bf16 v[88:103], v[60:63], v[56:59], v[88:103]
    v_mfma_f32_32x32x16_bf16 v[120:135], v[64:67], v[56:59], v[120:135]
    v_mfma_f32_32x32x16_bf16 v[152:167], v[68:71], v[56:59], v[152:167]
    s_waitcnt vmcnt(6)
    v_mfma_f32_32x32x16_bf16 v[72:87], v[20:23], v[12:15], v[72:87]
    buffer_load_dwordx4 v[52:55], v2, s[16:19], s70 offen sc1
    buffer_load_dwordx4 v[60:63], v4, s[16:19], s71 offen offset:0 sc1
    buffer_load_dwordx4 v[64:67], v4, s[16:19], s71 offen offset:1024 sc1
    buffer_load_dwordx4 v[68:71], v4, s[16:19], s71 offen offset:2048 sc1
    buffer_load_dwordx4 v[56:59], v3, s[16:19], s70 offen sc1
    s_add_u32 s70, s70, 65536
    s_add_u32 s71, s71, 20480
    v_mfma_f32_32x32x16_bf16 v[104:119], v[24:27], v[12:15], v[104:119]
    v_mfma_f32_32x32x16_bf16 v[136:151], v[28:31], v[12:15], v[136:151]
    s_waitcnt vmcnt(10)
    v_mfma_f32_32x32x16_bf16 v[88:103], v[20:23], v[16:19], v[88:103]
    v_mfma_f32_32x32x16_bf16 v[120:135], v[24:27], v[16:19], v[120:135]
    v_mfma_f32_32x32x16_bf16 v[152:167], v[28:31], v[16:19], v[152:167]
    s_waitcnt vmcnt(6)
    v_mfma_f32_32x32x16_bf16 v[72:87], v[40:43], v[32:35], v[72:87]
    buffer_load_dwordx4 v[12:15], v2, s[16:19], s70 offen sc1
    buffer_load_dwordx4 v[20:23], v4, s[16:19], s71 offen offset:0 sc1
    buffer_load_dwordx4 v[24:27], v4, s[16:19], s71 offen offset:1024 sc1
    buffer_load_dwordx4 v[28:31], v4, s[16:19], s71 offen offset:2048 sc1
    buffer_load_dwordx4 v[16:19], v3, s[16:19], s70 offen sc1
    s_add_u32 s70, s70, 65536
    s_add_u32 s71, s71, 20480
    v_mfma_f32_32x32x16_bf16 v[104:119], v[44:47], v[32:35], v[104:119]
    v_mfma_f32_32x32x16_bf16 v[136:151], v[48:51], v[32:35], v[136:151]
    s_waitcnt vmcnt(10)
    v_mfma_f32_32x32x16_bf16 v[88:103], v[40:43], v[36:39], v[88:103]
    v_mfma_f32_32x32x16_bf16 v[120:135], v[44:47], v[36:39], v[120:135]
    v_mfma_f32_32x32x16_bf16 v[152:167], v[48:51], v[36:39], v[152:167]
    s_waitcnt vmcnt(6)
    v_mfma_f32_32x32x16_bf16 v[72:87], v[60:63], v[52:55], v[72:87]
    buffer_load_dwordx4 v[32:35], v2, s[16:19], s70 offen sc1
    buffer_load_dwordx4 v[40:43], v4, s[16:19], s71 offen offset:0 sc1
    buffer_load_dwordx4 v[44:47], v4, s[16:19], s71 offen offset:1024 sc1
    buffer_load_dwordx4 v[48:51], v4, s[16:19], s71 offen offset:2048 sc1
    buffer_load_dwordx4 v[36:39], v3, s[16:19], s70 offen sc1
    s_add_u32 s70, s70, 65536
    s_add_u32 s71, s71, 20480
    v_mfma_f32_32x32x16_bf16 v[104:119], v[64:67], v[52:55], v[104:119]
    v_mfma_f32_32x32x16_bf16 v[136:151], v[68:71], v[52:55], v[136:151]
    s_waitcnt vmcnt(10)
    v_mfma_f32_32x32x16_bf16 v[88:103], v[60:63], v[56:59], v[88:103]
    v_mfma_f32_32x32x16_bf16 v[120:135], v[64:67], v[56:59], v[120:135]
    v_mfma_f32_32x32x16_bf16 v[152:167], v[68:71], v[56:59], v[152:167]
    s_waitcnt vmcnt(6)
    v_mfma_f32_32x32x16_bf16 v[72:87], v[20:23], v[12:15], v[72:87]
    buffer_load_dwordx4 v[52:55], v2, s[16:19], s70 offen sc1
    buffer_load_dwordx4 v[60:63], v4, s[16:19], s71 offen offset:0 sc1
    buffer_load_dwordx4 v[64:67], v4, s[16:19], s71 offen offset:1024 sc1
    buffer_load_dwordx4 v[68:71], v4, s[16:19], s71 offen offset:2048 sc1
    buffer_load_dwordx4 v[56:59], v3, s[16:19], s70 offen sc1
    s_add_u32 s70, s70, 65536
    s_add_u32 s71, s71, 20480
    v_mfma_f32_32x32x16_bf16 v[104:119], v[24:27], v[12:15], v[104:119]
    v_mfma_f32_32x32x16_bf16 v[136:151], v[28:31], v[12:15], v[136:151]
    s_waitcnt vmcnt(10)
    v_mfma_f32_32x32x16_bf16 v[88:103], v[20:23], v[16:19], v[88:103]
    v_mfma_f32_32x32x16_bf16 v[120:135], v[24:27], v[16:19], v[120:135]
    v_mfma_f32_32x32x16_bf16 v[152:167], v[28:31], v[16:19], v[152:167]
    s_waitcnt vmcnt(6)
    v_mfma_f32_32x32x16_bf16 v[72:87], v[40:43], v[32:35], v[72:87]
    buffer_load_dwordx4 v[12:15], v2, s[16:19], s70 offen sc1
    buffer_load_dwordx4 v[20:23], v4, s[16:19], s71 offen offset:0 sc1
    buffer_load_dwordx4 v[24:27], v4, s[16:19], s71 offen offset:1024 sc1
    buffer_load_dwordx4 v[28:31], v4, s[16:19], s71 offen offset:2048 sc1
    buffer_load_dwordx4 v[16:19], v3, s[16:19], s70 offen sc1
    s_add_u32 s70, s70, 65536
    s_add_u32 s71, s71, 20480
    v_mfma_f32_32x32x16_bf16 v[104:119], v[44:47], v[32:35], v[104:119]
    v_mfma_f32_32x32x16_bf16 v[136:151], v[48:51], v[32:35], v[136:151]
    s_waitcnt vmcnt(10)
    v_mfma_f32_32x32x16_bf16 v[88:103], v[40:43], v[36:39], v[88:103]
    v_mfma_f32_32x32x16_bf16 v[120:135], v[44:47], v[36:39], v[120:135]
    v_mfma_f32_32x32x16_bf16 v[152:167], v[48:51], v[36:39], v[152:167]
    s_waitcnt vmcnt(6)
    v_mfma_f32_32x32x16_bf16 v[72:87], v[60:63], v[52:55], v[72:87]
    buffer_load_dwordx4 v[32:35], v2, s[16:19], s70 offen sc1
    buffer_load_dwordx4 v[40:43], v4, s[16:19], s71 offen offset:0 sc1
    buffer_load_dwordx4 v[44:47], v4, s[16:19], s71 offen offset:1024 sc1
    buffer_load_dwordx4 v[48:51], v4, s[16:19], s71 offen offset:2048 sc1
    buffer_load_dwordx4 v[36:39], v3, s[16:19], s70 offen sc1
    s_add_u32 s70, s70, 65536
    s_add_u32 s71, s71, 20480
    v_mfma_f32_32x32x16_bf16 v[104:119], v[64:67], v[52:55], v[104:119]
    v_mfma_f32_32x32x16_bf16 v[136:151], v[68:71], v[52:55], v[136:151]
    s_waitcnt vmcnt(10)
    v_mfma_f32_32x32x16_bf16 v[88:103], v[60:63], v[56:59], v[88:103]
    v_mfma_f32_32x32x16_bf16 v[120:135], v[64:67], v[56:59], v[120:135]
    v_mfma_f32_32x32x16_bf16 v[152:167], v[68:71], v[56:59], v[152:167]
    s_waitcnt vmcnt(6)
    v_mfma_f32_32x32x16_bf16 v[72:87], v[20:23], v[12:15], v[72:87]
    buffer_load_dwordx4 v[52:55], v2, s[16:19], s70 offen sc1
    buffer_load_dwordx4 v[60:63], v4, s[16:19], s71 offen offset:0 sc1
    buffer_load_dwordx4 v[64:67], v4, s[16:19], s71 offen offset:1024 sc1
    buffer_load_dwordx4 v[68:71], v4, s[16:19], s71 offen offset:2048 sc1
    buffer_load_dwordx4 v[56:59], v3, s[16:19], s70 offen sc1
    s_add_u32 s70, s70, 65536
    s_add_u32 s71, s71, 20480
    v_mfma_f32_32x32x16_bf16 v[104:119], v[24:27], v[12:15], v[104:119]
    v_mfma_f32_32x32x16_bf16 v[136:151], v[28:31], v[12:15], v[136:151]
    s_waitcnt vmcnt(10)
    v_mfma_f32_32x32x16_bf16 v[88:103], v[20:23], v[16:19], v[88:103]
    v_mfma_f32_32x32x16_bf16 v[120:135], v[24:27], v[16:19], v[120:135]
    v_mfma_f32_32x32x16_bf16 v[152:167], v[28:31], v[16:19], v[152:167]
    s_waitcnt vmcnt(6)
    v_mfma_f32_32x32x16_bf16 v[72:87], v[40:43], v[32:35], v[72:87]
    buffer_load_dwordx4 v[12:15], v2, s[16:19], s70 offen sc1
    buffer_load_dwordx4 v[20:23], v4, s[16:19], s71 offen offset:0 sc1
    buffer_load_dwordx4 v[24:27], v4, s[16:19], s71 offen offset:1024 sc1
    buffer_load_dwordx4 v[28:31], v4, s[16:19], s71 offen offset:2048 sc1
    buffer_load_dwordx4 v[16:19], v3, s[16:19], s70 offen sc1
    s_add_u32 s70, s70, 65536
    s_add_u32 s71, s71, 20480
    v_mfma_f32_32x32x16_bf16 v[104:119], v[44:47], v[32:35], v[104:119]
    v_mfma_f32_32x32x16_bf16 v[136:151], v[48:51], v[32:35], v[136:151]
    s_waitcnt vmcnt(10)
    v_mfma_f32_32x32x16_bf16 v[88:103], v[40:43], v[36:39], v[88:103]
    v_mfma_f32_32x32x16_bf16 v[120:135], v[44:47], v[36:39], v[120:135]
    v_mfma_f32_32x32x16_bf16 v[152:167], v[48:51], v[36:39], v[152:167]
    s_waitcnt vmcnt(6)
    v_mfma_f32_32x32x16_bf16 v[72:87], v[60:63], v[52:55], v[72:87]
    buffer_load_dwordx4 v[32:35], v2, s[16:19], s70 offen sc1
    buffer_load_dwordx4 v[40:43], v4, s[16:19], s71 offen offset:0 sc1
    buffer_load_dwordx4 v[44:47], v4, s[16:19], s71 offen offset:1024 sc1
    buffer_load_dwordx4 v[48:51], v4, s[16:19], s71 offen offset:2048 sc1
    buffer_load_dwordx4 v[36:39], v3, s[16:19], s70 offen sc1
    s_add_u32 s70, s70, 65536
    s_add_u32 s71, s71, 20480
    v_mfma_f32_32x32x16_bf16 v[104:119], v[64:67], v[52:55], v[104:119]
    v_mfma_f32_32x32x16_bf16 v[136:151], v[68:71], v[52:55], v[136:151]
    s_waitcnt vmcnt(10)
    v_mfma_f32_32x32x16_bf16 v[88:103], v[60:63], v[56:59], v[88:103]
    v_mfma_f32_32x32x16_bf16 v[120:135], v[64:67], v[56:59], v[120:135]
    v_mfma_f32_32x32x16_bf16 v[152:167], v[68:71], v[56:59], v[152:167]
    s_waitcnt vmcnt(6)
    v_mfma_f32_32x32x16_bf16 v[72:87], v[20:23], v[12:15], v[72:87]
    buffer_load_dwordx4 v[52:55], v2, s[16:19], s70 offen sc1
    buffer_load_dwordx4 v[60:63], v4, s[16:19], s71 offen offset:0 sc1
    buffer_load_dwordx4 v[64:67], v4, s[16:19], s71 offen offset:1024 sc1
    buffer_load_dwordx4 v[68:71], v4, s[16:19], s71 offen offset:2048 sc1
    buffer_load_dwordx4 v[56:59], v3, s[16:19], s70 offen sc1
    s_add_u32 s70, s70, 65536
    s_add_u32 s71, s71, 20480
    v_mfma_f32_32x32x16_bf16 v[104:119], v[24:27], v[12:15], v[104:119]
    v_mfma_f32_32x32x16_bf16 v[136:151], v[28:31], v[12:15], v[136:151]
    s_waitcnt vmcnt(10)
    v_mfma_f32_32x32x16_bf16 v[88:103], v[20:23], v[16:19], v[88:103]
    v_mfma_f32_32x32x16_bf16 v[120:135], v[24:27], v[16:19], v[120:135]
    v_mfma_f32_32x32x16_bf16 v[152:167], v[28:31], v[16:19], v[152:167]
    s_waitcnt vmcnt(6)
    v_mfma_f32_32x32x16_bf16 v[72:87], v[40:43], v[32:35], v[72:87]
    buffer_load_dwordx4 v[12:15], v2, s[16:19], s70 offen sc1
    buffer_load_dwordx4 v[20:23], v4, s[16:19], s71 offen offset:0 sc1
    buffer_load_dwordx4 v[24:27], v4, s[16:19], s71 offen offset:1024 sc1
    buffer_load_dwordx4 v[28:31], v4, s[16:19], s71 offen offset:2048 sc1
    buffer_load_dwordx4 v[16:19], v3, s[16:19], s70 offen sc1
    s_add_u32 s70, s70, 65536
    s_add_u32 s71, s71, 20480
    v_mfma_f32_32x32x16_bf16 v[104:119], v[44:47], v[32:35], v[104:119]
    v_mfma_f32_32x32x16_bf16 v[136:151], v[48:51], v[32:35], v[136:151]
    s_waitcnt vmcnt(10)
    v_mfma_f32_32x32x16_bf16 v[88:103], v[40:43], v[36:39], v[88:103]
    v_mfma_f32_32x32x16_bf16 v[120:135], v[44:47], v[36:39], v[120:135]
    v_mfma_f32_32x32x16_bf16 v[152:167], v[48:51], v[36:39], v[152:167]
    s_waitcnt vmcnt(6)
    v_mfma_f32_32x32x16_bf16 v[72:87], v[60:63], v[52:55], v[72:87]
    buffer_load_dwordx4 v[32:35], v2, s[16:19], s70 offen sc1
    buffer_load_dwordx4 v[40:43], v4, s[16:19], s71 offen offset:0 sc1
    buffer_load_dwordx4 v[44:47], v4, s[16:19], s71 offen offset:1024 sc1
    buffer_load_dwordx4 v[48:51], v4, s[16:19], s71 offen offset:2048 sc1
    buffer_load_dwordx4 v[36:39], v3, s[16:19], s70 offen sc1
    s_add_u32 s70, s70, 65536
    s_add_u32 s71, s71, 20480
    v_mfma_f32_32x32x16_bf16 v[104:119], v[64:67], v[52:55], v[104:119]
    v_mfma_f32_32x32x16_bf16 v[136:151], v[68:71], v[52:55], v[136:151]
    s_waitcnt vmcnt(10)
    v_mfma_f32_32x32x16_bf16 v[88:103], v[60:63], v[56:59], v[88:103]
    v_mfma_f32_32x32x16_bf16 v[120:135], v[64:67], v[56:59], v[120:135]
    v_mfma_f32_32x32x16_bf16 v[152:167], v[68:71], v[56:59], v[152:167]
    s_waitcnt vmcnt(6)
    v_mfma_f32_32x32x16_bf16 v[72:87], v[20:23], v[12:15], v[72:87]
    buffer_load_dwordx4 v[52:55], v2, s[16:19], s70 offen sc1
    buffer_load_dwordx4 v[60:63], v4, s[16:19], s71 offen offset:0 sc1
    buffer_load_dwordx4 v[64:67], v4, s[16:19], s71 offen offset:1024 sc1
    buffer_load_dwordx4 v[68:71], v4, s[16:19], s71 offen offset:2048 sc1
    buffer_load_dwordx4 v[56:59], v3, s[16:19], s70 offen sc1
    v_mfma_f32_32x32x16_bf16 v[104:119], v[24:27], v[12:15], v[104:119]
    v_mfma_f32_32x32x16_bf16 v[136:151], v[28:31], v[12:15], v[136:151]
    s_waitcnt vmcnt(10)
    v_mfma_f32_32x32x16_bf16 v[88:103], v[20:23], v[16:19], v[88:103]
    v_mfma_f32_32x32x16_bf16 v[120:135], v[24:27], v[16:19], v[120:135]
    v_mfma_f32_32x32x16_bf16 v[152:167], v[28:31], v[16:19], v[152:167]
    s_waitcnt vmcnt(6)
    v_mfma_f32_32x32x16_bf16 v[72:87], v[40:43], v[32:35], v[72:87]
    v_mfma_f32_32x32x16_bf16 v[104:119], v[44:47], v[32:35], v[104:119]
    v_mfma_f32_32x32x16_bf16 v[136:151], v[48:51], v[32:35], v[136:151]
    s_waitcnt vmcnt(5)
    v_mfma_f32_32x32x16_bf16 v[88:103], v[40:43], v[36:39], v[88:103]
    v_mfma_f32_32x32x16_bf16 v[120:135], v[44:47], v[36:39], v[120:135]
    v_mfma_f32_32x32x16_bf16 v[152:167], v[48:51], v[36:39], v[152:167]
    s_waitcnt vmcnt(1)
    v_mfma_f32_32x32x16_bf16 v[72:87], v[60:63], v[52:55], v[72:87]
    v_mfma_f32_32x32x16_bf16 v[104:119], v[64:67], v[52:55], v[104:119]
    v_mfma_f32_32x32x16_bf16 v[136:151], v[68:71], v[52:55], v[136:151]
    s_waitcnt vmcnt(0)
    v_mfma_f32_32x32x16_bf16 v[88:103], v[60:63], v[56:59], v[88:103]
    v_mfma_f32_32x32x16_bf16 v[120:135], v[64:67], v[56:59], v[120:135]
    v_mfma_f32_32x32x16_bf16 v[152:167], v[68:71], v[56:59], v[152:167]
    s_lshr_b32 s36, s50, 1
    s_and_b32 s37, s50, 1
    s_lshl_b32 s72, s54, 6
    s_lshl_b32 s38, s37, 5
    s_add_u32 s72, s72, s38
    s_lshl_b32 s56, s80, 1
    s_add_u32 s56, s56, s36
    s_mul_i32 s56, s56, 40960
    s_add_u32 s56, s56, s72
    v_lshrrev_b32 v13, 5, v1
    v_lshlrev_b32 v13, 3, v13
    v_and_b32 v12, 31, v1
    v_mul_u32_u24 v12, 1280, v12
    v_add_u32 v12, v12, v13
    v_add_u32 v0, v12, v13
    buffer_load_dwordx2 v[16:17], v13, s[60:63], s72 offen offset:0
    buffer_load_dwordx2 v[18:19], v13, s[60:63], s72 offen offset:16
    buffer_load_dwordx2 v[28:29], v12, s[8:11], s56 offen offset:0
    buffer_load_dwordx2 v[30:31], v12, s[8:11], s56 offen offset:16
    buffer_load_dwordx2 v[20:21], v13, s[60:63], s72 offen offset:64
    buffer_load_dwordx2 v[22:23], v13, s[60:63], s72 offen offset:80
    buffer_load_dwordx2 v[32:33], v12, s[8:11], s56 offen offset:64
    buffer_load_dwordx2 v[34:35], v12, s[8:11], s56 offen offset:80
    buffer_load_dwordx2 v[24:25], v13, s[60:63], s72 offen offset:128
    buffer_load_dwordx2 v[26:27], v13, s[60:63], s72 offen offset:144
    buffer_load_dwordx2 v[36:37], v12, s[8:11], s56 offen offset:128
    buffer_load_dwordx2 v[38:39], v12, s[8:11], s56 offen offset:144
    s_waitcnt vmcnt(0)
    v_lshlrev_b32 v14, 16, v16
    v_and_b32 v15, 0xffff0000, v16
    v_add_f32 v72, v72, v14
    v_add_f32 v73, v73, v15
    v_lshlrev_b32 v14, 16, v17
    v_and_b32 v15, 0xffff0000, v17
    v_add_f32 v74, v74, v14
    v_add_f32 v75, v75, v15
    v_lshlrev_b32 v14, 16, v18
    v_and_b32 v15, 0xffff0000, v18
    v_add_f32 v76, v76, v14
    v_add_f32 v77, v77, v15
    v_lshlrev_b32 v14, 16, v19
    v_and_b32 v15, 0xffff0000, v19
    v_add_f32 v78, v78, v14
    v_add_f32 v79, v79, v15
    v_lshlrev_b32 v14, 16, v28
    v_and_b32 v15, 0xffff0000, v28
    v_add_f32 v72, v72, v14
    v_add_f32 v73, v73, v15
    v_lshlrev_b32 v14, 16, v29
    v_and_b32 v15, 0xffff0000, v29
    v_add_f32 v74, v74, v14
    v_add_f32 v75, v75, v15
    v_lshlrev_b32 v14, 16, v30
    v_and_b32 v15, 0xffff0000, v30
    v_add_f32 v76, v76, v14
    v_add_f32 v77, v77, v15
    v_lshlrev_b32 v14, 16, v31
    v_and_b32 v15, 0xffff0000, v31
    v_add_f32 v78, v78, v14
    v_add_f32 v79, v79, v15
    v_lshlrev_b32 v14, 16, v20
    v_and_b32 v15, 0xffff0000, v20
    v_add_f32 v104, v104, v14
    v_add_f32 v105, v105, v15
    v_lshlrev_b32 v14, 16, v21
    v_and_b32 v15, 0xffff0000, v21
    v_add_f32 v106, v106, v14
    v_add_f32 v107, v107, v15
    v_lshlrev_b32 v14, 16, v22
    v_and_b32 v15, 0xffff0000, v22
    v_add_f32 v108, v108, v14
    v_add_f32 v109, v109, v15
    v_lshlrev_b32 v14, 16, v23
    v_and_b32 v15, 0xffff0000, v23
    v_add_f32 v110, v110, v14
    v_add_f32 v111, v111, v15
    v_lshlrev_b32 v14, 16, v32
    v_and_b32 v15, 0xffff0000, v32
    v_add_f32 v104, v104, v14
    v_add_f32 v105, v105, v15
    v_lshlrev_b32 v14, 16, v33
    v_and_b32 v15, 0xffff0000, v33
    v_add_f32 v106, v106, v14
    v_add_f32 v107, v107, v15
    v_lshlrev_b32 v14, 16, v34
    v_and_b32 v15, 0xffff0000, v34
    v_add_f32 v108, v108, v14
    v_add_f32 v109, v109, v15
    v_lshlrev_b32 v14, 16, v35
    v_and_b32 v15, 0xffff0000, v35
    v_add_f32 v110, v110, v14
    v_add_f32 v111, v111, v15
    v_lshlrev_b32 v14, 16, v24
    v_and_b32 v15, 0xffff0000, v24
    v_add_f32 v136, v136, v14
    v_add_f32 v137, v137, v15
    v_lshlrev_b32 v14, 16, v25
    v_and_b32 v15, 0xffff0000, v25
    v_add_f32 v138, v138, v14
    v_add_f32 v139, v139, v15
    v_lshlrev_b32 v14, 16, v26
    v_and_b32 v15, 0xffff0000, v26
    v_add_f32 v140, v140, v14
    v_add_f32 v141, v141, v15
    v_lshlrev_b32 v14, 16, v27
    v_and_b32 v15, 0xffff0000, v27
    v_add_f32 v142, v142, v14
    v_add_f32 v143, v143, v15
    v_lshlrev_b32 v14, 16, v36
    v_and_b32 v15, 0xffff0000, v36
    v_add_f32 v136, v136, v14
    v_add_f32 v137, v137, v15
    v_lshlrev_b32 v14, 16, v37
    v_and_b32 v15, 0xffff0000, v37
    v_add_f32 v138, v138, v14
    v_add_f32 v139, v139, v15
    v_lshlrev_b32 v14, 16, v38
    v_and_b32 v15, 0xffff0000, v38
    v_add_f32 v140, v140, v14
    v_add_f32 v141, v141, v15
    v_lshlrev_b32 v14, 16, v39
    v_and_b32 v15, 0xffff0000, v39
    v_add_f32 v142, v142, v14
    v_add_f32 v143, v143, v15
    s_setprio 3
    buffer_load_dwordx4 v[24:27], v4, s[16:19], s74 offen offset:0 sc1
    buffer_load_dwordx4 v[28:31], v4, s[16:19], s74 offen offset:1024 sc1
    buffer_load_dwordx4 v[32:35], v4, s[16:19], s74 offen offset:2048 sc1
    s_add_u32 s74, s74, 20480
    buffer_load_dwordx4 v[36:39], v4, s[16:19], s74 offen offset:0 sc1
    buffer_load_dwordx4 v[40:43], v4, s[16:19], s74 offen offset:1024 sc1
    buffer_load_dwordx4 v[44:47], v4, s[16:19], s74 offen offset:2048 sc1
    s_add_u32 s74, s74, 20480
    buffer_load_dwordx4 v[48:51], v4, s[16:19], s74 offen offset:0 sc1
    buffer_load_dwordx4 v[52:55], v4, s[16:19], s74 offen offset:1024 sc1
    buffer_load_dwordx4 v[56:59], v4, s[16:19], s74 offen offset:2048 sc1
    s_add_u32 s74, s74, 20480
    buffer_load_dwordx4 v[60:63], v4, s[16:19], s74 offen offset:0 sc1
    buffer_load_dwordx4 v[64:67], v4, s[16:19], s74 offen offset:1024 sc1
    buffer_load_dwordx4 v[68:71], v4, s[16:19], s74 offen offset:2048 sc1
    s_add_u32 s74, s74, 20480
    s_lshr_b32 s36, s50, 1
    s_lshl_b32 s37, s80, 1
    s_add_u32 s37, s37, s36
    s_mul_i32 s70, s37, 40960
    s_xor_b32 s37, s37, 1
    s_mul_i32 s71, s37, 40960
    s_mul_i32 s36, s50, 10240
    s_add_u32 s36, s36, 18239488
    s_add_u32 s70, s70, s36
    s_add_u32 s71, s71, s36
    s_mul_i32 s58, s50, 20480
    v_and_b32 v9, 31, v1
    v_lshlrev_b32 v2, 3, v9
    v_lshrrev_b32 v9, 5, v1
    v_lshl_add_u32 v2, v9, 8, v2
    v_add_u32 v2, s58, v2
    v_add_u32 v3, s57, v5
    v_mov_b32 v9, 159320
LW24:
    ds_read_b32 v10, v9
    s_waitcnt lgkmcnt(0)
    v_cmp_gt_u32 vcc, 8, v10
    s_nop 1
    s_cbranch_vccz LW24_OK
    s_add_u32 s101, s101, 1
    s_cmp_gt_u32 s101, 0x40000
    s_cbranch_scc1 K_END
    s_sleep 2
    s_branch LW24
LW24_OK:
    s_cmp_lg_u32 s3, 0
    s_cbranch_scc1 GATE25_W
    s_lshr_b32 s36, s80, 2
    s_lshl_b32 s36, s36, 8
    s_add_u32 s36, s36, 20905984
    v_mov_b32 v12, s36
    v_mov_b32 v13, 32
POLL26:
    buffer_load_dword v14, v12, s[16:19], 0 offen sc1
    s_waitcnt vmcnt(0)
    v_cmp_gt_u32 vcc, v13, v14
    s_nop 1
    s_cbranch_vccz POLL26_OK
    s_add_u32 s101, s101, 1
    s_cmp_gt_u32 s101, 0x40000
    s_cbranch_scc1 K_END
    s_sleep 2
    s_branch POLL26
POLL26_OK:
    v_mov_b32 v12, 159328
    v_mov_b32 v13, 1
    s_mov_b64 exec, 1
    ds_add_u32 v12, v13
    s_mov_b64 exec, -1
    s_branch GATE25_G
GATE25_W:
    v_mov_b32 v12, 159328
LW27:
    ds_read_b32 v13, v12
    s_waitcnt lgkmcnt(0)
    v_cmp_gt_u32 vcc, 2, v13
    s_nop 1
    s_cbranch_vccz LW27_OK
    s_add_u32 s101, s101, 1
    s_cmp_gt_u32 s101, 0x40000
    s_cbranch_scc1 K_END
    s_sleep 2
    s_branch LW27
LW27_OK:
GATE25_G:
    s_add_u32 m0, s58, 0
    s_nop 0
    buffer_load_dwordx4 v5, s[16:19], s70 offen offset:0 sc1 lds
    buffer_load_dwordx4 v5, s[16:19], s70 offen offset:1024 sc1 lds
    buffer_load_dwordx4 v5, s[16:19], s70 offen offset:2048 sc1 lds
    buffer_load_dwordx4 v5, s[16:19], s70 offen offset:3072 sc1 lds
    s_add_u32 s70, s70, 4096
    s_add_u32 m0, s58, 10240
    s_nop 0
    buffer_load_dwordx4 v5, s[16:19], s71 offen offset:0 sc1 lds
    buffer_load_dwordx4 v5, s[16:19], s71 offen offset:1024 sc1 lds
    buffer_load_dwordx4 v5, s[16:19], s71 offen offset:2048 sc1 lds
    buffer_load_dwordx4 v5, s[16:19], s71 offen offset:3072 sc1 lds
    s_add_u32 s71, s71, 4096
    s_add_u32 m0, s58, 4096
    s_nop 0
    buffer_load_dwordx4 v5, s[16:19], s70 offen offset:0 sc1 lds
    buffer_load_dwordx4 v5, s[16:19], s70 offen offset:1024 sc1 lds
    buffer_load_dwordx4 v5, s[16:19], s70 offen offset:2048 sc1 lds
    buffer_load_dwordx4 v5, s[16:19], s70 offen offset:3072 sc1 lds
    s_add_u32 s70, s70, 4096
    s_add_u32 m0, s58, 14336
    s_nop 0
    buffer_load_dwordx4 v5, s[16:19], s71 offen offset:0 sc1 lds
    buffer_load_dwordx4 v5, s[16:19], s71 offen offset:1024 sc1 lds
    buffer_load_dwordx4 v5, s[16:19], s71 offen offset:2048 sc1 lds
    buffer_load_dwordx4 v5, s[16:19], s71 offen offset:3072 sc1 lds
    s_add_u32 s71, s71, 4096
    s_add_u32 m0, s58, 8192
    s_nop 0
    buffer_load_dwordx4 v5, s[16:19], s70 offen offset:0 sc1 lds
    buffer_load_dwordx4 v5, s[16:19], s70 offen offset:1024 sc1 lds
    s_add_u32 s70, s70, 4096
    s_add_u32 m0, s58, 18432
    s_nop 0
    buffer_load_dwordx4 v5, s[16:19], s71 offen offset:0 sc1 lds
    buffer_load_dwordx4 v5, s[16:19], s71 offen offset:1024 sc1 lds
    s_add_u32 s71, s71, 4096
    s_waitcnt vmcnt(19)
    ds_read_b64 v[12:13], v2 offset:0
    ds_read_b64 v[14:15], v2 offset:512
    s_waitcnt vmcnt(15)
    ds_read_b64 v[16:17], v2 offset:10240
    ds_read_b64 v[18:19], v2 offset:10752
    s_waitcnt lgkmcnt(2)
    v_mfma_f32_32x32x16_bf16 v[72:87], v[24:27], v[12:15], v[72:87]
    s_waitcnt vmcnt(18)
    ds_read_b64 v[20:21], v2 offset:1024
    ds_read_b64 v[22:23], v2 offset:1536
    v_mfma_f32_32x32x16_bf16 v[104:119], v[28:31], v[12:15], v[104:119]
    v_mfma_f32_32x32x16_bf16 v[136:151], v[32:35], v[12:15], v[136:151]
    s_waitcnt lgkmcnt(2)
    v_mfma_f32_32x32x16_bf16 v[88:103], v[24:27], v[16:19], v[88:103]
    s_waitcnt vmcnt(14)
    ds_read_b64 v[12:13], v2 offset:11264
    ds_read_b64 v[14:15], v2 offset:11776
    v_mfma_f32_32x32x16_bf16 v[120:135], v[28:31], v[16:19], v[120:135]
    v_mfma_f32_32x32x16_bf16 v[152:167], v[32:35], v[16:19], v[152:167]
    s_waitcnt lgkmcnt(2)
    v_mfma_f32_32x32x16_bf16 v[72:87], v[36:39], v[20:23], v[72:87]
    s_waitcnt vmcnt(17)
    ds_read_b64 v[16:17], v2 offset:2048
    ds_read_b64 v[18:19], v2 offset:2560
    v_mfma_f32_32x32x16_bf16 v[104:119], v[40:43], v[20:23], v[104:119]
    v_mfma_f32_32x32x16_bf16 v[136:151], v[44:47], v[20:23], v[136:151]
    s_waitcnt lgkmcnt(2)
    v_mfma_f32_32x32x16_bf16 v[88:103], v[36:39], v[12:15], v[88:103]
    s_waitcnt vmcnt(13)
    ds_read_b64 v[20:21], v2 offset:12288
    ds_read_b64 v[22:23], v2 offset:12800
    v_mfma_f32_32x32x16_bf16 v[120:135], v[40:43], v[12:15], v[120:135]
    v_mfma_f32_32x32x16_bf16 v[152:167], v[44:47], v[12:15], v[152:167]
    s_waitcnt lgkmcnt(2)
    v_mfma_f32_32x32x16_bf16 v[72:87], v[48:51], v[16:19], v[72:87]
    s_waitcnt vmcnt(16)
    ds_read_b64 v[12:13], v2 offset:3072
    ds_read_b64 v[14:15], v2 offset:3584
    v_mfma_f32_32x32x16_bf16 v[104:119], v[52:55], v[16:19], v[104:119]
    v_mfma_f32_32x32x16_bf16 v[136:151], v[56:59], v[16:19], v[136:151]
    s_waitcnt lgkmcnt(2)
    v_mfma_f32_32x32x16_bf16 v[88:103], v[48:51], v[20:23], v[88:103]
    s_waitcnt vmcnt(12)
    ds_read_b64 v[16:17], v2 offset:13312
    ds_read_b64 v[18:19], v2 offset:13824
    v_mfma_f32_32x32x16_bf16 v[120:135], v[52:55], v[20:23], v[120:135]
    v_mfma_f32_32x32x16_bf16 v[152:167], v[56:59], v[20:23], v[152:167]
    s_waitcnt lgkmcnt(2)
    v_mfma_f32_32x32x16_bf16 v[72:87], v[60:63], v[12:15], v[72:87]
    ds_read_b128 v[24:27], v3 offset:0
    ds_read_b128 v[28:31], v3 offset:1024
    ds_read_b128 v[32:35], v3 offset:2048
    s_waitcnt vmcnt(11)
    ds_read_b64 v[20:21], v2 offset:4096
    ds_read_b64 v[22:23], v2 offset:4608
    v_mfma_f32_32x32x16_bf16 v[104:119], v[64:67], v[12:15], v[104:119]
    v_mfma_f32_32x32x16_bf16 v[136:151], v[68:71], v[12:15], v[136:151]
    s_waitcnt lgkmcnt(5)
    v_mfma_f32_32x32x16_bf16 v[88:103], v[60:63], v[16:19], v[88:103]
    s_waitcnt vmcnt(7)
    ds_read_b64 v[12:13], v2 offset:14336
    ds_read_b64 v[14:15], v2 offset:14848
    v_mfma_f32_32x32x16_bf16 v[120:135], v[64:67], v[16:19], v[120:135]
    v_mfma_f32_32x32x16_bf16 v[152:167], v[68:71], v[16:19], v[152:167]
    s_waitcnt lgkmcnt(2)
    v_mfma_f32_32x32x16_bf16 v[72:87], v[24:27], v[20:23], v[72:87]
    ds_read_b128 v[36:39], v3 offset:3072
    ds_read_b128 v[40:43], v3 offset:4096
    ds_read_b128 v[44:47], v3 offset:5120
    s_waitcnt vmcnt(10)
    ds_read_b64 v[16:17], v2 offset:5120
    ds_read_b64 v[18:19], v2 offset:5632
    v_mfma_f32_32x32x16_bf16 v[104:119], v[28:31], v[20:23], v[104:119]
    v_mfma_f32_32x32x16_bf16 v[136:151], v[32:35], v[20:23], v[136:151]
    s_waitcnt lgkmcnt(5)
    v_mfma_f32_32x32x16_bf16 v[88:103], v[24:27], v[12:15], v[88:103]
    s_waitcnt vmcnt(6)
    ds_read_b64 v[20:21], v2 offset:15360
    ds_read_b64 v[22:23], v2 offset:15872
    v_mfma_f32_32x32x16_bf16 v[120:135], v[28:31], v[12:15], v[120:135]
    v_mfma_f32_32x32x16_bf16 v[152:167], v[32:35], v[12:15], v[152:167]
    s_waitcnt lgkmcnt(2)
    v_mfma_f32_32x32x16_bf16 v[72:87], v[36:39], v[16:19], v[72:87]
    ds_read_b128 v[24:27], v3 offset:6144
    ds_read_b128 v[28:31], v3 offset:7168
    ds_read_b128 v[32:35], v3 offset:8192
    s_waitcnt vmcnt(9)
    ds_read_b64 v[12:13], v2 offset:6144
    ds_read_b64 v[14:15], v2 offset:6656
    v_mfma_f32_32x32x16_bf16 v[104:119], v[40:43], v[16:19], v[104:119]
    v_mfma_f32_32x32x16_bf16 v[136:151], v[44:47], v[16:19], v[136:151]
    s_waitcnt lgkmcnt(5)
    v_mfma_f32_32x32x16_bf16 v[88:103], v[36:39], v[20:23], v[88:103]
    s_waitcnt vmcnt(5)
    ds_read_b64 v[16:17], v2 offset:16384
    ds_read_b64 v[18:19], v2 offset:16896
    v_mfma_f32_32x32x16_bf16 v[120:135], v[40:43], v[20:23], v[120:135]
    v_mfma_f32_32x32x16_bf16 v[152:167], v[44:47], v[20:23], v[152:167]
    s_waitcnt lgkmcnt(2)
    v_mfma_f32_32x32x16_bf16 v[72:87], v[24:27], v[12:15], v[72:87]
    ds_read_b128 v[36:39], v3 offset:9216
    ds_read_b128 v[40:43], v3 offset:10240
    ds_read_b128 v[44:47], v3 offset:11264
    s_waitcnt vmcnt(8)
    ds_read_b64 v[20:21], v2 offset:7168
    ds_read_b64 v[22:23], v2 offset:7680
    v_mfma_f32_32x32x16_bf16 v[104:119], v[28:31], v[12:15], v[104:119]
    v_mfma_f32_32x32x16_bf16 v[136:151], v[32:35], v[12:15], v[136:151]
    s_waitcnt lgkmcnt(5)
    v_mfma_f32_32x32x16_bf16 v[88:103], v[24:27], v[16:19], v[88:103]
    s_waitcnt vmcnt(4)
    ds_read_b64 v[12:13], v2 offset:17408
    ds_read_b64 v[14:15], v2 offset:17920
    v_mfma_f32_32x32x16_bf16 v[120:135], v[28:31], v[16:19], v[120:135]
    v_mfma_f32_32x32x16_bf16 v[152:167], v[32:35], v[16:19], v[152:167]
    s_waitcnt lgkmcnt(2)
    v_mfma_f32_32x32x16_bf16 v[72:87], v[36:39], v[20:23], v[72:87]
    ds_read_b128 v[24:27], v3 offset:12288
    ds_read_b128 v[28:31], v3 offset:13312
    ds_read_b128 v[32:35], v3 offset:14336
    s_waitcnt vmcnt(3)
    ds_read_b64 v[16:17], v2 offset:8192
    ds_read_b64 v[18:19], v2 offset:8704
    v_mfma_f32_32x32x16_bf16 v[104:119], v[40:43], v[20:23], v[104:119]
    v_mfma_f32_32x32x16_bf16 v[136:151], v[44:47], v[20:23], v[136:151]
    s_waitcnt lgkmcnt(5)
    v_mfma_f32_32x32x16_bf16 v[88:103], v[36:39], v[12:15], v[88:103]
    s_waitcnt vmcnt(1)
    ds_read_b64 v[20:21], v2 offset:18432
    ds_read_b64 v[22:23], v2 offset:18944
    v_mfma_f32_32x32x16_bf16 v[120:135], v[40:43], v[12:15], v[120:135]
    v_mfma_f32_32x32x16_bf16 v[152:167], v[44:47], v[12:15], v[152:167]
    s_waitcnt lgkmcnt(2)
    v_mfma_f32_32x32x16_bf16 v[72:87], v[24:27], v[16:19], v[72:87]
    ds_read_b128 v[36:39], v3 offset:15360
    ds_read_b128 v[40:43], v3 offset:16384
    ds_read_b128 v[44:47], v3 offset:17408
    s_waitcnt vmcnt(2)
    ds_read_b64 v[12:13], v2 offset:9216
    ds_read_b64 v[14:15], v2 offset:9728
    v_mfma_f32_32x32x16_bf16 v[104:119], v[28:31], v[16:19], v[104:119]
    v_mfma_f32_32x32x16_bf16 v[136:151], v[32:35], v[16:19], v[136:151]
    s_waitcnt lgkmcnt(5)
    v_mfma_f32_32x32x16_bf16 v[88:103], v[24:27], v[20:23], v[88:103]
    s_waitcnt vmcnt(0)
    ds_read_b64 v[16:17], v2 offset:19456
    ds_read_b64 v[18:19], v2 offset:19968
    v_mfma_f32_32x32x16_bf16 v[120:135], v[28:31], v[20:23], v[120:135]
    v_mfma_f32_32x32x16_bf16 v[152:167], v[32:35], v[20:23], v[152:167]
    s_waitcnt lgkmcnt(2)
    v_mfma_f32_32x32x16_bf16 v[72:87], v[36:39], v[12:15], v[72:87]
    v_mfma_f32_32x32x16_bf16 v[104:119], v[40:43], v[12:15], v[104:119]
    v_mfma_f32_32x32x16_bf16 v[136:151], v[44:47], v[12:15], v[136:151]
    s_waitcnt lgkmcnt(0)
    v_mfma_f32_32x32x16_bf16 v[88:103], v[36:39], v[16:19], v[88:103]
    v_mfma_f32_32x32x16_bf16 v[120:135], v[40:43], v[16:19], v[120:135]
    v_mfma_f32_32x32x16_bf16 v[152:167], v[44:47], v[16:19], v[152:167]
    s_nop 7
    ds_write_b128 v11, v[80:83] offset:0
    ds_write_b128 v11, v[84:87] offset:1024
    ds_write_b128 v11, v[112:115] offset:2048
    ds_write_b128 v11, v[116:119] offset:3072
    ds_write_b128 v11, v[144:147] offset:4096
    ds_write_b128 v11, v[148:151] offset:5120
    ds_write_b128 v11, v[88:91] offset:6144
    ds_write_b128 v11, v[92:95] offset:7168
    ds_write_b128 v11, v[120:123] offset:8192
    ds_write_b128 v11, v[124:127] offset:9216
    ds_write_b128 v11, v[152:155] offset:10240
    ds_write_b128 v11, v[156:159] offset:11264
    ds_write_b128 v11, v[96:99] offset:12288
    ds_write_b128 v11, v[100:103] offset:13312
    ds_write_b128 v11, v[128:131] offset:14336
    ds_write_b128 v11, v[132:135] offset:15360
    ds_write_b128 v11, v[160:163] offset:16384
    ds_write_b128 v11, v[164:167] offset:17408
    s_xor_b32 s36, s50, 1
    s_mul_i32 s36, s36, 18432
    s_add_u32 s36, s36, 85504
    v_add_u32 v2, s36, v5
    s_xor_b32 s36, s50, 2
    s_mul_i32 s36, s36, 18432
    s_add_u32 s36, s36, 91648
    v_add_u32 v3, s36, v5
    s_xor_b32 s36, s50, 3
    s_mul_i32 s36, s36, 18432
    s_add_u32 s36, s36, 97792
    v_add_u32 v4, s36, v5
    v_mov_b32 v8, 1
    s_waitcnt lgkmcnt(0)
    ds_write_b32 v6, v8
FF_SP1:
    ds_read_b32 v9, v7
    s_waitcnt lgkmcnt(0)
    v_cmp_gt_u32 vcc, 1, v9
    s_nop 1
    s_cbranch_vccz FF_SP1_OK
    s_add_u32 s101, s101, 1
    s_cmp_gt_u32 s101, 0x40000
    s_cbranch_scc1 K_END
    s_sleep 0
    s_branch FF_SP1
FF_SP1_OK:
    ds_read_b128 v[80:83], v2 offset:0
    ds_read_b128 v[84:87], v2 offset:1024
    ds_read_b128 v[88:91], v3 offset:0
    ds_read_b128 v[92:95], v3 offset:1024
    ds_read_b128 v[96:99], v4 offset:0
    ds_read_b128 v[100:103], v4 offset:1024
    ds_read_b128 v[112:115], v2 offset:2048
    ds_read_b128 v[116:119], v2 offset:3072
    ds_read_b128 v[120:123], v3 offset:2048
    ds_read_b128 v[124:127], v3 offset:3072
    ds_read_b128 v[128:131], v4 offset:2048
    ds_read_b128 v[132:135], v4 offset:3072
    s_waitcnt lgkmcnt(6)
    v_add_f32 v80, v80, v88
    v_add_f32 v72, v72, v96
    v_add_f32 v81, v81, v89
    v_add_f32 v73, v73, v97
    v_add_f32 v82, v82, v90
    v_add_f32 v74, v74, v98
    v_add_f32 v83, v83, v91
    v_add_f32 v75, v75, v99
    v_add_f32 v84, v84, v92
    v_add_f32 v76, v76, v100
    v_add_f32 v85, v85, v93
    v_add_f32 v77, v77, v101
    v_add_f32 v86, v86, v94
    v_add_f32 v78, v78, v102
    v_add_f32 v87, v87, v95
    v_add_f32 v79, v79, v103
    v_add_f32 v72, v72, v80
    v_add_f32 v73, v73, v81
    v_add_f32 v74, v74, v82
    v_add_f32 v75, v75, v83
    v_add_f32 v76, v76, v84
    v_add_f32 v77, v77, v85
    v_add_f32 v78, v78, v86
    v_add_f32 v79, v79, v87
    ds_read_b128 v[144:147], v2 offset:4096
    ds_read_b128 v[148:151], v2 offset:5120
    ds_read_b128 v[152:155], v3 offset:4096
    ds_read_b128 v[156:159], v3 offset:5120
    ds_read_b128 v[160:163], v4 offset:4096
    ds_read_b128 v[164:167], v4 offset:5120
    s_waitcnt lgkmcnt(6)
    v_add_f32 v112, v112, v120
    v_add_f32 v104, v104, v128
    v_add_f32 v113, v113, v121
    v_add_f32 v105, v105, v129
    v_add_f32 v114, v114, v122
    v_add_f32 v106, v106, v130
    v_add_f32 v115, v115, v123
    v_add_f32 v107, v107, v131
    v_add_f32 v116, v116, v124
    v_add_f32 v108, v108, v132
    v_add_f32 v117, v117, v125
    v_add_f32 v109, v109, v133
    v_add_f32 v118, v118, v126
    v_add_f32 v110, v110, v134
    v_add_f32 v119, v119, v127
    v_add_f32 v111, v111, v135
    v_add_f32 v104, v104, v112
    v_add_f32 v105, v105, v113
    v_add_f32 v106, v106, v114
    v_add_f32 v107, v107, v115
    v_add_f32 v108, v108, v116
    v_add_f32 v109, v109, v117
    v_add_f32 v110, v110, v118
    v_add_f32 v111, v111, v119
    s_waitcnt lgkmcnt(0)
    v_add_f32 v144, v144, v152
    v_add_f32 v136, v136, v160
    v_add_f32 v145, v145, v153
    v_add_f32 v137, v137, v161
    v_add_f32 v146, v146, v154
    v_add_f32 v138, v138, v162
    v_add_f32 v147, v147, v155
    v_add_f32 v139, v139, v163
    v_add_f32 v148, v148, v156
    v_add_f32 v140, v140, v164
    v_add_f32 v149, v149, v157
    v_add_f32 v141, v141, v165
    v_add_f32 v150, v150, v158
    v_add_f32 v142, v142, v166
    v_add_f32 v151, v151, v159
    v_add_f32 v143, v143, v167
    v_add_f32 v136, v136, v144
    v_add_f32 v137, v137, v145
    v_add_f32 v138, v138, v146
    v_add_f32 v139, v139, v147
    v_add_f32 v140, v140, v148
    v_add_f32 v141, v141, v149
    v_add_f32 v142, v142, v150
    v_add_f32 v143, v143, v151
    v_cvt_pk_bf16_f32 v88, v72, v73
    v_cvt_pk_bf16_f32 v89, v74, v75
    v_cvt_pk_bf16_f32 v90, v76, v77
    v_cvt_pk_bf16_f32 v91, v78, v79
    s_nop 1
    v_permlane32_swap_b32 v88, v90
    v_permlane32_swap_b32 v89, v91
    buffer_store_dwordx4 v[88:91], v0, s[64:67], s56 offen offset:0 nt
    v_cvt_pk_bf16_f32 v120, v104, v105
    v_cvt_pk_bf16_f32 v121, v106, v107
    v_cvt_pk_bf16_f32 v122, v108, v109
    v_cvt_pk_bf16_f32 v123, v110, v111
    s_nop 1
    v_permlane32_swap_b32 v120, v122
    v_permlane32_swap_b32 v121, v123
    buffer_store_dwordx4 v[120:123], v0, s[64:67], s56 offen offset:64 nt
    v_cvt_pk_bf16_f32 v152, v136, v137
    v_cvt_pk_bf16_f32 v153, v138, v139
    v_cvt_pk_bf16_f32 v154, v140, v141
    v_cvt_pk_bf16_f32 v155, v142, v143
    s_nop 1
    v_permlane32_swap_b32 v152, v154
    v_permlane32_swap_b32 v153, v155
    buffer_store_dwordx4 v[152:155], v0, s[64:67], s56 offen offset:128 nt
    s_endpgm
FF2_NB2:
    s_mul_i32 s74, s50, 200
    s_add_u32 s74, s74, s54
    s_lshl_b32 s74, s74, 10
    s_add_u32 s74, s74, 10076160
    s_add_u32 s75, s74, 20480
    s_mul_i32 s57, s50, 18432
    s_add_u32 s57, s57, 85504
    s_add_u32 m0, s57, 0
    s_nop 0
    buffer_load_dwordx4 v4, s[16:19], s75 offen offset:0 sc1 lds
    buffer_load_dwordx4 v4, s[16:19], s75 offen offset:1024 sc1 lds
    s_add_u32 s75, s75, 20480
    s_add_u32 m0, s57, 2048
    s_nop 0
    buffer_load_dwordx4 v4, s[16:19], s75 offen offset:0 sc1 lds
    buffer_load_dwordx4 v4, s[16:19], s75 offen offset:1024 sc1 lds
    s_add_u32 s75, s75, 20480
    s_add_u32 m0, s57, 4096
    s_nop 0
    buffer_load_dwordx4 v4, s[16:19], s75 offen offset:0 sc1 lds
    buffer_load_dwordx4 v4, s[16:19], s75 offen offset:1024 sc1 lds
    s_add_u32 s75, s75, 20480
    s_add_u32 m0, s57, 6144
    s_nop 0
    buffer_load_dwordx4 v4, s[16:19], s75 offen offset:0 sc1 lds
    buffer_load_dwordx4 v4, s[16:19], s75 offen offset:1024 sc1 lds
    s_add_u32 s75, s75, 20480
    s_add_u32 m0, s57, 8192
    s_nop 0
    buffer_load_dwordx4 v4, s[16:19], s75 offen offset:0 sc1 lds
    buffer_load_dwordx4 v4, s[16:19], s75 offen offset:1024 sc1 lds
    s_add_u32 s75, s75, 20480
    s_add_u32 m0, s57, 10240
    s_nop 0
    buffer_load_dwordx4 v4, s[16:19], s75 offen offset:0 sc1 lds
    buffer_load_dwordx4 v4, s[16:19], s75 offen offset:1024 sc1 lds
    s_add_u32 s75, s75, 20480
    s_add_u32 m0, s57, 12288
    s_nop 0
    buffer_load_dwordx4 v4, s[16:19], s75 offen offset:0 sc1 lds
    buffer_load_dwordx4 v4, s[16:19], s75 offen offset:1024 sc1 lds
    s_add_u32 s75, s75, 20480
    s_add_u32 m0, s57, 14336
    s_nop 0
    buffer_load_dwordx4 v4, s[16:19], s75 offen offset:0 sc1 lds
    buffer_load_dwordx4 v4, s[16:19], s75 offen offset:1024 sc1 lds
    s_add_u32 s75, s75, 20480
    s_add_u32 m0, s57, 16384
    s_nop 0
    buffer_load_dwordx4 v4, s[16:19], s75 offen offset:0 sc1 lds
    buffer_load_dwordx4 v4, s[16:19], s75 offen offset:1024 sc1 lds
    s_add_u32 s75, s75, 20480
    buffer_load_dwordx4 v[12:15], v2, s[16:19], s70 offen sc1
    buffer_load_dwordx4 v[20:23], v4, s[16:19], s71 offen offset:0 sc1
    buffer_load_dwordx4 v[24:27], v4, s[16:19], s71 offen offset:1024 sc1
    buffer_load_dwordx4 v[16:19], v3, s[16:19], s70 offen sc1
    s_add_u32 s70, s70, 65536
    s_add_u32 s71, s71, 20480
    buffer_load_dwordx4 v[28:31], v2, s[16:19], s70 offen sc1
    buffer_load_dwordx4 v[36:39], v4, s[16:19], s71 offen offset:0 sc1
    buffer_load_dwordx4 v[40:43], v4, s[16:19], s71 offen offset:1024 sc1
    buffer_load_dwordx4 v[32:35], v3, s[16:19], s70 offen sc1
    s_add_u32 s70, s70, 65536
    s_add_u32 s71, s71, 20480
    buffer_load_dwordx4 v[44:47], v2, s[16:19], s70 offen sc1
    buffer_load_dwordx4 v[52:55], v4, s[16:19], s71 offen offset:0 sc1
    buffer_load_dwordx4 v[56:59], v4, s[16:19], s71 offen offset:1024 sc1
    buffer_load_dwordx4 v[48:51], v3, s[16:19], s70 offen sc1
    s_add_u32 s70, s70, 65536
    s_add_u32 s71, s71, 20480
    buffer_load_dwordx4 v[60:63], v2, s[16:19], s70 offen sc1
    buffer_load_dwordx4 v[68:71], v4, s[16:19], s71 offen offset:0 sc1
    buffer_load_dwordx4 v[72:75], v4, s[16:19], s71 offen offset:1024 sc1
    buffer_load_dwordx4 v[64:67], v3, s[16:19], s70 offen sc1
    s_add_u32 s70, s70, 65536
    s_add_u32 s71, s71, 20480
    s_waitcnt vmcnt(13)
    v_mfma_f32_32x32x16_bf16 v[104:119], v[20:23], v[12:15], 0
    buffer_load_dwordx4 v[76:79], v2, s[16:19], s70 offen sc1
    buffer_load_dwordx4 v[84:87], v4, s[16:19], s71 offen offset:0 sc1
    buffer_load_dwordx4 v[88:91], v4, s[16:19], s71 offen offset:1024 sc1
    buffer_load_dwordx4 v[80:83], v3, s[16:19], s70 offen sc1
    s_add_u32 s70, s70, 65536
    s_add_u32 s71, s71, 20480
    v_mfma_f32_32x32x16_bf16 v[136:151], v[24:27], v[12:15], 0
    s_waitcnt vmcnt(16)
    v_mfma_f32_32x32x16_bf16 v[120:135], v[20:23], v[16:19], 0
    v_mfma_f32_32x32x16_bf16 v[152:167], v[24:27], v[16:19], 0
    s_waitcnt vmcnt(13)
    v_mfma_f32_32x32x16_bf16 v[104:119], v[36:39], v[28:31], v[104:119]
    buffer_load_dwordx4 v[12:15], v2, s[16:19], s70 offen sc1
    buffer_load_dwordx4 v[20:23], v4, s[16:19], s71 offen offset:0 sc1
    buffer_load_dwordx4 v[24:27], v4, s[16:19], s71 offen offset:1024 sc1
    buffer_load_dwordx4 v[16:19], v3, s[16:19], s70 offen sc1
    s_add_u32 s70, s70, 65536
    s_add_u32 s71, s71, 20480
    v_mfma_f32_32x32x16_bf16 v[136:151], v[40:43], v[28:31], v[136:151]
    s_waitcnt vmcnt(16)
    v_mfma_f32_32x32x16_bf16 v[120:135], v[36:39], v[32:35], v[120:135]
    v_mfma_f32_32x32x16_bf16 v[152:167], v[40:43], v[32:35], v[152:167]
    s_waitcnt vmcnt(13)
    v_mfma_f32_32x32x16_bf16 v[104:119], v[52:55], v[44:47], v[104:119]
    buffer_load_dwordx4 v[28:31], v2, s[16:19], s70 offen sc1
    buffer_load_dwordx4 v[36:39], v4, s[16:19], s71 offen offset:0 sc1
    buffer_load_dwordx4 v[40:43], v4, s[16:19], s71 offen offset:1024 sc1
    buffer_load_dwordx4 v[32:35], v3, s[16:19], s70 offen sc1
    s_add_u32 s70, s70, 65536
    s_add_u32 s71, s71, 20480
    v_mfma_f32_32x32x16_bf16 v[136:151], v[56:59], v[44:47], v[136:151]
    s_waitcnt vmcnt(16)
    v_mfma_f32_32x32x16_bf16 v[120:135], v[52:55], v[48:51], v[120:135]
    v_mfma_f32_32x32x16_bf16 v[152:167], v[56:59], v[48:51], v[152:167]
    s_waitcnt vmcnt(13)
    v_mfma_f32_32x32x16_bf16 v[104:119], v[68:71], v[60:63], v[104:119]
    buffer_load_dwordx4 v[44:47], v2, s[16:19], s70 offen sc1
    buffer_load_dwordx4 v[52:55], v4, s[16:19], s71 offen offset:0 sc1
    buffer_load_dwordx4 v[56:59], v4, s[16:19], s71 offen offset:1024 sc1
    buffer_load_dwordx4 v[48:51], v3, s[16:19], s70 offen sc1
    s_add_u32 s70, s70, 65536
    s_add_u32 s71, s71, 20480
    v_mfma_f32_32x32x16_bf16 v[136:151], v[72:75], v[60:63], v[136:151]
    s_waitcnt vmcnt(16)
    v_mfma_f32_32x32x16_bf16 v[120:135], v[68:71], v[64:67], v[120:135]
    v_mfma_f32_32x32x16_bf16 v[152:167], v[72:75], v[64:67], v[152:167]
    s_waitcnt vmcnt(13)
    v_mfma_f32_32x32x16_bf16 v[104:119], v[84:87], v[76:79], v[104:119]
    buffer_load_dwordx4 v[60:63], v2, s[16:19], s70 offen sc1
    buffer_load_dwordx4 v[68:71], v4, s[16:19], s71 offen offset:0 sc1
    buffer_load_dwordx4 v[72:75], v4, s[16:19], s71 offen offset:1024 sc1
    buffer_load_dwordx4 v[64:67], v3, s[16:19], s70 offen sc1
    s_add_u32 s70, s70, 65536
    s_add_u32 s71, s71, 20480
    v_mfma_f32_32x32x16_bf16 v[136:151], v[88:91], v[76:79], v[136:151]
    s_waitcnt vmcnt(16)
    v_mfma_f32_32x32x16_bf16 v[120:135], v[84:87], v[80:83], v[120:135]
    v_mfma_f32_32x32x16_bf16 v[152:167], v[88:91], v[80:83], v[152:167]
    s_waitcnt vmcnt(13)
    v_mfma_f32_32x32x16_bf16 v[104:119], v[20:23], v[12:15], v[104:119]
    buffer_load_dwordx4 v[76:79], v2, s[16:19], s70 offen sc1
    buffer_load_dwordx4 v[84:87], v4, s[16:19], s71 offen offset:0 sc1
    buffer_load_dwordx4 v[88:91], v4, s[16:19], s71 offen offset:1024 sc1
    buffer_load_dwordx4 v[80:83], v3, s[16:19], s70 offen sc1
    s_add_u32 s70, s70, 65536
    s_add_u32 s71, s71, 20480
    v_mfma_f32_32x32x16_bf16 v[136:151], v[24:27], v[12:15], v[136:151]
    s_waitcnt vmcnt(16)
    v_mfma_f32_32x32x16_bf16 v[120:135], v[20:23], v[16:19], v[120:135]
    v_mfma_f32_32x32x16_bf16 v[152:167], v[24:27], v[16:19], v[152:167]
    s_waitcnt vmcnt(13)
    v_mfma_f32_32x32x16_bf16 v[104:119], v[36:39], v[28:31], v[104:119]
    buffer_load_dwordx4 v[12:15], v2, s[16:19], s70 offen sc1
    buffer_load_dwordx4 v[20:23], v4, s[16:19], s71 offen offset:0 sc1
    buffer_load_dwordx4 v[24:27], v4, s[16:19], s71 offen offset:1024 sc1
    buffer_load_dwordx4 v[16:19], v3, s[16:19], s70 offen sc1
    s_add_u32 s70, s70, 65536
    s_add_u32 s71, s71, 20480
    v_mfma_f32_32x32x16_bf16 v[136:151], v[40:43], v[28:31], v[136:151]
    s_waitcnt vmcnt(16)
    v_mfma_f32_32x32x16_bf16 v[120:135], v[36:39], v[32:35], v[120:135]
    v_mfma_f32_32x32x16_bf16 v[152:167], v[40:43], v[32:35], v[152:167]
    s_waitcnt vmcnt(13)
    v_mfma_f32_32x32x16_bf16 v[104:119], v[52:55], v[44:47], v[104:119]
    buffer_load_dwordx4 v[28:31], v2, s[16:19], s70 offen sc1
    buffer_load_dwordx4 v[36:39], v4, s[16:19], s71 offen offset:0 sc1
    buffer_load_dwordx4 v[40:43], v4, s[16:19], s71 offen offset:1024 sc1
    buffer_load_dwordx4 v[32:35], v3, s[16:19], s70 offen sc1
    s_add_u32 s70, s70, 65536
    s_add_u32 s71, s71, 20480
    v_mfma_f32_32x32x16_bf16 v[136:151], v[56:59], v[44:47], v[136:151]
    s_waitcnt vmcnt(16)
    v_mfma_f32_32x32x16_bf16 v[120:135], v[52:55], v[48:51], v[120:135]
    v_mfma_f32_32x32x16_bf16 v[152:167], v[56:59], v[48:51], v[152:167]
    s_waitcnt vmcnt(13)
    v_mfma_f32_32x32x16_bf16 v[104:119], v[68:71], v[60:63], v[104:119]
    buffer_load_dwordx4 v[44:47], v2, s[16:19], s70 offen sc1
    buffer_load_dwordx4 v[52:55], v4, s[16:19], s71 offen offset:0 sc1
    buffer_load_dwordx4 v[56:59], v4, s[16:19], s71 offen offset:1024 sc1
    buffer_load_dwordx4 v[48:51], v3, s[16:19], s70 offen sc1
    s_add_u32 s70, s70, 65536
    s_add_u32 s71, s71, 20480
    v_mfma_f32_32x32x16_bf16 v[136:151], v[72:75], v[60:63], v[136:151]
    s_waitcnt vmcnt(16)
    v_mfma_f32_32x32x16_bf16 v[120:135], v[68:71], v[64:67], v[120:135]
    v_mfma_f32_32x32x16_bf16 v[152:167], v[72:75], v[64:67], v[152:167]
    s_waitcnt vmcnt(13)
    v_mfma_f32_32x32x16_bf16 v[104:119], v[84:87], v[76:79], v[104:119]
    buffer_load_dwordx4 v[60:63], v2, s[16:19], s70 offen sc1
    buffer_load_dwordx4 v[68:71], v4, s[16:19], s71 offen offset:0 sc1
    buffer_load_dwordx4 v[72:75], v4, s[16:19], s71 offen offset:1024 sc1
    buffer_load_dwordx4 v[64:67], v3, s[16:19], s70 offen sc1
    s_add_u32 s70, s70, 65536
    s_add_u32 s71, s71, 20480
    v_mfma_f32_32x32x16_bf16 v[136:151], v[88:91], v[76:79], v[136:151]
    s_waitcnt vmcnt(16)
    v_mfma_f32_32x32x16_bf16 v[120:135], v[84:87], v[80:83], v[120:135]
    v_mfma_f32_32x32x16_bf16 v[152:167], v[88:91], v[80:83], v[152:167]
    s_waitcnt vmcnt(13)
    v_mfma_f32_32x32x16_bf16 v[104:119], v[20:23], v[12:15], v[104:119]
    buffer_load_dwordx4 v[76:79], v2, s[16:19], s70 offen sc1
    buffer_load_dwordx4 v[84:87], v4, s[16:19], s71 offen offset:0 sc1
    buffer_load_dwordx4 v[88:91], v4, s[16:19], s71 offen offset:1024 sc1
    buffer_load_dwordx4 v[80:83], v3, s[16:19], s70 offen sc1
    s_add_u32 s70, s70, 65536
    s_add_u32 s71, s71, 20480
    v_mfma_f32_32x32x16_bf16 v[136:151], v[24:27], v[12:15], v[136:151]
    s_waitcnt vmcnt(16)
    v_mfma_f32_32x32x16_bf16 v[120:135], v[20:23], v[16:19], v[120:135]
    v_mfma_f32_32x32x16_bf16 v[152:167], v[24:27], v[16:19], v[152:167]
    s_waitcnt vmcnt(13)
    v_mfma_f32_32x32x16_bf16 v[104:119], v[36:39], v[28:31], v[104:119]
    buffer_load_dwordx4 v[12:15], v2, s[16:19], s70 offen sc1
    buffer_load_dwordx4 v[20:23], v4, s[16:19], s71 offen offset:0 sc1
    buffer_load_dwordx4 v[24:27], v4, s[16:19], s71 offen offset:1024 sc1
    buffer_load_dwordx4 v[16:19], v3, s[16:19], s70 offen sc1
    s_add_u32 s70, s70, 65536
    s_add_u32 s71, s71, 20480
    v_mfma_f32_32x32x16_bf16 v[136:151], v[40:43], v[28:31], v[136:151]
    s_waitcnt vmcnt(16)
    v_mfma_f32_32x32x16_bf16 v[120:135], v[36:39], v[32:35], v[120:135]
    v_mfma_f32_32x32x16_bf16 v[152:167], v[40:43], v[32:35], v[152:167]
    s_waitcnt vmcnt(13)
    v_mfma_f32_32x32x16_bf16 v[104:119], v[52:55], v[44:47], v[104:119]
    buffer_load_dwordx4 v[28:31], v2, s[16:19], s70 offen sc1
    buffer_load_dwordx4 v[36:39], v4, s[16:19], s71 offen offset:0 sc1
    buffer_load_dwordx4 v[40:43], v4, s[16:19], s71 offen offset:1024 sc1
    buffer_load_dwordx4 v[32:35], v3, s[16:19], s70 offen sc1
    s_add_u32 s70, s70, 65536
    s_add_u32 s71, s71, 20480
    v_mfma_f32_32x32x16_bf16 v[136:151], v[56:59], v[44:47], v[136:151]
    s_waitcnt vmcnt(16)
    v_mfma_f32_32x32x16_bf16 v[120:135], v[52:55], v[48:51], v[120:135]
    v_mfma_f32_32x32x16_bf16 v[152:167], v[56:59], v[48:51], v[152:167]
    s_waitcnt vmcnt(13)
    v_mfma_f32_32x32x16_bf16 v[104:119], v[68:71], v[60:63], v[104:119]
    buffer_load_dwordx4 v[44:47], v2, s[16:19], s70 offen sc1
    buffer_load_dwordx4 v[52:55], v4, s[16:19], s71 offen offset:0 sc1
    buffer_load_dwordx4 v[56:59], v4, s[16:19], s71 offen offset:1024 sc1
    buffer_load_dwordx4 v[48:51], v3, s[16:19], s70 offen sc1
    s_add_u32 s70, s70, 65536
    s_add_u32 s71, s71, 20480
    v_mfma_f32_32x32x16_bf16 v[136:151], v[72:75], v[60:63], v[136:151]
    s_waitcnt vmcnt(16)
    v_mfma_f32_32x32x16_bf16 v[120:135], v[68:71], v[64:67], v[120:135]
    v_mfma_f32_32x32x16_bf16 v[152:167], v[72:75], v[64:67], v[152:167]
    s_waitcnt vmcnt(13)
    v_mfma_f32_32x32x16_bf16 v[104:119], v[84:87], v[76:79], v[104:119]
    buffer_load_dwordx4 v[60:63], v2, s[16:19], s70 offen sc1
    buffer_load_dwordx4 v[68:71], v4, s[16:19], s71 offen offset:0 sc1
    buffer_load_dwordx4 v[72:75], v4, s[16:19], s71 offen offset:1024 sc1
    buffer_load_dwordx4 v[64:67], v3, s[16:19], s70 offen sc1
    s_add_u32 s70, s70, 65536
    s_add_u32 s71, s71, 20480
    v_mfma_f32_32x32x16_bf16 v[136:151], v[88:91], v[76:79], v[136:151]
    s_waitcnt vmcnt(16)
    v_mfma_f32_32x32x16_bf16 v[120:135], v[84:87], v[80:83], v[120:135]
    v_mfma_f32_32x32x16_bf16 v[152:167], v[88:91], v[80:83], v[152:167]
    s_waitcnt vmcnt(13)
    v_mfma_f32_32x32x16_bf16 v[104:119], v[20:23], v[12:15], v[104:119]
    buffer_load_dwordx4 v[76:79], v2, s[16:19], s70 offen sc1
    buffer_load_dwordx4 v[84:87], v4, s[16:19], s71 offen offset:0 sc1
    buffer_load_dwordx4 v[88:91], v4, s[16:19], s71 offen offset:1024 sc1
    buffer_load_dwordx4 v[80:83], v3, s[16:19], s70 offen sc1
    s_add_u32 s70, s70, 65536
    s_add_u32 s71, s71, 20480
    v_mfma_f32_32x32x16_bf16 v[136:151], v[24:27], v[12:15], v[136:151]
    s_waitcnt vmcnt(16)
    v_mfma_f32_32x32x16_bf16 v[120:135], v[20:23], v[16:19], v[120:135]
    v_mfma_f32_32x32x16_bf16 v[152:167], v[24:27], v[16:19], v[152:167]
    s_waitcnt vmcnt(13)
    v_mfma_f32_32x32x16_bf16 v[104:119], v[36:39], v[28:31], v[104:119]
    buffer_load_dwordx4 v[12:15], v2, s[16:19], s70 offen sc1
    buffer_load_dwordx4 v[20:23], v4, s[16:19], s71 offen offset:0 sc1
    buffer_load_dwordx4 v[24:27], v4, s[16:19], s71 offen offset:1024 sc1
    buffer_load_dwordx4 v[16:19], v3, s[16:19], s70 offen sc1
    s_add_u32 s70, s70, 65536
    s_add_u32 s71, s71, 20480
    v_mfma_f32_32x32x16_bf16 v[136:151], v[40:43], v[28:31], v[136:151]
    s_waitcnt vmcnt(16)
    v_mfma_f32_32x32x16_bf16 v[120:135], v[36:39], v[32:35], v[120:135]
    v_mfma_f32_32x32x16_bf16 v[152:167], v[40:43], v[32:35], v[152:167]
    s_waitcnt vmcnt(13)
    v_mfma_f32_32x32x16_bf16 v[104:119], v[52:55], v[44:47], v[104:119]
    buffer_load_dwordx4 v[28:31], v2, s[16:19], s70 offen sc1
    buffer_load_dwordx4 v[36:39], v4, s[16:19], s71 offen offset:0 sc1
    buffer_load_dwordx4 v[40:43], v4, s[16:19], s71 offen offset:1024 sc1
    buffer_load_dwordx4 v[32:35], v3, s[16:19], s70 offen sc1
    s_add_u32 s70, s70, 65536
    s_add_u32 s71, s71, 20480
    v_mfma_f32_32x32x16_bf16 v[136:151], v[56:59], v[44:47], v[136:151]
    s_waitcnt vmcnt(16)
    v_mfma_f32_32x32x16_bf16 v[120:135], v[52:55], v[48:51], v[120:135]
    v_mfma_f32_32x32x16_bf16 v[152:167], v[56:59], v[48:51], v[152:167]
    s_waitcnt vmcnt(13)
    v_mfma_f32_32x32x16_bf16 v[104:119], v[68:71], v[60:63], v[104:119]
    buffer_load_dwordx4 v[44:47], v2, s[16:19], s70 offen sc1
    buffer_load_dwordx4 v[52:55], v4, s[16:19], s71 offen offset:0 sc1
    buffer_load_dwordx4 v[56:59], v4, s[16:19], s71 offen offset:1024 sc1
    buffer_load_dwordx4 v[48:51], v3, s[16:19], s70 offen sc1
    s_add_u32 s70, s70, 65536
    s_add_u32 s71, s71, 20480
    v_mfma_f32_32x32x16_bf16 v[136:151], v[72:75], v[60:63], v[136:151]
    s_waitcnt vmcnt(16)
    v_mfma_f32_32x32x16_bf16 v[120:135], v[68:71], v[64:67], v[120:135]
    v_mfma_f32_32x32x16_bf16 v[152:167], v[72:75], v[64:67], v[152:167]
    s_waitcnt vmcnt(13)
    v_mfma_f32_32x32x16_bf16 v[104:119], v[84:87], v[76:79], v[104:119]
    buffer_load_dwordx4 v[60:63], v2, s[16:19], s70 offen sc1
    buffer_load_dwordx4 v[68:71], v4, s[16:19], s71 offen offset:0 sc1
    buffer_load_dwordx4 v[72:75], v4, s[16:19], s71 offen offset:1024 sc1
    buffer_load_dwordx4 v[64:67], v3, s[16:19], s70 offen sc1
    s_add_u32 s70, s70, 65536
    s_add_u32 s71, s71, 20480
    v_mfma_f32_32x32x16_bf16 v[136:151], v[88:91], v[76:79], v[136:151]
    s_waitcnt vmcnt(16)
    v_mfma_f32_32x32x16_bf16 v[120:135], v[84:87], v[80:83], v[120:135]
    v_mfma_f32_32x32x16_bf16 v[152:167], v[88:91], v[80:83], v[152:167]
    s_waitcnt vmcnt(13)
    v_mfma_f32_32x32x16_bf16 v[104:119], v[20:23], v[12:15], v[104:119]
    buffer_load_dwordx4 v[76:79], v2, s[16:19], s70 offen sc1
    buffer_load_dwordx4 v[84:87], v4, s[16:19], s71 offen offset:0 sc1
    buffer_load_dwordx4 v[88:91], v4, s[16:19], s71 offen offset:1024 sc1
    buffer_load_dwordx4 v[80:83], v3, s[16:19], s70 offen sc1
    s_add_u32 s70, s70, 65536
    s_add_u32 s71, s71, 20480
    v_mfma_f32_32x32x16_bf16 v[136:151], v[24:27], v[12:15], v[136:151]
    s_waitcnt vmcnt(16)
    v_mfma_f32_32x32x16_bf16 v[120:135], v[20:23], v[16:19], v[120:135]
    v_mfma_f32_32x32x16_bf16 v[152:167], v[24:27], v[16:19], v[152:167]
    s_waitcnt vmcnt(13)
    v_mfma_f32_32x32x16_bf16 v[104:119], v[36:39], v[28:31], v[104:119]
    buffer_load_dwordx4 v[12:15], v2, s[16:19], s70 offen sc1
    buffer_load_dwordx4 v[20:23], v4, s[16:19], s71 offen offset:0 sc1
    buffer_load_dwordx4 v[24:27], v4, s[16:19], s71 offen offset:1024 sc1
    buffer_load_dwordx4 v[16:19], v3, s[16:19], s70 offen sc1
    s_add_u32 s70, s70, 65536
    s_add_u32 s71, s71, 20480
    v_mfma_f32_32x32x16_bf16 v[136:151], v[40:43], v[28:31], v[136:151]
    s_waitcnt vmcnt(16)
    v_mfma_f32_32x32x16_bf16 v[120:135], v[36:39], v[32:35], v[120:135]
    v_mfma_f32_32x32x16_bf16 v[152:167], v[40:43], v[32:35], v[152:167]
    s_waitcnt vmcnt(13)
    v_mfma_f32_32x32x16_bf16 v[104:119], v[52:55], v[44:47], v[104:119]
    buffer_load_dwordx4 v[28:31], v2, s[16:19], s70 offen sc1
    buffer_load_dwordx4 v[36:39], v4, s[16:19], s71 offen offset:0 sc1
    buffer_load_dwordx4 v[40:43], v4, s[16:19], s71 offen offset:1024 sc1
    buffer_load_dwordx4 v[32:35], v3, s[16:19], s70 offen sc1
    v_mfma_f32_32x32x16_bf16 v[136:151], v[56:59], v[44:47], v[136:151]
    s_waitcnt vmcnt(16)
    v_mfma_f32_32x32x16_bf16 v[120:135], v[52:55], v[48:51], v[120:135]
    v_mfma_f32_32x32x16_bf16 v[152:167], v[56:59], v[48:51], v[152:167]
    s_waitcnt vmcnt(13)
    v_mfma_f32_32x32x16_bf16 v[104:119], v[68:71], v[60:63], v[104:119]
    v_mfma_f32_32x32x16_bf16 v[136:151], v[72:75], v[60:63], v[136:151]
    s_waitcnt vmcnt(12)
    v_mfma_f32_32x32x16_bf16 v[120:135], v[68:71], v[64:67], v[120:135]
    v_mfma_f32_32x32x16_bf16 v[152:167], v[72:75], v[64:67], v[152:167]
    s_waitcnt vmcnt(9)
    v_mfma_f32_32x32x16_bf16 v[104:119], v[84:87], v[76:79], v[104:119]
    v_mfma_f32_32x32x16_bf16 v[136:151], v[88:91], v[76:79], v[136:151]
    s_waitcnt vmcnt(8)
    v_mfma_f32_32x32x16_bf16 v[120:135], v[84:87], v[80:83], v[120:135]
    v_mfma_f32_32x32x16_bf16 v[152:167], v[88:91], v[80:83], v[152:167]
    s_waitcnt vmcnt(5)
    v_mfma_f32_32x32x16_bf16 v[104:119], v[20:23], v[12:15], v[104:119]
    v_mfma_f32_32x32x16_bf16 v[136:151], v[24:27], v[12:15], v[136:151]
    s_waitcnt vmcnt(4)
    v_mfma_f32_32x32x16_bf16 v[120:135], v[20:23], v[16:19], v[120:135]
    v_mfma_f32_32x32x16_bf16 v[152:167], v[24:27], v[16:19], v[152:167]
    s_waitcnt vmcnt(1)
    v_mfma_f32_32x32x16_bf16 v[104:119], v[36:39], v[28:31], v[104:119]
    v_mfma_f32_32x32x16_bf16 v[136:151], v[40:43], v[28:31], v[136:151]
    s_waitcnt vmcnt(0)
    v_mfma_f32_32x32x16_bf16 v[120:135], v[36:39], v[32:35], v[120:135]
    v_mfma_f32_32x32x16_bf16 v[152:167], v[40:43], v[32:35], v[152:167]
    s_lshr_b32 s36, s50, 1
    s_and_b32 s37, s50, 1
    s_lshl_b32 s72, s54, 6
    s_lshl_b32 s38, s37, 5
    s_add_u32 s72, s72, s38
    s_lshl_b32 s56, s80, 1
    s_add_u32 s56, s56, s36
    s_mul_i32 s56, s56, 40960
    s_add_u32 s56, s56, s72
    v_lshrrev_b32 v13, 5, v1
    v_lshlrev_b32 v13, 3, v13
    v_and_b32 v12, 31, v1
    v_mul_u32_u24 v12, 1280, v12
    v_add_u32 v12, v12, v13
    v_add_u32 v0, v12, v13
    buffer_load_dwordx2 v[16:17], v13, s[60:63], s72 offen offset:0
    buffer_load_dwordx2 v[18:19], v13, s[60:63], s72 offen offset:16
    buffer_load_dwordx2 v[28:29], v12, s[8:11], s56 offen offset:0
    buffer_load_dwordx2 v[30:31], v12, s[8:11], s56 offen offset:16
    buffer_load_dwordx2 v[20:21], v13, s[60:63], s72 offen offset:64
    buffer_load_dwordx2 v[22:23], v13, s[60:63], s72 offen offset:80
    buffer_load_dwordx2 v[32:33], v12, s[8:11], s56 offen offset:64
    buffer_load_dwordx2 v[34:35], v12, s[8:11], s56 offen offset:80
    s_waitcnt vmcnt(0)
    v_lshlrev_b32 v14, 16, v16
    v_and_b32 v15, 0xffff0000, v16
    v_add_f32 v104, v104, v14
    v_add_f32 v105, v105, v15
    v_lshlrev_b32 v14, 16, v17
    v_and_b32 v15, 0xffff0000, v17
    v_add_f32 v106, v106, v14
    v_add_f32 v107, v107, v15
    v_lshlrev_b32 v14, 16, v18
    v_and_b32 v15, 0xffff0000, v18
    v_add_f32 v108, v108, v14
    v_add_f32 v109, v109, v15
    v_lshlrev_b32 v14, 16, v19
    v_and_b32 v15, 0xffff0000, v19
    v_add_f32 v110, v110, v14
    v_add_f32 v111, v111, v15
    v_lshlrev_b32 v14, 16, v28
    v_and_b32 v15, 0xffff0000, v28
    v_add_f32 v104, v104, v14
    v_add_f32 v105, v105, v15
    v_lshlrev_b32 v14, 16, v29
    v_and_b32 v15, 0xffff0000, v29
    v_add_f32 v106, v106, v14
    v_add_f32 v107, v107, v15
    v_lshlrev_b32 v14, 16, v30
    v_and_b32 v15, 0xffff0000, v30
    v_add_f32 v108, v108, v14
    v_add_f32 v109, v109, v15
    v_lshlrev_b32 v14, 16, v31
    v_and_b32 v15, 0xffff0000, v31
    v_add_f32 v110, v110, v14
    v_add_f32 v111, v111, v15
    v_lshlrev_b32 v14, 16, v20
    v_and_b32 v15, 0xffff0000, v20
    v_add_f32 v136, v136, v14
    v_add_f32 v137, v137, v15
    v_lshlrev_b32 v14, 16, v21
    v_and_b32 v15, 0xffff0000, v21
    v_add_f32 v138, v138, v14
    v_add_f32 v139, v139, v15
    v_lshlrev_b32 v14, 16, v22
    v_and_b32 v15, 0xffff0000, v22
    v_add_f32 v140, v140, v14
    v_add_f32 v141, v141, v15
    v_lshlrev_b32 v14, 16, v23
    v_and_b32 v15, 0xffff0000, v23
    v_add_f32 v142, v142, v14
    v_add_f32 v143, v143, v15
    v_lshlrev_b32 v14, 16, v32
    v_and_b32 v15, 0xffff0000, v32
    v_add_f32 v136, v136, v14
    v_add_f32 v137, v137, v15
    v_lshlrev_b32 v14, 16, v33
    v_and_b32 v15, 0xffff0000, v33
    v_add_f32 v138, v138, v14
    v_add_f32 v139, v139, v15
    v_lshlrev_b32 v14, 16, v34
    v_and_b32 v15, 0xffff0000, v34
    v_add_f32 v140, v140, v14
    v_add_f32 v141, v141, v15
    v_lshlrev_b32 v14, 16, v35
    v_and_b32 v15, 0xffff0000, v35
    v_add_f32 v142, v142, v14
    v_add_f32 v143, v143, v15
    s_setprio 3
    buffer_load_dwordx4 v[24:27], v4, s[16:19], s74 offen offset:0 sc1
    buffer_load_dwordx4 v[28:31], v4, s[16:19], s74 offen offset:1024 sc1
    s_add_u32 s74, s74, 20480
    s_lshr_b32 s36, s50, 1
    s_lshl_b32 s37, s80, 1
    s_add_u32 s37, s37, s36
    s_mul_i32 s70, s37, 40960
    s_xor_b32 s37, s37, 1
    s_mul_i32 s71, s37, 40960
    s_mul_i32 s36, s50, 10240
    s_add_u32 s36, s36, 18239488
    s_add_u32 s70, s70, s36
    s_add_u32 s71, s71, s36
    s_mul_i32 s58, s50, 20480
    v_and_b32 v9, 31, v1
    v_lshlrev_b32 v2, 3, v9
    v_lshrrev_b32 v9, 5, v1
    v_lshl_add_u32 v2, v9, 8, v2
    v_add_u32 v2, s58, v2
    v_add_u32 v3, s57, v5
    v_mov_b32 v9, 159320
LW28:
    ds_read_b32 v10, v9
    s_waitcnt lgkmcnt(0)
    v_cmp_gt_u32 vcc, 8, v10
    s_nop 1
    s_cbranch_vccz LW28_OK
    s_add_u32 s101, s101, 1
    s_cmp_gt_u32 s101, 0x40000
    s_cbranch_scc1 K_END
    s_sleep 2
    s_branch LW28
LW28_OK:
    s_cmp_lg_u32 s3, 0
    s_cbranch_scc1 GATE29_W
    s_lshr_b32 s36, s80, 2
    s_lshl_b32 s36, s36, 8
    s_add_u32 s36, s36, 20905984
    v_mov_b32 v12, s36
    v_mov_b32 v13, 32
POLL30:
    buffer_load_dword v14, v12, s[16:19], 0 offen sc1
    s_waitcnt vmcnt(0)
    v_cmp_gt_u32 vcc, v13, v14
    s_nop 1
    s_cbranch_vccz POLL30_OK
    s_add_u32 s101, s101, 1
    s_cmp_gt_u32 s101, 0x40000
    s_cbranch_scc1 K_END
    s_sleep 2
    s_branch POLL30
POLL30_OK:
    v_mov_b32 v12, 159328
    v_mov_b32 v13, 1
    s_mov_b64 exec, 1
    ds_add_u32 v12, v13
    s_mov_b64 exec, -1
    s_branch GATE29_G
GATE29_W:
    v_mov_b32 v12, 159328
LW31:
    ds_read_b32 v13, v12
    s_waitcnt lgkmcnt(0)
    v_cmp_gt_u32 vcc, 2, v13
    s_nop 1
    s_cbranch_vccz LW31_OK
    s_add_u32 s101, s101, 1
    s_cmp_gt_u32 s101, 0x40000
    s_cbranch_scc1 K_END
    s_sleep 2
    s_branch LW31
LW31_OK:
GATE29_G:
    s_add_u32 m0, s58, 0
    s_nop 0
    buffer_load_dwordx4 v5, s[16:19], s70 offen offset:0 sc1 lds
    buffer_load_dwordx4 v5, s[16:19], s70 offen offset:1024 sc1 lds
    buffer_load_dwordx4 v5, s[16:19], s70 offen offset:2048 sc1 lds
    buffer_load_dwordx4 v5, s[16:19], s70 offen offset:3072 sc1 lds
    s_add_u32 s70, s70, 4096
    s_add_u32 m0, s58, 10240
    s_nop 0
    buffer_load_dwordx4 v5, s[16:19], s71 offen offset:0 sc1 lds
    buffer_load_dwordx4 v5, s[16:19], s71 offen offset:1024 sc1 lds
    buffer_load_dwordx4 v5, s[16:19], s71 offen offset:2048 sc1 lds
    buffer_load_dwordx4 v5, s[16:19], s71 offen offset:3072 sc1 lds
    s_add_u32 s71, s71, 4096
    s_add_u32 m0, s58, 4096
    s_nop 0
    buffer_load_dwordx4 v5, s[16:19], s70 offen offset:0 sc1 lds
    buffer_load_dwordx4 v5, s[16:19], s70 offen offset:1024 sc1 lds
    buffer_load_dwordx4 v5, s[16:19], s70 offen offset:2048 sc1 lds
    buffer_load_dwordx4 v5, s[16:19], s70 offen offset:3072 sc1 lds
    s_add_u32 s70, s70, 4096
    s_add_u32 m0, s58, 14336
    s_nop 0
    buffer_load_dwordx4 v5, s[16:19], s71 offen offset:0 sc1 lds
    buffer_load_dwordx4 v5, s[16:19], s71 offen offset:1024 sc1 lds
    buffer_load_dwordx4 v5, s[16:19], s71 offen offset:2048 sc1 lds
    buffer_load_dwordx4 v5, s[16:19], s71 offen offset:3072 sc1 lds
    s_add_u32 s71, s71, 4096
    s_add_u32 m0, s58, 8192
    s_nop 0
    buffer_load_dwordx4 v5, s[16:19], s70 offen offset:0 sc1 lds
    buffer_load_dwordx4 v5, s[16:19], s70 offen offset:1024 sc1 lds
    s_add_u32 s70, s70, 4096
    s_add_u32 m0, s58, 18432
    s_nop 0
    buffer_load_dwordx4 v5, s[16:19], s71 offen offset:0 sc1 lds
    buffer_load_dwordx4 v5, s[16:19], s71 offen offset:1024 sc1 lds
    s_add_u32 s71, s71, 4096
    s_waitcnt vmcnt(19)
    ds_read_b64 v[12:13], v2 offset:0
    ds_read_b64 v[14:15], v2 offset:512
    s_waitcnt vmcnt(15)
    ds_read_b64 v[16:17], v2 offset:10240
    ds_read_b64 v[18:19], v2 offset:10752
    s_waitcnt lgkmcnt(2)
    v_mfma_f32_32x32x16_bf16 v[104:119], v[24:27], v[12:15], v[104:119]
    ds_read_b128 v[40:43], v3 offset:0
    ds_read_b128 v[44:47], v3 offset:1024
    s_waitcnt vmcnt(18)
    ds_read_b64 v[20:21], v2 offset:1024
    ds_read_b64 v[22:23], v2 offset:1536
    v_mfma_f32_32x32x16_bf16 v[136:151], v[28:31], v[12:15], v[136:151]
    s_waitcnt lgkmcnt(4)
    v_mfma_f32_32x32x16_bf16 v[120:135], v[24:27], v[16:19], v[120:135]
    s_waitcnt vmcnt(14)
    ds_read_b64 v[12:13], v2 offset:11264
    ds_read_b64 v[14:15], v2 offset:11776
    v_mfma_f32_32x32x16_bf16 v[152:167], v[28:31], v[16:19], v[152:167]
    s_waitcnt lgkmcnt(2)
    v_mfma_f32_32x32x16_bf16 v[104:119], v[40:43], v[20:23], v[104:119]
    ds_read_b128 v[32:35], v3 offset:2048
    ds_read_b128 v[36:39], v3 offset:3072
    s_waitcnt vmcnt(17)
    ds_read_b64 v[16:17], v2 offset:2048
    ds_read_b64 v[18:19], v2 offset:2560
    v_mfma_f32_32x32x16_bf16 v[136:151], v[44:47], v[20:23], v[136:151]
    s_waitcnt lgkmcnt(4)
    v_mfma_f32_32x32x16_bf16 v[120:135], v[40:43], v[12:15], v[120:135]
    s_waitcnt vmcnt(13)
    ds_read_b64 v[20:21], v2 offset:12288
    ds_read_b64 v[22:23], v2 offset:12800
    v_mfma_f32_32x32x16_bf16 v[152:167], v[44:47], v[12:15], v[152:167]
    s_waitcnt lgkmcnt(2)
    v_mfma_f32_32x32x16_bf16 v[104:119], v[32:35], v[16:19], v[104:119]
    ds_read_b128 v[40:43], v3 offset:4096
    ds_read_b128 v[44:47], v3 offset:5120
    s_waitcnt vmcnt(16)
    ds_read_b64 v[12:13], v2 offset:3072
    ds_read_b64 v[14:15], v2 offset:3584
    v_mfma_f32_32x32x16_bf16 v[136:151], v[36:39], v[16:19], v[136:151]
    s_waitcnt lgkmcnt(4)
    v_mfma_f32_32x32x16_bf16 v[120:135], v[32:35], v[20:23], v[120:135]
    s_waitcnt vmcnt(12)
    ds_read_b64 v[16:17], v2 offset:13312
    ds_read_b64 v[18:19], v2 offset:13824
    v_mfma_f32_32x32x16_bf16 v[152:167], v[36:39], v[20:23], v[152:167]
    s_waitcnt lgkmcnt(2)
    v_mfma_f32_32x32x16_bf16 v[104:119], v[40:43], v[12:15], v[104:119]
    ds_read_b128 v[32:35], v3 offset:6144
    ds_read_b128 v[36:39], v3 offset:7168
    s_waitcnt vmcnt(11)
    ds_read_b64 v[20:21], v2 offset:4096
    ds_read_b64 v[22:23], v2 offset:4608
    v_mfma_f32_32x32x16_bf16 v[136:151], v[44:47], v[12:15], v[136:151]
    s_waitcnt lgkmcnt(4)
    v_mfma_f32_32x32x16_bf16 v[120:135], v[40:43], v[16:19], v[120:135]
    s_waitcnt vmcnt(7)
    ds_read_b64 v[12:13], v2 offset:14336
    ds_read_b64 v[14:15], v2 offset:14848
    v_mfma_f32_32x32x16_bf16 v[152:167], v[44:47], v[16:19], v[152:167]
    s_waitcnt lgkmcnt(2)
    v_mfma_f32_32x32x16_bf16 v[104:119], v[32:35], v[20:23], v[104:119]
    ds_read_b128 v[40:43], v3 offset:8192
    ds_read_b128 v[44:47], v3 offset:9216
    s_waitcnt vmcnt(10)
    ds_read_b64 v[16:17], v2 offset:5120
    ds_read_b64 v[18:19], v2 offset:5632
    v_mfma_f32_32x32x16_bf16 v[136:151], v[36:39], v[20:23], v[136:151]
    s_waitcnt lgkmcnt(4)
    v_mfma_f32_32x32x16_bf16 v[120:135], v[32:35], v[12:15], v[120:135]
    s_waitcnt vmcnt(6)
    ds_read_b64 v[20:21], v2 offset:15360
    ds_read_b64 v[22:23], v2 offset:15872
    v_mfma_f32_32x32x16_bf16 v[152:167], v[36:39], v[12:15], v[152:167]
    s_waitcnt lgkmcnt(2)
    v_mfma_f32_32x32x16_bf16 v[104:119], v[40:43], v[16:19], v[104:119]
    ds_read_b128 v[32:35], v3 offset:10240
    ds_read_b128 v[36:39], v3 offset:11264
    s_waitcnt vmcnt(9)
    ds_read_b64 v[12:13], v2 offset:6144
    ds_read_b64 v[14:15], v2 offset:6656
    v_mfma_f32_32x32x16_bf16 v[136:151], v[44:47], v[16:19], v[136:151]
    s_waitcnt lgkmcnt(4)
    v_mfma_f32_32x32x16_bf16 v[120:135], v[40:43], v[20:23], v[120:135]
    s_waitcnt vmcnt(5)
    ds_read_b64 v[16:17], v2 offset:16384
    ds_read_b64 v[18:19], v2 offset:16896
    v_mfma_f32_32x32x16_bf16 v[152:167], v[44:47], v[20:23], v[152:167]
    s_waitcnt lgkmcnt(2)
    v_mfma_f32_32x32x16_bf16 v[104:119], v[32:35], v[12:15], v[104:119]
    ds_read_b128 v[40:43], v3 offset:12288
    ds_read_b128 v[44:47], v3 offset:13312
    s_waitcnt vmcnt(8)
    ds_read_b64 v[20:21], v2 offset:7168
    ds_read_b64 v[22:23], v2 offset:7680
    v_mfma_f32_32x32x16_bf16 v[136:151], v[36:39], v[12:15], v[136:151]
    s_waitcnt lgkmcnt(4)
    v_mfma_f32_32x32x16_bf16 v[120:135], v[32:35], v[16:19], v[120:135]
    s_waitcnt vmcnt(4)
    ds_read_b64 v[12:13], v2 offset:17408
    ds_read_b64 v[14:15], v2 offset:17920
    v_mfma_f32_32x32x16_bf16 v[152:167], v[36:39], v[16:19], v[152:167]
    s_waitcnt lgkmcnt(2)
    v_mfma_f32_32x32x16_bf16 v[104:119], v[40:43], v[20:23], v[104:119]
    ds_read_b128 v[32:35], v3 offset:14336
    ds_read_b128 v[36:39], v3 offset:15360
    s_waitcnt vmcnt(3)
    ds_read_b64 v[16:17], v2 offset:8192
    ds_read_b64 v[18:19], v2 offset:8704
    v_mfma_f32_32x32x16_bf16 v[136:151], v[44:47], v[20:23], v[136:151]
    s_waitcnt lgkmcnt(4)
    v_mfma_f32_32x32x16_bf16 v[120:135], v[40:43], v[12:15], v[120:135]
    s_waitcnt vmcnt(1)
    ds_read_b64 v[20:21], v2 offset:18432
    ds_read_b64 v[22:23], v2 offset:18944
    v_mfma_f32_32x32x16_bf16 v[152:167], v[44:47], v[12:15], v[152:167]
    s_waitcnt lgkmcnt(2)
    v_mfma_f32_32x32x16_bf16 v[104:119], v[32:35], v[16:19], v[104:119]
    ds_read_b128 v[40:43], v3 offset:16384
    ds_read_b128 v[44:47], v3 offset:17408
    s_waitcnt vmcnt(2)
    ds_read_b64 v[12:13], v2 offset:9216
    ds_read_b64 v[14:15], v2 offset:9728
    v_mfma_f32_32x32x16_bf16 v[136:151], v[36:39], v[16:19], v[136:151]
    s_waitcnt lgkmcnt(4)
    v_mfma_f32_32x32x16_bf16 v[120:135], v[32:35], v[20:23], v[120:135]
    s_waitcnt vmcnt(0)
    ds_read_b64 v[16:17], v2 offset:19456
    ds_read_b64 v[18:19], v2 offset:19968
    v_mfma_f32_32x32x16_bf16 v[152:167], v[36:39], v[20:23], v[152:167]
    s_waitcnt lgkmcnt(2)
    v_mfma_f32_32x32x16_bf16 v[104:119], v[40:43], v[12:15], v[104:119]
    v_mfma_f32_32x32x16_bf16 v[136:151], v[44:47], v[12:15], v[136:151]
    s_waitcnt lgkmcnt(0)
    v_mfma_f32_32x32x16_bf16 v[120:135], v[40:43], v[16:19], v[120:135]
    v_mfma_f32_32x32x16_bf16 v[152:167], v[44:47], v[16:19], v[152:167]
    s_nop 7
    ds_write_b128 v11, v[112:115] offset:0
    ds_write_b128 v11, v[116:119] offset:1024
    ds_write_b128 v11, v[144:147] offset:2048
    ds_write_b128 v11, v[148:151] offset:3072
    ds_write_b128 v11, v[120:123] offset:6144
    ds_write_b128 v11, v[124:127] offset:7168
    ds_write_b128 v11, v[152:155] offset:8192
    ds_write_b128 v11, v[156:159] offset:9216
    ds_write_b128 v11, v[128:131] offset:12288
    ds_write_b128 v11, v[132:135] offset:13312
    ds_write_b128 v11, v[160:163] offset:14336
    ds_write_b128 v11, v[164:167] offset:15360
    s_xor_b32 s36, s50, 1
    s_mul_i32 s36, s36, 18432
    s_add_u32 s36, s36, 85504
    v_add_u32 v2, s36, v5
    s_xor_b32 s36, s50, 2
    s_mul_i32 s36, s36, 18432
    s_add_u32 s36, s36, 91648
    v_add_u32 v3, s36, v5
    s_xor_b32 s36, s50, 3
    s_mul_i32 s36, s36, 18432
    s_add_u32 s36, s36, 97792
    v_add_u32 v4, s36, v5
    v_mov_b32 v8, 1
    s_waitcnt lgkmcnt(0)
    ds_write_b32 v6, v8
FF_SP2:
    ds_read_b32 v9, v7
    s_waitcnt lgkmcnt(0)
    v_cmp_gt_u32 vcc, 1, v9
    s_nop 1
    s_cbranch_vccz FF_SP2_OK
    s_add_u32 s101, s101, 1
    s_cmp_gt_u32 s101, 0x40000
    s_cbranch_scc1 K_END
    s_sleep 0
    s_branch FF_SP2
FF_SP2_OK:
    ds_read_b128 v[112:115], v2 offset:0
    ds_read_b128 v[116:119], v2 offset:1024
    ds_read_b128 v[120:123], v3 offset:0
    ds_read_b128 v[124:127], v3 offset:1024
    ds_read_b128 v[128:131], v4 offset:0
    ds_read_b128 v[132:135], v4 offset:1024
    ds_read_b128 v[144:147], v2 offset:2048
    ds_read_b128 v[148:151], v2 offset:3072
    ds_read_b128 v[152:155], v3 offset:2048
    ds_read_b128 v[156:159], v3 offset:3072
    ds_read_b128 v[160:163], v4 offset:2048
    ds_read_b128 v[164:167], v4 offset:3072
    s_waitcnt lgkmcnt(6)
    v_add_f32 v112, v112, v120
    v_add_f32 v104, v104, v128
    v_add_f32 v113, v113, v121
    v_add_f32 v105, v105, v129
    v_add_f32 v114, v114, v122
    v_add_f32 v106, v106, v130
    v_add_f32 v115, v115, v123
    v_add_f32 v107, v107, v131
    v_add_f32 v116, v116, v124
    v_add_f32 v108, v108, v132
    v_add_f32 v117, v117, v125
    v_add_f32 v109, v109, v133
    v_add_f32 v118, v118, v126
    v_add_f32 v110, v110, v134
    v_add_f32 v119, v119, v127
    v_add_f32 v111, v111, v135
    v_add_f32 v104, v104, v112
    v_add_f32 v105, v105, v113
    v_add_f32 v106, v106, v114
    v_add_f32 v107, v107, v115
    v_add_f32 v108, v108, v116
    v_add_f32 v109, v109, v117
    v_add_f32 v110, v110, v118
    v_add_f32 v111, v111, v119
    s_waitcnt lgkmcnt(0)
    v_add_f32 v144, v144, v152
    v_add_f32 v136, v136, v160
    v_add_f32 v145, v145, v153
    v_add_f32 v137, v137, v161
    v_add_f32 v146, v146, v154
    v_add_f32 v138, v138, v162
    v_add_f32 v147, v147, v155
    v_add_f32 v139, v139, v163
    v_add_f32 v148, v148, v156
    v_add_f32 v140, v140, v164
    v_add_f32 v149, v149, v157
    v_add_f32 v141, v141, v165
    v_add_f32 v150, v150, v158
    v_add_f32 v142, v142, v166
    v_add_f32 v151, v151, v159
    v_add_f32 v143, v143, v167
    v_add_f32 v136, v136, v144
    v_add_f32 v137, v137, v145
    v_add_f32 v138, v138, v146
    v_add_f32 v139, v139, v147
    v_add_f32 v140, v140, v148
    v_add_f32 v141, v141, v149
    v_add_f32 v142, v142, v150
    v_add_f32 v143, v143, v151
    v_cvt_pk_bf16_f32 v120, v104, v105
    v_cvt_pk_bf16_f32 v121, v106, v107
    v_cvt_pk_bf16_f32 v122, v108, v109
    v_cvt_pk_bf16_f32 v123, v110, v111
    s_nop 1
    v_permlane32_swap_b32 v120, v122
    v_permlane32_swap_b32 v121, v123
    buffer_store_dwordx4 v[120:123], v0, s[64:67], s56 offen offset:0 nt
    v_cvt_pk_bf16_f32 v152, v136, v137
    v_cvt_pk_bf16_f32 v153, v138, v139
    v_cvt_pk_bf16_f32 v154, v140, v141
    v_cvt_pk_bf16_f32 v155, v142, v143
    s_nop 1
    v_permlane32_swap_b32 v152, v154
    v_permlane32_swap_b32 v153, v155
    buffer_store_dwordx4 v[152:155], v0, s[64:67], s56 offen offset:64 nt
    s_endpgm
K_END:
    s_endpgm
.section .rodata,"a"
.p2align 6
.amdhsa_kernel parallel_sum__mha_block__dense_activation_gelu__prompt_kernel
  .amdhsa_next_free_vgpr 168
  .amdhsa_next_free_sgpr 102
  .amdhsa_accum_offset 168
  .amdhsa_group_segment_fixed_size 0
  .amdhsa_kernarg_size 88
  .amdhsa_user_sgpr_count 2
  .amdhsa_user_sgpr_kernarg_segment_ptr 1
  .amdhsa_system_sgpr_workgroup_id_x 1
.end_amdhsa_kernel
```
